```python
import torch

def _softmax(x, axis=-1):
    return torch.softmax(x, dim=axis)
def _gelu(x):
    return torch.nn.functional.gelu(x, approximate="tanh")
def _silu(x):
    return torch.nn.functional.silu(x)
def _sigmoid(x):
    return torch.sigmoid(x)
def _layernorm(x, axis=-1, eps=1e-5):
    m = x.mean(dim=axis, keepdim=True)
    v = x.var(dim=axis, keepdim=True, unbiased=False)
    return (x - m) / torch.sqrt(v + eps)
def _scatter_add(tgt, idx, src, axis=0):
    return tgt.clone().index_add_(axis, idx, src)
def _segment_sum(src, seg, n):
    out = torch.zeros((n,) + src.shape[1:], dtype=src.dtype)
    return out.index_add_(0, seg, src)
def _pad(x, pw):
    flat = tuple(v for pair in reversed(pw) for v in pair)
    return torch.nn.functional.pad(x, flat)

kernel_name = 'gated_mix__sliding_block__dense_activation_relu__prompt'

def setup_inputs():

    _w = (lambda a: (lambda t: t.to(torch.bfloat16) if t.is_floating_point() else t)(torch.as_tensor(a)))
    def _A_setup():
        B, S, D = 1, 2048, 640
        return {
            "x": _w((lambda *s: torch.randn(*s, dtype=torch.bfloat16) * 0.05)(B, S, D)),
            "wqkv": _w((lambda *s: torch.randn(*s, dtype=torch.bfloat16) * 1.6)(D, 3 * D)),
            "wo": _w((lambda *s: torch.randn(*s, dtype=torch.bfloat16) * 0.05)(D, D)),
        }
    _A_in = _A_setup()

    def _B_setup():
        B, S, D, Dff = 1, 2048, 640, 1536
        return {
            "x": _w((lambda *s: torch.randn(*s, dtype=torch.bfloat16) * 0.05)(B, S, D)),
            "w1": _w((lambda *s: torch.randn(*s, dtype=torch.bfloat16) * 0.2)(D, Dff)),
            "w2": _w((lambda *s: torch.randn(*s, dtype=torch.bfloat16) * 0.2)(Dff, D)),
        }
    _B_in = _B_setup()

    return {
        "A_x": _A_in["x"],
        "A_wqkv": _A_in["wqkv"],
        "A_wo": _A_in["wo"],
        "B_x": _B_in["x"],
        "B_w1": _B_in["w1"],
        "B_w2": _B_in["w2"],
        "gate_w": _w((lambda *s: torch.randn(*s, dtype=torch.bfloat16) * 0.05)(640) * 16.0),
    }

def reference(A_x, A_wqkv, A_wo, B_x, B_w1, B_w2, gate_w):
    def _A_ref(x, wqkv, wo):
        B, S, D = x.shape
        H = 32; Dh = D // H; W = 256
        qkv = (lambda x, *d: x.permute(*d))((x @ wqkv).reshape(B, S, 3, H, Dh), 2, 0, 3, 1, 4)
        q, k, v = qkv[0], qkv[1], qkv[2]
        scores = torch.einsum("bhqd,bhkd->bhqk", q, k) * (Dh ** -0.5)
        idx = torch.arange(S)
        mask = (idx[:, None] - idx[None, :] >= 0) & (idx[:, None] - idx[None, :] < W)
        scores = torch.where(mask[None, None], scores, -1e9)
        p = _softmax(scores, axis=-1)
        o = torch.einsum("bhqk,bhkd->bhqd", p, v)
        return (lambda x, *d: x.permute(*d))(o, 0, 2, 1, 3).reshape(B, S, D) @ wo

    def _B_ref(x, w1, w2):
        h = torch.einsum("bsd,df->bsf", x, w1)
        zero = torch.zeros_like(h)
        h = torch.maximum(h, zero)
        return torch.einsum("bsf,fd->bsd", h, w2)

    x = A_x
    g = _sigmoid((x * gate_w).sum(-1, keepdims=True))
    a = _A_ref(x, A_wqkv, A_wo)
    b = _B_ref(x, B_w1, B_w2)
    return g * a + (1 - g) * b
```

```asm
; @launch grid=(256,1,1) block=(512,1,1) lds=163840
.amdgcn_target "amdgcn-amd-amdhsa--gfx950"
.text
.globl gated_mix__sliding_block__dense_activation_relu__prompt_kernel
.p2align 8
.type gated_mix__sliding_block__dense_activation_relu__prompt_kernel,@function
gated_mix__sliding_block__dense_activation_relu__prompt_kernel:
    s_cmp_ge_u32 s2, 256
    s_cbranch_scc1 L_END
    s_load_dwordx4 s[40:43], s[0:1], 0
    s_load_dwordx2 s[44:45], s[0:1], 16
    s_load_dwordx4 s[48:51], s[0:1], 32
    s_load_dwordx4 s[52:55], s[0:1], 48
    s_load_dwordx4 s[56:59], s[0:1], 64
    v_and_b32 v1, 63, v0
    v_lshrrev_b32 v2, 6, v0
    s_and_b32 s63, s2, 7
    s_lshr_b32 s64, s2, 3
    v_readfirstlane_b32 s3, v2
    s_lshr_b32 s93, s63, 2
    s_lshl_b32 s93, s93, 3
    s_and_b32 s65, s64, 7
    s_add_u32 s93, s93, s65
    s_lshr_b32 s62, s64, 3
    s_and_b32 s94, s63, 3
    s_lshl_b32 s94, s94, 2
    s_add_u32 s94, s94, s62
    s_lshl_b32 s92, s93, 4
    s_add_u32 s92, s92, s94
    v_lshrrev_b32 v6, 3, v1
    v_lshrrev_b32 v7, 4, v1
    v_and_b32 v8, 7, v1
    s_and_b32 s74, s3, 3
    s_lshl_b32 s64, s74, 5
    v_add_u32 v9, s64, v6
    v_mul_u32_u24 v4, 1280, v9
    v_xor_b32 v10, v8, v7
    v_lshl_add_u32 v4, v10, 4, v4
    v_xor_b32 v10, 4, v10
    v_add_u32 v9, 8, v9
    v_mul_u32_u24 v5, 1280, v9
    v_lshl_add_u32 v5, v10, 4, v5
    s_mul_i32 s66, s93, 163840
    s_add_u32 s75, s66, 20480
    s_lshr_b32 s64, s74, 1
    s_lshl_b32 s64, s64, 5
    v_add_u32 v9, s64, v6
    v_and_b32 v10, 2, v6
    v_xor_b32 v10, v8, v10
    s_and_b32 s65, s74, 1
    s_lshl_b32 s65, s65, 7
    v_lshl_add_u32 v13, v10, 4, s65
    v_xor_b32 v10, 4, v10
    v_lshl_add_u32 v14, v10, 4, s65
    v_mul_u32_u24 v2, 3840, v9
    v_add_u32 v2, v2, v13
    v_add_u32 v10, 8, v9
    v_mul_u32_u24 v3, 3840, v10
    v_add_u32 v3, v3, v14
    s_lshl_b32 s67, s94, 8
    s_lshl_b32 s68, s74, 12
    s_lshr_b32 s64, s74, 1
    s_lshl_b32 s69, s64, 13
    s_and_b32 s65, s74, 1
    s_lshl_b32 s65, s65, 12
    s_add_u32 s69, s69, s65
    s_add_u32 s69, s69, 16384
    s_cmp_eq_u32 s94, 15
    s_cselect_b32 s67, 0x7ff00000, s67
    s_cselect_b32 s70, 0, 245760
    s_add_u32 s76, s67, 61440
    s_waitcnt lgkmcnt(0)
    s_mov_b32 s8, s40
    s_and_b32 s9, s41, 0xffff
    s_mov_b32 s10, 2621440
    s_mov_b32 s11, 0x00020000
    s_mov_b32 s12, s42
    s_and_b32 s13, s43, 0xffff
    s_mov_b32 s14, 2457600
    s_mov_b32 s15, 0x00020000
    s_mov_b32 s36, s58
    s_and_b32 s37, s59, 0xffff
    s_mov_b32 s38, 23068672
    s_mov_b32 s39, 0x00020000
    s_mov_b32 s88, s56
    s_and_b32 s89, s57, 0xffff
    s_mov_b32 s90, 256
    s_mov_b32 s91, 0x00020000
    s_xor_b32 s64, s3, 4
    s_or_b32 s64, s64, s2
    s_cmp_lg_u32 s64, 0
    s_cbranch_scc1 L_notok
    v_mov_b32 v8, 18808832
    buffer_load_dword v9, v8, s[36:39], 0 offen sc1
    s_waitcnt vmcnt(0)
    v_add_u32 v9, 1, v9
    v_mov_b32 v10, v9
    v_mov_b32 v11, 0x5a5a5a5a
    v_mov_b32 v14, 0
    s_mov_b64 exec, 1
    buffer_store_dword v9, v8, s[36:39], 0 offen sc1
    buffer_store_dwordx2 v[10:11], v14, s[88:91], 0 offen sc1
    s_mov_b64 exec, -1
L_notok:
    s_cmp_ge_u32 s3, 4
    s_cbranch_scc1 L_lop
    s_add_u32 m0, s68, 0
    s_nop 0
    buffer_load_dwordx4 v4, s[8:11], s66 offen lds
    s_add_u32 m0, s68, 1024
    s_nop 0
    buffer_load_dwordx4 v5, s[8:11], s66 offen lds
    s_add_u32 m0, s68, 2048
    s_nop 0
    buffer_load_dwordx4 v4, s[8:11], s75 offen lds
    s_add_u32 m0, s68, 3072
    s_nop 0
    buffer_load_dwordx4 v5, s[8:11], s75 offen lds
    s_add_u32 s66, s66, 128
    s_add_u32 s75, s75, 128
    s_add_u32 m0, s69, 0
    s_nop 0
    buffer_load_dwordx4 v2, s[12:15], s67 offen lds
    s_add_u32 m0, s69, 1024
    s_nop 0
    buffer_load_dwordx4 v3, s[12:15], s67 offen lds
    s_add_u32 m0, s69, 2048
    s_nop 0
    buffer_load_dwordx4 v2, s[12:15], s76 offen lds
    s_add_u32 m0, s69, 3072
    s_nop 0
    buffer_load_dwordx4 v3, s[12:15], s76 offen lds
    s_add_u32 s67, s67, s70
    s_add_u32 s76, s76, s70
    s_add_u32 m0, s68, 32768
    s_nop 0
    buffer_load_dwordx4 v4, s[8:11], s66 offen lds
    s_add_u32 m0, s68, 33792
    s_nop 0
    buffer_load_dwordx4 v5, s[8:11], s66 offen lds
    s_add_u32 m0, s68, 34816
    s_nop 0
    buffer_load_dwordx4 v4, s[8:11], s75 offen lds
    s_add_u32 m0, s68, 35840
    s_nop 0
    buffer_load_dwordx4 v5, s[8:11], s75 offen lds
    s_add_u32 s66, s66, 128
    s_add_u32 s75, s75, 128
    s_add_u32 m0, s69, 32768
    s_nop 0
    buffer_load_dwordx4 v2, s[12:15], s67 offen lds
    s_add_u32 m0, s69, 33792
    s_nop 0
    buffer_load_dwordx4 v3, s[12:15], s67 offen lds
    s_add_u32 m0, s69, 34816
    s_nop 0
    buffer_load_dwordx4 v2, s[12:15], s76 offen lds
    s_add_u32 m0, s69, 35840
    s_nop 0
    buffer_load_dwordx4 v3, s[12:15], s76 offen lds
    s_add_u32 s67, s67, s70
    s_add_u32 s76, s76, s70
    s_add_u32 m0, s68, 65536
    s_nop 0
    buffer_load_dwordx4 v4, s[8:11], s66 offen lds
    s_add_u32 m0, s68, 66560
    s_nop 0
    buffer_load_dwordx4 v5, s[8:11], s66 offen lds
    s_add_u32 m0, s68, 67584
    s_nop 0
    buffer_load_dwordx4 v4, s[8:11], s75 offen lds
    s_add_u32 m0, s68, 68608
    s_nop 0
    buffer_load_dwordx4 v5, s[8:11], s75 offen lds
    s_add_u32 s66, s66, 128
    s_add_u32 s75, s75, 128
    s_add_u32 m0, s69, 65536
    s_nop 0
    buffer_load_dwordx4 v2, s[12:15], s67 offen lds
    s_add_u32 m0, s69, 66560
    s_nop 0
    buffer_load_dwordx4 v3, s[12:15], s67 offen lds
    s_add_u32 m0, s69, 67584
    s_nop 0
    buffer_load_dwordx4 v2, s[12:15], s76 offen lds
    s_add_u32 m0, s69, 68608
    s_nop 0
    buffer_load_dwordx4 v3, s[12:15], s76 offen lds
    s_add_u32 s67, s67, s70
    s_add_u32 s76, s76, s70
L_lop:
    s_mov_b32 s16, s48
    s_and_b32 s17, s49, 0xffff
    s_mov_b32 s18, 1966080
    s_mov_b32 s19, 0x00020000
    s_cmp_lt_u32 s3, 4
    s_cbranch_scc1 L_gtdone
    v_lshlrev_b32 v8, 7, v1
    s_cmp_eq_u32 s3, 4
    s_cbranch_scc0 L_gt5
    s_mul_i32 s64, s2, 9600
    buffer_load_dword v255, v8, s[12:15], s64 offen
    s_branch L_gtdone
L_gt5:
    s_cmp_eq_u32 s3, 5
    s_cbranch_scc0 L_gt6
    s_mul_i32 s64, s2, 7680
    buffer_load_dword v255, v8, s[16:19], s64 offen
    s_branch L_gtdone
L_gt6:
    s_cmp_eq_u32 s3, 6
    s_cbranch_scc0 L_gt7
    s_mul_i32 s64, s2, 10240
    buffer_load_dword v255, v8, s[8:11], s64 offen
    s_branch L_gtdone
L_gt7:
    v_cmp_gt_u32 vcc, 16, v1
    v_mov_b32 v9, 0x7fffff00
    s_nop 0
    v_cndmask_b32 v9, v9, v8, vcc
    s_mul_i32 s64, s2, 10240
    s_add_u32 s64, s64, 8192
    buffer_load_dword v255, v9, s[8:11], s64 offen
    s_mul_i32 s64, s2, 9600
    s_add_u32 s64, s64, 8192
    buffer_load_dword v255, v9, s[12:15], s64 offen
L_gtdone:
    s_mov_b32 s28, s52
    s_and_b32 s29, s53, 0xffff
    s_mov_b32 s30, 1280
    s_mov_b32 s31, 0x00020000
    s_mov_b32 s24, s44
    s_and_b32 s25, s45, 0xffff
    s_mov_b32 s26, 819200
    s_mov_b32 s27, 0x00020000
    s_mov_b32 s20, s50
    s_and_b32 s21, s51, 0xffff
    s_mov_b32 s22, 1966080
    s_mov_b32 s23, 0x00020000
    s_mov_b32 s32, s54
    s_and_b32 s33, s55, 0xffff
    s_mov_b32 s34, 2621440
    s_mov_b32 s35, 0x00020000
    s_cmp_ge_u32 s3, 6
    s_cbranch_scc1 L_noones
    s_lshl_b32 s64, s3, 9
    v_lshl_add_u32 v8, v1, 3, s64
    v_add_u32 v8, 160384, v8
    v_mov_b32 v10, 0x3f80
    v_mov_b32 v11, 0
    ds_write_b64 v8, v[10:11]
    v_mov_b32 v8, 163456
    v_mov_b32 v10, 0
    ds_write_b64 v8, v[10:11]
    ds_write_b64 v8, v[10:11] offset:8
    ds_write_b64 v8, v[10:11] offset:16
L_noones:
    v_add_u32 v8, 0, v1
    v_mul_u32_u24 v9, 171, v8
    v_lshrrev_b32 v9, 10, v9
    v_mul_u32_u24 v10, 6, v9
    v_sub_u32 v10, v8, v10
    v_bfe_u32 v14, v9, 2, 2
    v_lshlrev_b32 v14, 3, v14
    v_lshrrev_b32 v15, 4, v9
    v_lshl_add_u32 v14, v15, 2, v14
    v_and_b32 v15, 3, v9
    v_add_u32 v14, v14, v15
    v_mul_u32_u24 v11, 3072, v14
    v_lshl_add_u32 v11, v10, 4, v11
    v_add_u32 v8, 64, v1
    v_mul_u32_u24 v9, 171, v8
    v_lshrrev_b32 v9, 10, v9
    v_mul_u32_u24 v10, 6, v9
    v_sub_u32 v10, v8, v10
    v_bfe_u32 v14, v9, 2, 2
    v_lshlrev_b32 v14, 3, v14
    v_lshrrev_b32 v15, 4, v9
    v_lshl_add_u32 v14, v15, 2, v14
    v_and_b32 v15, 3, v9
    v_add_u32 v14, v14, v15
    v_mul_u32_u24 v12, 3072, v14
    v_lshl_add_u32 v12, v10, 4, v12
    v_add_u32 v8, 128, v1
    v_mul_u32_u24 v9, 171, v8
    v_lshrrev_b32 v9, 10, v9
    v_mul_u32_u24 v10, 6, v9
    v_sub_u32 v10, v8, v10
    v_bfe_u32 v14, v9, 2, 2
    v_lshlrev_b32 v14, 3, v14
    v_lshrrev_b32 v15, 4, v9
    v_lshl_add_u32 v14, v15, 2, v14
    v_and_b32 v15, 3, v9
    v_add_u32 v14, v14, v15
    v_mul_u32_u24 v13, 3072, v14
    v_lshl_add_u32 v13, v10, 4, v13
    s_lshr_b32 s64, s3, 1
    s_mul_i32 s71, s64, 98304
    s_mul_i32 s65, s94, 192
    s_add_u32 s71, s71, s65
    s_and_b32 s65, s3, 1
    s_mul_i32 s65, s65, 96
    s_add_u32 s71, s71, s65
    s_mul_i32 s72, s3, 3072
    v_and_b32 v6, 15, v1
    v_lshrrev_b32 v8, 1, v6
    v_xor_b32 v9, v7, v8
    s_and_b32 s64, s3, 3
    s_lshl_b32 s64, s64, 12
    v_lshlrev_b32 v10, 7, v6
    v_add_u32 v10, s64, v10
    v_lshl_add_u32 v16, v9, 4, v10
    v_xor_b32 v9, 4, v9
    v_lshl_add_u32 v17, v9, 4, v10
    v_add_u32 v18, 0x10000, v16
    v_add_u32 v19, 0x10000, v17
    v_bfe_u32 v8, v1, 2, 2
    v_and_b32 v9, 3, v1
    v_lshrrev_b32 v10, 1, v8
    v_and_b32 v14, 1, v7
    v_lshl_or_b32 v10, v14, 1, v10
    v_lshl_add_u32 v14, v7, 3, v8
    v_lshlrev_b32 v14, 7, v14
    v_lshl_add_u32 v14, v9, 3, v14
    s_lshr_b32 s64, s3, 2
    s_lshl_b32 s65, s64, 12
    s_add_u32 s65, s65, 16384
    v_add_u32 v14, s65, v14
    v_xor_b32 v15, 0, v10
    v_lshl_add_u32 v20, v15, 5, v14
    v_add_u32 v24, 0x10000, v20
    v_xor_b32 v15, 1, v10
    v_lshl_add_u32 v21, v15, 5, v14
    v_add_u32 v25, 0x10000, v21
    v_xor_b32 v15, 2, v10
    v_lshl_add_u32 v22, v15, 5, v14
    v_add_u32 v26, 0x10000, v22
    v_xor_b32 v15, 3, v10
    v_lshl_add_u32 v23, v15, 5, v14
    v_add_u32 v27, 0x10000, v23
    v_lshl_add_u32 v14, v7, 2, v8
    v_mul_u32_u24 v28, 96, v14
    v_lshl_add_u32 v28, v9, 3, v28
    s_mul_i32 s65, s64, 3072
    v_add_u32 v28, s65, v28
    v_add_u32 v29, 0x10000, v28
    v_add_u32 v31, 0x20000, v28
    v_lshlrev_b32 v30, 4, v1
    v_mov_b32 v64, 0
    v_mov_b32 v65, 0
    v_mov_b32 v66, 0
    v_mov_b32 v67, 0
    v_mov_b32 v68, 0
    v_mov_b32 v69, 0
    v_mov_b32 v70, 0
    v_mov_b32 v71, 0
    v_mov_b32 v72, 0
    v_mov_b32 v73, 0
    v_mov_b32 v74, 0
    v_mov_b32 v75, 0
    v_mov_b32 v76, 0
    v_mov_b32 v77, 0
    v_mov_b32 v78, 0
    v_mov_b32 v79, 0
    v_mov_b32 v80, 0
    v_mov_b32 v81, 0
    v_mov_b32 v82, 0
    v_mov_b32 v83, 0
    v_mov_b32 v84, 0
    v_mov_b32 v85, 0
    v_mov_b32 v86, 0
    v_mov_b32 v87, 0
    v_mov_b32 v88, 0
    v_mov_b32 v89, 0
    v_mov_b32 v90, 0
    v_mov_b32 v91, 0
    v_mov_b32 v92, 0
    v_mov_b32 v93, 0
    v_mov_b32 v94, 0
    v_mov_b32 v95, 0
    s_lshr_b32 s64, s2, 3
    s_bfe_u32 s65, s2, 0x10002
    s_lshl_b32 s65, s65, 10
    s_lshl_b32 s73, s64, 5
    s_add_u32 s65, s65, s73
    v_and_b32 v8, 31, v1
    v_add_u32 v9, s65, v8
    v_mul_u32_u24 v9, 1280, v9
    v_lshrrev_b32 v10, 5, v1
    v_lshl_add_u32 v9, v10, 7, v9
    v_lshlrev_b32 v10, 6, v7
    v_bfe_u32 v14, v1, 3, 1
    v_add_u32 v10, v10, v14
    s_lshl_b32 s73, s64, 1
    v_add_u32 v10, s73, v10
    v_mul_u32_u24 v10, 3840, v10
    v_and_b32 v14, 7, v1
    v_lshl_add_u32 v10, v14, 7, v10
    s_and_b32 s65, s2, 3
    s_lshl_b32 s73, s65, 10
    v_add_u32 v10, s73, v10
    s_and_b32 s73, s3, 1
    s_lshl_b32 s73, s73, 6
    v_add_u32 v8, s73, v1
    v_mul_u32_u24 v14, 0x2aab, v8
    v_lshrrev_b32 v14, 16, v14
    v_mul_u32_u24 v15, 6, v14
    v_sub_u32 v15, v8, v15
    s_mul_i32 s64, s64, 20
    v_add_u32 v14, s64, v14
    v_mul_u32_u24 v14, 3072, v14
    v_lshl_add_u32 v14, v15, 7, v14
    s_mul_i32 s65, s65, 768
    v_add_u32 v14, s65, v14
    v_cmp_gt_u32 vcc, 120, v8
    v_mov_b32 v15, 0x7fffff00
    s_nop 0
    v_cndmask_b32 v8, v15, v14, vcc
    s_cmp_eq_u32 s94, 15
    s_cbranch_scc1 L_GWG
    s_cmp_ge_u32 s3, 4
    s_cbranch_scc1 L_AHI
    s_waitcnt vmcnt(16)
    s_barrier
    ds_read_b128 v[96:99], v16 offset:0
    ds_read_b128 v[100:103], v16 offset:2048
    ds_read_b128 v[104:107], v17 offset:0
    ds_read_b128 v[108:111], v17 offset:2048
    ds_read_b64_tr_b16 v[32:33], v20 offset:0
    ds_read_b64_tr_b16 v[34:35], v20 offset:512
    ds_read_b64_tr_b16 v[36:37], v21 offset:0
    ds_read_b64_tr_b16 v[38:39], v21 offset:512
    ds_read_b64_tr_b16 v[40:41], v22 offset:0
    ds_read_b64_tr_b16 v[42:43], v22 offset:512
    ds_read_b64_tr_b16 v[44:45], v23 offset:0
    ds_read_b64_tr_b16 v[46:47], v23 offset:512
    ds_read_b64_tr_b16 v[48:49], v20 offset:8192
    ds_read_b64_tr_b16 v[50:51], v20 offset:8704
    ds_read_b64_tr_b16 v[52:53], v21 offset:8192
    ds_read_b64_tr_b16 v[54:55], v21 offset:8704
    ds_read_b64_tr_b16 v[56:57], v22 offset:8192
    ds_read_b64_tr_b16 v[58:59], v22 offset:8704
    ds_read_b64_tr_b16 v[60:61], v23 offset:8192
    ds_read_b64_tr_b16 v[62:63], v23 offset:8704
    s_waitcnt vmcnt(8)
    s_barrier
    ds_read_b128 v[112:115], v16 offset:32768
    s_waitcnt lgkmcnt(15)
    s_add_u32 m0, s68, 98304
    s_nop 0
    buffer_load_dwordx4 v4, s[8:11], s66 offen lds
    v_mfma_f32_16x16x32_bf16 v[64:67], v[32:35], v[96:99], v[64:67]
    v_mfma_f32_16x16x32_bf16 v[80:83], v[32:35], v[100:103], v[80:83]
    ds_read_b64_tr_b16 v[32:33], v20 offset:32768
    ds_read_b64_tr_b16 v[34:35], v20 offset:33280
    ds_read_b128 v[116:119], v16 offset:34816
    s_waitcnt lgkmcnt(15)
    s_add_u32 m0, s68, 99328
    s_nop 0
    buffer_load_dwordx4 v5, s[8:11], s66 offen lds
    v_mfma_f32_16x16x32_bf16 v[68:71], v[36:39], v[96:99], v[68:71]
    v_mfma_f32_16x16x32_bf16 v[84:87], v[36:39], v[100:103], v[84:87]
    ds_read_b64_tr_b16 v[36:37], v21 offset:32768
    ds_read_b64_tr_b16 v[38:39], v21 offset:33280
    ds_read_b128 v[120:123], v17 offset:32768
    s_waitcnt lgkmcnt(15)
    s_add_u32 m0, s68, 100352
    s_nop 0
    buffer_load_dwordx4 v4, s[8:11], s75 offen lds
    v_mfma_f32_16x16x32_bf16 v[72:75], v[40:43], v[96:99], v[72:75]
    v_mfma_f32_16x16x32_bf16 v[88:91], v[40:43], v[100:103], v[88:91]
    ds_read_b64_tr_b16 v[40:41], v22 offset:32768
    ds_read_b64_tr_b16 v[42:43], v22 offset:33280
    ds_read_b128 v[124:127], v17 offset:34816
    s_waitcnt lgkmcnt(15)
    s_add_u32 m0, s68, 101376
    s_nop 0
    buffer_load_dwordx4 v5, s[8:11], s75 offen lds
    s_add_u32 s66, s66, 128
    s_add_u32 s75, s75, 128
    v_mfma_f32_16x16x32_bf16 v[76:79], v[44:47], v[96:99], v[76:79]
    v_mfma_f32_16x16x32_bf16 v[92:95], v[44:47], v[100:103], v[92:95]
    ds_read_b64_tr_b16 v[44:45], v23 offset:32768
    ds_read_b64_tr_b16 v[46:47], v23 offset:33280
    s_waitcnt lgkmcnt(15)
    s_add_u32 m0, s69, 98304
    s_nop 0
    buffer_load_dwordx4 v2, s[12:15], s67 offen lds
    v_mfma_f32_16x16x32_bf16 v[64:67], v[48:51], v[104:107], v[64:67]
    v_mfma_f32_16x16x32_bf16 v[80:83], v[48:51], v[108:111], v[80:83]
    ds_read_b64_tr_b16 v[48:49], v20 offset:40960
    ds_read_b64_tr_b16 v[50:51], v20 offset:41472
    s_waitcnt lgkmcnt(15)
    v_mfma_f32_16x16x32_bf16 v[68:71], v[52:55], v[104:107], v[68:71]
    v_mfma_f32_16x16x32_bf16 v[84:87], v[52:55], v[108:111], v[84:87]
    ds_read_b64_tr_b16 v[52:53], v21 offset:40960
    ds_read_b64_tr_b16 v[54:55], v21 offset:41472
    s_waitcnt lgkmcnt(15)
    s_add_u32 m0, s69, 99328
    s_nop 0
    buffer_load_dwordx4 v3, s[12:15], s67 offen lds
    v_mfma_f32_16x16x32_bf16 v[72:75], v[56:59], v[104:107], v[72:75]
    v_mfma_f32_16x16x32_bf16 v[88:91], v[56:59], v[108:111], v[88:91]
    ds_read_b64_tr_b16 v[56:57], v22 offset:40960
    ds_read_b64_tr_b16 v[58:59], v22 offset:41472
    s_waitcnt lgkmcnt(15)
    s_add_u32 m0, s69, 100352
    s_nop 0
    buffer_load_dwordx4 v2, s[12:15], s76 offen lds
    v_mfma_f32_16x16x32_bf16 v[76:79], v[60:63], v[104:107], v[76:79]
    v_mfma_f32_16x16x32_bf16 v[92:95], v[60:63], v[108:111], v[92:95]
    ds_read_b64_tr_b16 v[60:61], v23 offset:40960
    ds_read_b64_tr_b16 v[62:63], v23 offset:41472
    s_add_u32 m0, s69, 101376
    s_nop 0
    buffer_load_dwordx4 v3, s[12:15], s76 offen lds
    s_add_u32 s67, s67, s70
    s_add_u32 s76, s76, s70
    s_waitcnt vmcnt(8)
    s_barrier
    ds_read_b128 v[128:131], v18 offset:0
    s_waitcnt lgkmcnt(15)
    s_add_u32 m0, s68, 0
    s_nop 0
    buffer_load_dwordx4 v4, s[8:11], s66 offen lds
    s_add_u32 m0, s68, 1024
    s_nop 0
    buffer_load_dwordx4 v5, s[8:11], s66 offen lds
    v_mfma_f32_16x16x32_bf16 v[64:67], v[32:35], v[112:115], v[64:67]
    v_mfma_f32_16x16x32_bf16 v[80:83], v[32:35], v[116:119], v[80:83]
    ds_read_b64_tr_b16 v[32:33], v24 offset:0
    ds_read_b64_tr_b16 v[34:35], v24 offset:512
    ds_read_b128 v[132:135], v18 offset:2048
    s_waitcnt lgkmcnt(15)
    s_add_u32 m0, s68, 2048
    s_nop 0
    buffer_load_dwordx4 v4, s[8:11], s75 offen lds
    s_add_u32 m0, s68, 3072
    s_nop 0
    buffer_load_dwordx4 v5, s[8:11], s75 offen lds
    s_add_u32 s66, s66, 128
    s_add_u32 s75, s75, 128
    v_mfma_f32_16x16x32_bf16 v[68:71], v[36:39], v[112:115], v[68:71]
    v_mfma_f32_16x16x32_bf16 v[84:87], v[36:39], v[116:119], v[84:87]
    ds_read_b64_tr_b16 v[36:37], v25 offset:0
    ds_read_b64_tr_b16 v[38:39], v25 offset:512
    ds_read_b128 v[136:139], v19 offset:0
    s_waitcnt lgkmcnt(15)
    s_add_u32 m0, s69, 0
    s_nop 0
    buffer_load_dwordx4 v2, s[12:15], s67 offen lds
    v_mfma_f32_16x16x32_bf16 v[72:75], v[40:43], v[112:115], v[72:75]
    v_mfma_f32_16x16x32_bf16 v[88:91], v[40:43], v[116:119], v[88:91]
    ds_read_b64_tr_b16 v[40:41], v26 offset:0
    ds_read_b64_tr_b16 v[42:43], v26 offset:512
    ds_read_b128 v[140:143], v19 offset:2048
    s_waitcnt lgkmcnt(15)
    s_add_u32 m0, s69, 1024
    s_nop 0
    buffer_load_dwordx4 v3, s[12:15], s67 offen lds
    v_mfma_f32_16x16x32_bf16 v[76:79], v[44:47], v[112:115], v[76:79]
    v_mfma_f32_16x16x32_bf16 v[92:95], v[44:47], v[116:119], v[92:95]
    ds_read_b64_tr_b16 v[44:45], v27 offset:0
    ds_read_b64_tr_b16 v[46:47], v27 offset:512
    s_waitcnt lgkmcnt(15)
    s_add_u32 m0, s69, 2048
    s_nop 0
    buffer_load_dwordx4 v2, s[12:15], s76 offen lds
    v_mfma_f32_16x16x32_bf16 v[64:67], v[48:51], v[120:123], v[64:67]
    v_mfma_f32_16x16x32_bf16 v[80:83], v[48:51], v[124:127], v[80:83]
    ds_read_b64_tr_b16 v[48:49], v24 offset:8192
    ds_read_b64_tr_b16 v[50:51], v24 offset:8704
    s_waitcnt lgkmcnt(15)
    s_add_u32 m0, s69, 3072
    s_nop 0
    buffer_load_dwordx4 v3, s[12:15], s76 offen lds
    s_add_u32 s67, s67, s70
    s_add_u32 s76, s76, s70
    v_mfma_f32_16x16x32_bf16 v[68:71], v[52:55], v[120:123], v[68:71]
    v_mfma_f32_16x16x32_bf16 v[84:87], v[52:55], v[124:127], v[84:87]
    ds_read_b64_tr_b16 v[52:53], v25 offset:8192
    ds_read_b64_tr_b16 v[54:55], v25 offset:8704
    s_waitcnt lgkmcnt(15)
    s_add_u32 m0, s72, 131072
    s_nop 0
    buffer_load_dwordx4 v11, s[16:19], s71 offen lds
    v_mfma_f32_16x16x32_bf16 v[72:75], v[56:59], v[120:123], v[72:75]
    v_mfma_f32_16x16x32_bf16 v[88:91], v[56:59], v[124:127], v[88:91]
    ds_read_b64_tr_b16 v[56:57], v26 offset:8192
    ds_read_b64_tr_b16 v[58:59], v26 offset:8704
    s_waitcnt lgkmcnt(15)
    s_add_u32 m0, s72, 132096
    s_nop 0
    buffer_load_dwordx4 v12, s[16:19], s71 offen lds
    v_mfma_f32_16x16x32_bf16 v[76:79], v[60:63], v[120:123], v[76:79]
    v_mfma_f32_16x16x32_bf16 v[92:95], v[60:63], v[124:127], v[92:95]
    ds_read_b64_tr_b16 v[60:61], v27 offset:8192
    ds_read_b64_tr_b16 v[62:63], v27 offset:8704
    s_add_u32 m0, s72, 133120
    s_nop 0
    buffer_load_dwordx4 v13, s[16:19], s71 offen lds
    s_add_u32 s71, s71, 393216
    s_waitcnt vmcnt(11)
    s_barrier
    ds_read_b128 v[144:147], v18 offset:32768
    s_waitcnt lgkmcnt(15)
    s_add_u32 m0, s68, 32768
    s_nop 0
    buffer_load_dwordx4 v4, s[8:11], s66 offen lds
    v_mfma_f32_16x16x32_bf16 v[64:67], v[32:35], v[128:131], v[64:67]
    v_mfma_f32_16x16x32_bf16 v[80:83], v[32:35], v[132:135], v[80:83]
    ds_read_b64_tr_b16 v[32:33], v24 offset:32768
    ds_read_b64_tr_b16 v[34:35], v24 offset:33280
    ds_read_b128 v[148:151], v18 offset:34816
    s_waitcnt lgkmcnt(15)
    s_add_u32 m0, s68, 33792
    s_nop 0
    buffer_load_dwordx4 v5, s[8:11], s66 offen lds
    v_mfma_f32_16x16x32_bf16 v[68:71], v[36:39], v[128:131], v[68:71]
    v_mfma_f32_16x16x32_bf16 v[84:87], v[36:39], v[132:135], v[84:87]
    ds_read_b64_tr_b16 v[36:37], v25 offset:32768
    ds_read_b64_tr_b16 v[38:39], v25 offset:33280
    ds_read_b128 v[152:155], v19 offset:32768
    s_waitcnt lgkmcnt(15)
    s_add_u32 m0, s68, 34816
    s_nop 0
    buffer_load_dwordx4 v4, s[8:11], s75 offen lds
    v_mfma_f32_16x16x32_bf16 v[72:75], v[40:43], v[128:131], v[72:75]
    v_mfma_f32_16x16x32_bf16 v[88:91], v[40:43], v[132:135], v[88:91]
    ds_read_b64_tr_b16 v[40:41], v26 offset:32768
    ds_read_b64_tr_b16 v[42:43], v26 offset:33280
    ds_read_b128 v[156:159], v19 offset:34816
    s_waitcnt lgkmcnt(15)
    s_add_u32 m0, s68, 35840
    s_nop 0
    buffer_load_dwordx4 v5, s[8:11], s75 offen lds
    s_add_u32 s66, s66, 128
    s_add_u32 s75, s75, 128
    v_mfma_f32_16x16x32_bf16 v[76:79], v[44:47], v[128:131], v[76:79]
    v_mfma_f32_16x16x32_bf16 v[92:95], v[44:47], v[132:135], v[92:95]
    ds_read_b64_tr_b16 v[44:45], v27 offset:32768
    ds_read_b64_tr_b16 v[46:47], v27 offset:33280
    s_waitcnt lgkmcnt(15)
    s_add_u32 m0, s69, 32768
    s_nop 0
    buffer_load_dwordx4 v2, s[12:15], s67 offen lds
    v_mfma_f32_16x16x32_bf16 v[64:67], v[48:51], v[136:139], v[64:67]
    v_mfma_f32_16x16x32_bf16 v[80:83], v[48:51], v[140:143], v[80:83]
    ds_read_b64_tr_b16 v[48:49], v24 offset:40960
    ds_read_b64_tr_b16 v[50:51], v24 offset:41472
    s_waitcnt lgkmcnt(15)
    v_mfma_f32_16x16x32_bf16 v[68:71], v[52:55], v[136:139], v[68:71]
    v_mfma_f32_16x16x32_bf16 v[84:87], v[52:55], v[140:143], v[84:87]
    ds_read_b64_tr_b16 v[52:53], v25 offset:40960
    ds_read_b64_tr_b16 v[54:55], v25 offset:41472
    s_waitcnt lgkmcnt(15)
    s_add_u32 m0, s69, 33792
    s_nop 0
    buffer_load_dwordx4 v3, s[12:15], s67 offen lds
    v_mfma_f32_16x16x32_bf16 v[72:75], v[56:59], v[136:139], v[72:75]
    v_mfma_f32_16x16x32_bf16 v[88:91], v[56:59], v[140:143], v[88:91]
    ds_read_b64_tr_b16 v[56:57], v26 offset:40960
    ds_read_b64_tr_b16 v[58:59], v26 offset:41472
    s_waitcnt lgkmcnt(15)
    s_add_u32 m0, s69, 34816
    s_nop 0
    buffer_load_dwordx4 v2, s[12:15], s76 offen lds
    v_mfma_f32_16x16x32_bf16 v[76:79], v[60:63], v[136:139], v[76:79]
    v_mfma_f32_16x16x32_bf16 v[92:95], v[60:63], v[140:143], v[92:95]
    ds_read_b64_tr_b16 v[60:61], v27 offset:40960
    ds_read_b64_tr_b16 v[62:63], v27 offset:41472
    s_add_u32 m0, s69, 35840
    s_nop 0
    buffer_load_dwordx4 v3, s[12:15], s76 offen lds
    s_add_u32 s67, s67, s70
    s_add_u32 s76, s76, s70
    s_waitcnt vmcnt(11)
    s_barrier
    ds_read_b128 v[160:163], v16 offset:0
    s_waitcnt lgkmcnt(15)
    s_add_u32 m0, s68, 65536
    s_nop 0
    buffer_load_dwordx4 v4, s[8:11], s66 offen lds
    v_mfma_f32_16x16x32_bf16 v[64:67], v[32:35], v[144:147], v[64:67]
    v_mfma_f32_16x16x32_bf16 v[80:83], v[32:35], v[148:151], v[80:83]
    ds_read_b64_tr_b16 v[32:33], v20 offset:0
    ds_read_b64_tr_b16 v[34:35], v20 offset:512
    ds_read_b128 v[164:167], v16 offset:2048
    s_waitcnt lgkmcnt(15)
    s_add_u32 m0, s68, 66560
    s_nop 0
    buffer_load_dwordx4 v5, s[8:11], s66 offen lds
    v_mfma_f32_16x16x32_bf16 v[68:71], v[36:39], v[144:147], v[68:71]
    v_mfma_f32_16x16x32_bf16 v[84:87], v[36:39], v[148:151], v[84:87]
    ds_read_b64_tr_b16 v[36:37], v21 offset:0
    ds_read_b64_tr_b16 v[38:39], v21 offset:512
    ds_read_b128 v[168:171], v17 offset:0
    s_waitcnt lgkmcnt(15)
    s_add_u32 m0, s68, 67584
    s_nop 0
    buffer_load_dwordx4 v4, s[8:11], s75 offen lds
    v_mfma_f32_16x16x32_bf16 v[72:75], v[40:43], v[144:147], v[72:75]
    v_mfma_f32_16x16x32_bf16 v[88:91], v[40:43], v[148:151], v[88:91]
    ds_read_b64_tr_b16 v[40:41], v22 offset:0
    ds_read_b64_tr_b16 v[42:43], v22 offset:512
    ds_read_b128 v[172:175], v17 offset:2048
    s_waitcnt lgkmcnt(15)
    s_add_u32 m0, s68, 68608
    s_nop 0
    buffer_load_dwordx4 v5, s[8:11], s75 offen lds
    s_add_u32 s66, s66, 128
    s_add_u32 s75, s75, 128
    v_mfma_f32_16x16x32_bf16 v[76:79], v[44:47], v[144:147], v[76:79]
    v_mfma_f32_16x16x32_bf16 v[92:95], v[44:47], v[148:151], v[92:95]
    ds_read_b64_tr_b16 v[44:45], v23 offset:0
    ds_read_b64_tr_b16 v[46:47], v23 offset:512
    s_waitcnt lgkmcnt(15)
    s_add_u32 m0, s69, 65536
    s_nop 0
    buffer_load_dwordx4 v2, s[12:15], s67 offen lds
    v_mfma_f32_16x16x32_bf16 v[64:67], v[48:51], v[152:155], v[64:67]
    v_mfma_f32_16x16x32_bf16 v[80:83], v[48:51], v[156:159], v[80:83]
    ds_read_b64_tr_b16 v[48:49], v20 offset:8192
    ds_read_b64_tr_b16 v[50:51], v20 offset:8704
    s_waitcnt lgkmcnt(15)
    v_mfma_f32_16x16x32_bf16 v[68:71], v[52:55], v[152:155], v[68:71]
    v_mfma_f32_16x16x32_bf16 v[84:87], v[52:55], v[156:159], v[84:87]
    ds_read_b64_tr_b16 v[52:53], v21 offset:8192
    ds_read_b64_tr_b16 v[54:55], v21 offset:8704
    s_waitcnt lgkmcnt(15)
    s_add_u32 m0, s69, 66560
    s_nop 0
    buffer_load_dwordx4 v3, s[12:15], s67 offen lds
    v_mfma_f32_16x16x32_bf16 v[72:75], v[56:59], v[152:155], v[72:75]
    v_mfma_f32_16x16x32_bf16 v[88:91], v[56:59], v[156:159], v[88:91]
    ds_read_b64_tr_b16 v[56:57], v22 offset:8192
    ds_read_b64_tr_b16 v[58:59], v22 offset:8704
    s_waitcnt lgkmcnt(15)
    s_add_u32 m0, s69, 67584
    s_nop 0
    buffer_load_dwordx4 v2, s[12:15], s76 offen lds
    v_mfma_f32_16x16x32_bf16 v[76:79], v[60:63], v[152:155], v[76:79]
    v_mfma_f32_16x16x32_bf16 v[92:95], v[60:63], v[156:159], v[92:95]
    ds_read_b64_tr_b16 v[60:61], v23 offset:8192
    ds_read_b64_tr_b16 v[62:63], v23 offset:8704
    s_add_u32 m0, s69, 68608
    s_nop 0
    buffer_load_dwordx4 v3, s[12:15], s76 offen lds
    s_add_u32 s67, s67, s70
    s_add_u32 s76, s76, s70
    s_waitcnt vmcnt(8)
    s_barrier
    ds_read_b128 v[176:179], v16 offset:32768
    s_waitcnt lgkmcnt(15)
    s_add_u32 m0, s68, 98304
    s_nop 0
    buffer_load_dwordx4 v4, s[8:11], s66 offen lds
    v_mfma_f32_16x16x32_bf16 v[64:67], v[32:35], v[160:163], v[64:67]
    v_mfma_f32_16x16x32_bf16 v[80:83], v[32:35], v[164:167], v[80:83]
    ds_read_b64_tr_b16 v[32:33], v20 offset:32768
    ds_read_b64_tr_b16 v[34:35], v20 offset:33280
    ds_read_b128 v[180:183], v16 offset:34816
    s_waitcnt lgkmcnt(15)
    s_add_u32 m0, s68, 99328
    s_nop 0
    buffer_load_dwordx4 v5, s[8:11], s66 offen lds
    v_mfma_f32_16x16x32_bf16 v[68:71], v[36:39], v[160:163], v[68:71]
    v_mfma_f32_16x16x32_bf16 v[84:87], v[36:39], v[164:167], v[84:87]
    ds_read_b64_tr_b16 v[36:37], v21 offset:32768
    ds_read_b64_tr_b16 v[38:39], v21 offset:33280
    ds_read_b128 v[184:187], v17 offset:32768
    s_waitcnt lgkmcnt(15)
    s_add_u32 m0, s68, 100352
    s_nop 0
    buffer_load_dwordx4 v4, s[8:11], s75 offen lds
    v_mfma_f32_16x16x32_bf16 v[72:75], v[40:43], v[160:163], v[72:75]
    v_mfma_f32_16x16x32_bf16 v[88:91], v[40:43], v[164:167], v[88:91]
    ds_read_b64_tr_b16 v[40:41], v22 offset:32768
    ds_read_b64_tr_b16 v[42:43], v22 offset:33280
    ds_read_b128 v[188:191], v17 offset:34816
    s_waitcnt lgkmcnt(15)
    s_add_u32 m0, s68, 101376
    s_nop 0
    buffer_load_dwordx4 v5, s[8:11], s75 offen lds
    s_add_u32 s66, s66, 128
    s_add_u32 s75, s75, 128
    v_mfma_f32_16x16x32_bf16 v[76:79], v[44:47], v[160:163], v[76:79]
    v_mfma_f32_16x16x32_bf16 v[92:95], v[44:47], v[164:167], v[92:95]
    ds_read_b64_tr_b16 v[44:45], v23 offset:32768
    ds_read_b64_tr_b16 v[46:47], v23 offset:33280
    s_waitcnt lgkmcnt(15)
    s_add_u32 m0, s69, 98304
    s_nop 0
    buffer_load_dwordx4 v2, s[12:15], s67 offen lds
    v_mfma_f32_16x16x32_bf16 v[64:67], v[48:51], v[168:171], v[64:67]
    v_mfma_f32_16x16x32_bf16 v[80:83], v[48:51], v[172:175], v[80:83]
    ds_read_b64_tr_b16 v[48:49], v20 offset:40960
    ds_read_b64_tr_b16 v[50:51], v20 offset:41472
    s_waitcnt lgkmcnt(15)
    v_mfma_f32_16x16x32_bf16 v[68:71], v[52:55], v[168:171], v[68:71]
    v_mfma_f32_16x16x32_bf16 v[84:87], v[52:55], v[172:175], v[84:87]
    ds_read_b64_tr_b16 v[52:53], v21 offset:40960
    ds_read_b64_tr_b16 v[54:55], v21 offset:41472
    s_waitcnt lgkmcnt(15)
    s_add_u32 m0, s69, 99328
    s_nop 0
    buffer_load_dwordx4 v3, s[12:15], s67 offen lds
    v_mfma_f32_16x16x32_bf16 v[72:75], v[56:59], v[168:171], v[72:75]
    v_mfma_f32_16x16x32_bf16 v[88:91], v[56:59], v[172:175], v[88:91]
    ds_read_b64_tr_b16 v[56:57], v22 offset:40960
    ds_read_b64_tr_b16 v[58:59], v22 offset:41472
    s_waitcnt lgkmcnt(15)
    s_add_u32 m0, s69, 100352
    s_nop 0
    buffer_load_dwordx4 v2, s[12:15], s76 offen lds
    v_mfma_f32_16x16x32_bf16 v[76:79], v[60:63], v[168:171], v[76:79]
    v_mfma_f32_16x16x32_bf16 v[92:95], v[60:63], v[172:175], v[92:95]
    ds_read_b64_tr_b16 v[60:61], v23 offset:40960
    ds_read_b64_tr_b16 v[62:63], v23 offset:41472
    s_add_u32 m0, s69, 101376
    s_nop 0
    buffer_load_dwordx4 v3, s[12:15], s76 offen lds
    s_add_u32 s67, s67, s70
    s_add_u32 s76, s76, s70
    s_waitcnt vmcnt(8)
    s_barrier
    ds_read_b128 v[192:195], v18 offset:0
    s_waitcnt lgkmcnt(15)
    s_add_u32 m0, s68, 0
    s_nop 0
    buffer_load_dwordx4 v4, s[8:11], s66 offen lds
    v_mfma_f32_16x16x32_bf16 v[64:67], v[32:35], v[176:179], v[64:67]
    v_mfma_f32_16x16x32_bf16 v[80:83], v[32:35], v[180:183], v[80:83]
    ds_read_b64_tr_b16 v[32:33], v24 offset:0
    ds_read_b64_tr_b16 v[34:35], v24 offset:512
    ds_read_b128 v[196:199], v18 offset:2048
    s_waitcnt lgkmcnt(15)
    s_add_u32 m0, s68, 1024
    s_nop 0
    buffer_load_dwordx4 v5, s[8:11], s66 offen lds
    v_mfma_f32_16x16x32_bf16 v[68:71], v[36:39], v[176:179], v[68:71]
    v_mfma_f32_16x16x32_bf16 v[84:87], v[36:39], v[180:183], v[84:87]
    ds_read_b64_tr_b16 v[36:37], v25 offset:0
    ds_read_b64_tr_b16 v[38:39], v25 offset:512
    ds_read_b128 v[200:203], v19 offset:0
    s_waitcnt lgkmcnt(15)
    s_add_u32 m0, s68, 2048
    s_nop 0
    buffer_load_dwordx4 v4, s[8:11], s75 offen lds
    v_mfma_f32_16x16x32_bf16 v[72:75], v[40:43], v[176:179], v[72:75]
    v_mfma_f32_16x16x32_bf16 v[88:91], v[40:43], v[180:183], v[88:91]
    ds_read_b64_tr_b16 v[40:41], v26 offset:0
    ds_read_b64_tr_b16 v[42:43], v26 offset:512
    ds_read_b128 v[204:207], v19 offset:2048
    s_waitcnt lgkmcnt(15)
    s_add_u32 m0, s68, 3072
    s_nop 0
    buffer_load_dwordx4 v5, s[8:11], s75 offen lds
    s_add_u32 s66, s66, 128
    s_add_u32 s75, s75, 128
    v_mfma_f32_16x16x32_bf16 v[76:79], v[44:47], v[176:179], v[76:79]
    v_mfma_f32_16x16x32_bf16 v[92:95], v[44:47], v[180:183], v[92:95]
    ds_read_b64_tr_b16 v[44:45], v27 offset:0
    ds_read_b64_tr_b16 v[46:47], v27 offset:512
    s_waitcnt lgkmcnt(15)
    s_add_u32 m0, s69, 0
    s_nop 0
    buffer_load_dwordx4 v2, s[12:15], s67 offen lds
    v_mfma_f32_16x16x32_bf16 v[64:67], v[48:51], v[184:187], v[64:67]
    v_mfma_f32_16x16x32_bf16 v[80:83], v[48:51], v[188:191], v[80:83]
    ds_read_b64_tr_b16 v[48:49], v24 offset:8192
    ds_read_b64_tr_b16 v[50:51], v24 offset:8704
    s_waitcnt lgkmcnt(15)
    v_mfma_f32_16x16x32_bf16 v[68:71], v[52:55], v[184:187], v[68:71]
    v_mfma_f32_16x16x32_bf16 v[84:87], v[52:55], v[188:191], v[84:87]
    ds_read_b64_tr_b16 v[52:53], v25 offset:8192
    ds_read_b64_tr_b16 v[54:55], v25 offset:8704
    s_waitcnt lgkmcnt(15)
    s_add_u32 m0, s69, 1024
    s_nop 0
    buffer_load_dwordx4 v3, s[12:15], s67 offen lds
    v_mfma_f32_16x16x32_bf16 v[72:75], v[56:59], v[184:187], v[72:75]
    v_mfma_f32_16x16x32_bf16 v[88:91], v[56:59], v[188:191], v[88:91]
    ds_read_b64_tr_b16 v[56:57], v26 offset:8192
    ds_read_b64_tr_b16 v[58:59], v26 offset:8704
    s_waitcnt lgkmcnt(15)
    s_add_u32 m0, s69, 2048
    s_nop 0
    buffer_load_dwordx4 v2, s[12:15], s76 offen lds
    v_mfma_f32_16x16x32_bf16 v[76:79], v[60:63], v[184:187], v[76:79]
    v_mfma_f32_16x16x32_bf16 v[92:95], v[60:63], v[188:191], v[92:95]
    ds_read_b64_tr_b16 v[60:61], v27 offset:8192
    ds_read_b64_tr_b16 v[62:63], v27 offset:8704
    s_add_u32 m0, s69, 3072
    s_nop 0
    buffer_load_dwordx4 v3, s[12:15], s76 offen lds
    s_add_u32 s67, s67, s70
    s_add_u32 s76, s76, s70
    s_waitcnt vmcnt(8)
    s_barrier
    ds_read_b128 v[208:211], v18 offset:32768
    s_waitcnt lgkmcnt(15)
    s_add_u32 m0, s68, 32768
    s_nop 0
    buffer_load_dwordx4 v4, s[8:11], s66 offen lds
    v_mfma_f32_16x16x32_bf16 v[64:67], v[32:35], v[192:195], v[64:67]
    v_mfma_f32_16x16x32_bf16 v[80:83], v[32:35], v[196:199], v[80:83]
    ds_read_b64_tr_b16 v[32:33], v24 offset:32768
    ds_read_b64_tr_b16 v[34:35], v24 offset:33280
    ds_read_b128 v[212:215], v18 offset:34816
    s_waitcnt lgkmcnt(15)
    s_add_u32 m0, s68, 33792
    s_nop 0
    buffer_load_dwordx4 v5, s[8:11], s66 offen lds
    v_mfma_f32_16x16x32_bf16 v[68:71], v[36:39], v[192:195], v[68:71]
    v_mfma_f32_16x16x32_bf16 v[84:87], v[36:39], v[196:199], v[84:87]
    ds_read_b64_tr_b16 v[36:37], v25 offset:32768
    ds_read_b64_tr_b16 v[38:39], v25 offset:33280
    ds_read_b128 v[216:219], v19 offset:32768
    s_waitcnt lgkmcnt(15)
    s_add_u32 m0, s68, 34816
    s_nop 0
    buffer_load_dwordx4 v4, s[8:11], s75 offen lds
    v_mfma_f32_16x16x32_bf16 v[72:75], v[40:43], v[192:195], v[72:75]
    v_mfma_f32_16x16x32_bf16 v[88:91], v[40:43], v[196:199], v[88:91]
    ds_read_b64_tr_b16 v[40:41], v26 offset:32768
    ds_read_b64_tr_b16 v[42:43], v26 offset:33280
    ds_read_b128 v[220:223], v19 offset:34816
    s_waitcnt lgkmcnt(15)
    s_add_u32 m0, s68, 35840
    s_nop 0
    buffer_load_dwordx4 v5, s[8:11], s75 offen lds
    s_add_u32 s66, s66, 128
    s_add_u32 s75, s75, 128
    v_mfma_f32_16x16x32_bf16 v[76:79], v[44:47], v[192:195], v[76:79]
    v_mfma_f32_16x16x32_bf16 v[92:95], v[44:47], v[196:199], v[92:95]
    ds_read_b64_tr_b16 v[44:45], v27 offset:32768
    ds_read_b64_tr_b16 v[46:47], v27 offset:33280
    s_waitcnt lgkmcnt(15)
    s_add_u32 m0, s69, 32768
    s_nop 0
    buffer_load_dwordx4 v2, s[12:15], s67 offen lds
    v_mfma_f32_16x16x32_bf16 v[64:67], v[48:51], v[200:203], v[64:67]
    v_mfma_f32_16x16x32_bf16 v[80:83], v[48:51], v[204:207], v[80:83]
    ds_read_b64_tr_b16 v[48:49], v24 offset:40960
    ds_read_b64_tr_b16 v[50:51], v24 offset:41472
    s_waitcnt lgkmcnt(15)
    v_mfma_f32_16x16x32_bf16 v[68:71], v[52:55], v[200:203], v[68:71]
    v_mfma_f32_16x16x32_bf16 v[84:87], v[52:55], v[204:207], v[84:87]
    ds_read_b64_tr_b16 v[52:53], v25 offset:40960
    ds_read_b64_tr_b16 v[54:55], v25 offset:41472
    s_waitcnt lgkmcnt(15)
    s_add_u32 m0, s69, 33792
    s_nop 0
    buffer_load_dwordx4 v3, s[12:15], s67 offen lds
    v_mfma_f32_16x16x32_bf16 v[72:75], v[56:59], v[200:203], v[72:75]
    v_mfma_f32_16x16x32_bf16 v[88:91], v[56:59], v[204:207], v[88:91]
    ds_read_b64_tr_b16 v[56:57], v26 offset:40960
    ds_read_b64_tr_b16 v[58:59], v26 offset:41472
    s_waitcnt lgkmcnt(15)
    s_add_u32 m0, s69, 34816
    s_nop 0
    buffer_load_dwordx4 v2, s[12:15], s76 offen lds
    v_mfma_f32_16x16x32_bf16 v[76:79], v[60:63], v[200:203], v[76:79]
    v_mfma_f32_16x16x32_bf16 v[92:95], v[60:63], v[204:207], v[92:95]
    ds_read_b64_tr_b16 v[60:61], v27 offset:40960
    ds_read_b64_tr_b16 v[62:63], v27 offset:41472
    s_add_u32 m0, s69, 35840
    s_nop 0
    buffer_load_dwordx4 v3, s[12:15], s76 offen lds
    s_add_u32 s67, s67, s70
    s_add_u32 s76, s76, s70
    s_waitcnt vmcnt(8)
    s_barrier
    s_cmp_lg_u32 s3, 0
    s_cbranch_scc1 L_ten
    v_mov_b32 v14, 0
    buffer_load_dwordx2 v[14:15], v14, s[88:91], 0 offen sc1
L_ten:
    ds_read_b128 v[224:227], v16 offset:0
    s_waitcnt lgkmcnt(15)
    s_add_u32 m0, s72, 65536
    s_nop 0
    buffer_load_dwordx4 v11, s[16:19], s71 offen lds
    v_mfma_f32_16x16x32_bf16 v[64:67], v[32:35], v[208:211], v[64:67]
    v_mfma_f32_16x16x32_bf16 v[80:83], v[32:35], v[212:215], v[80:83]
    ds_read_b64_tr_b16 v[32:33], v20 offset:0
    ds_read_b64_tr_b16 v[34:35], v20 offset:512
    ds_read_b128 v[228:231], v16 offset:2048
    s_waitcnt lgkmcnt(15)
    v_mfma_f32_16x16x32_bf16 v[68:71], v[36:39], v[208:211], v[68:71]
    v_mfma_f32_16x16x32_bf16 v[84:87], v[36:39], v[212:215], v[84:87]
    ds_read_b64_tr_b16 v[36:37], v21 offset:0
    ds_read_b64_tr_b16 v[38:39], v21 offset:512
    ds_read_b128 v[232:235], v17 offset:0
    s_waitcnt lgkmcnt(15)
    s_add_u32 m0, s72, 66560
    s_nop 0
    buffer_load_dwordx4 v12, s[16:19], s71 offen lds
    v_mfma_f32_16x16x32_bf16 v[72:75], v[40:43], v[208:211], v[72:75]
    v_mfma_f32_16x16x32_bf16 v[88:91], v[40:43], v[212:215], v[88:91]
    ds_read_b64_tr_b16 v[40:41], v22 offset:0
    ds_read_b64_tr_b16 v[42:43], v22 offset:512
    ds_read_b128 v[236:239], v17 offset:2048
    s_waitcnt lgkmcnt(15)
    v_mfma_f32_16x16x32_bf16 v[76:79], v[44:47], v[208:211], v[76:79]
    v_mfma_f32_16x16x32_bf16 v[92:95], v[44:47], v[212:215], v[92:95]
    ds_read_b64_tr_b16 v[44:45], v23 offset:0
    ds_read_b64_tr_b16 v[46:47], v23 offset:512
    s_waitcnt lgkmcnt(15)
    s_add_u32 m0, s72, 67584
    s_nop 0
    buffer_load_dwordx4 v13, s[16:19], s71 offen lds
    s_add_u32 s71, s71, 393216
    v_mfma_f32_16x16x32_bf16 v[64:67], v[48:51], v[216:219], v[64:67]
    v_mfma_f32_16x16x32_bf16 v[80:83], v[48:51], v[220:223], v[80:83]
    ds_read_b64_tr_b16 v[48:49], v20 offset:8192
    ds_read_b64_tr_b16 v[50:51], v20 offset:8704
    s_waitcnt lgkmcnt(15)
    v_mfma_f32_16x16x32_bf16 v[68:71], v[52:55], v[216:219], v[68:71]
    v_mfma_f32_16x16x32_bf16 v[84:87], v[52:55], v[220:223], v[84:87]
    ds_read_b64_tr_b16 v[52:53], v21 offset:8192
    ds_read_b64_tr_b16 v[54:55], v21 offset:8704
    s_waitcnt lgkmcnt(15)
    v_mfma_f32_16x16x32_bf16 v[72:75], v[56:59], v[216:219], v[72:75]
    v_mfma_f32_16x16x32_bf16 v[88:91], v[56:59], v[220:223], v[88:91]
    ds_read_b64_tr_b16 v[56:57], v22 offset:8192
    ds_read_b64_tr_b16 v[58:59], v22 offset:8704
    s_waitcnt lgkmcnt(15)
    v_mfma_f32_16x16x32_bf16 v[76:79], v[60:63], v[216:219], v[76:79]
    v_mfma_f32_16x16x32_bf16 v[92:95], v[60:63], v[220:223], v[92:95]
    ds_read_b64_tr_b16 v[60:61], v23 offset:8192
    ds_read_b64_tr_b16 v[62:63], v23 offset:8704
    s_waitcnt vmcnt(3)
    s_barrier
    ds_read_b128 v[240:243], v16 offset:32768
    s_waitcnt lgkmcnt(15)
    s_add_u32 m0, s72, 98304
    s_nop 0
    buffer_load_dwordx4 v11, s[16:19], s71 offen lds
    v_mfma_f32_16x16x32_bf16 v[64:67], v[32:35], v[224:227], v[64:67]
    v_mfma_f32_16x16x32_bf16 v[80:83], v[32:35], v[228:231], v[80:83]
    ds_read_b64_tr_b16 v[32:33], v20 offset:32768
    ds_read_b64_tr_b16 v[34:35], v20 offset:33280
    ds_read_b128 v[244:247], v16 offset:34816
    s_waitcnt lgkmcnt(15)
    v_mfma_f32_16x16x32_bf16 v[68:71], v[36:39], v[224:227], v[68:71]
    v_mfma_f32_16x16x32_bf16 v[84:87], v[36:39], v[228:231], v[84:87]
    ds_read_b64_tr_b16 v[36:37], v21 offset:32768
    ds_read_b64_tr_b16 v[38:39], v21 offset:33280
    ds_read_b128 v[248:251], v17 offset:32768
    s_waitcnt lgkmcnt(15)
    s_add_u32 m0, s72, 99328
    s_nop 0
    buffer_load_dwordx4 v12, s[16:19], s71 offen lds
    v_mfma_f32_16x16x32_bf16 v[72:75], v[40:43], v[224:227], v[72:75]
    v_mfma_f32_16x16x32_bf16 v[88:91], v[40:43], v[228:231], v[88:91]
    ds_read_b64_tr_b16 v[40:41], v22 offset:32768
    ds_read_b64_tr_b16 v[42:43], v22 offset:33280
    ds_read_b128 v[252:255], v17 offset:34816
    s_waitcnt lgkmcnt(15)
    v_mfma_f32_16x16x32_bf16 v[76:79], v[44:47], v[224:227], v[76:79]
    v_mfma_f32_16x16x32_bf16 v[92:95], v[44:47], v[228:231], v[92:95]
    ds_read_b64_tr_b16 v[44:45], v23 offset:32768
    ds_read_b64_tr_b16 v[46:47], v23 offset:33280
    s_waitcnt lgkmcnt(15)
    s_add_u32 m0, s72, 100352
    s_nop 0
    buffer_load_dwordx4 v13, s[16:19], s71 offen lds
    s_add_u32 s71, s71, 393216
    v_mfma_f32_16x16x32_bf16 v[64:67], v[48:51], v[232:235], v[64:67]
    v_mfma_f32_16x16x32_bf16 v[80:83], v[48:51], v[236:239], v[80:83]
    ds_read_b64_tr_b16 v[48:49], v20 offset:40960
    ds_read_b64_tr_b16 v[50:51], v20 offset:41472
    s_waitcnt lgkmcnt(15)
    v_mfma_f32_16x16x32_bf16 v[68:71], v[52:55], v[232:235], v[68:71]
    v_mfma_f32_16x16x32_bf16 v[84:87], v[52:55], v[236:239], v[84:87]
    ds_read_b64_tr_b16 v[52:53], v21 offset:40960
    ds_read_b64_tr_b16 v[54:55], v21 offset:41472
    s_waitcnt lgkmcnt(15)
    v_mfma_f32_16x16x32_bf16 v[72:75], v[56:59], v[232:235], v[72:75]
    v_mfma_f32_16x16x32_bf16 v[88:91], v[56:59], v[236:239], v[88:91]
    ds_read_b64_tr_b16 v[56:57], v22 offset:40960
    ds_read_b64_tr_b16 v[58:59], v22 offset:41472
    s_waitcnt lgkmcnt(15)
    v_mfma_f32_16x16x32_bf16 v[76:79], v[60:63], v[232:235], v[76:79]
    v_mfma_f32_16x16x32_bf16 v[92:95], v[60:63], v[236:239], v[92:95]
    ds_read_b64_tr_b16 v[60:61], v23 offset:40960
    ds_read_b64_tr_b16 v[62:63], v23 offset:41472
    s_waitcnt lgkmcnt(0)
    s_barrier
    s_waitcnt lgkmcnt(15)
    s_add_u32 m0, s72, 0
    s_nop 0
    buffer_load_dwordx4 v11, s[16:19], s71 offen lds
    v_mfma_f32_16x16x32_bf16 v[64:67], v[32:35], v[240:243], v[64:67]
    v_mfma_f32_16x16x32_bf16 v[80:83], v[32:35], v[244:247], v[80:83]
    s_waitcnt lgkmcnt(14)
    v_mfma_f32_16x16x32_bf16 v[68:71], v[36:39], v[240:243], v[68:71]
    v_mfma_f32_16x16x32_bf16 v[84:87], v[36:39], v[244:247], v[84:87]
    s_waitcnt lgkmcnt(11)
    s_add_u32 m0, s72, 1024
    s_nop 0
    buffer_load_dwordx4 v12, s[16:19], s71 offen lds
    v_mfma_f32_16x16x32_bf16 v[72:75], v[40:43], v[240:243], v[72:75]
    v_mfma_f32_16x16x32_bf16 v[88:91], v[40:43], v[244:247], v[88:91]
    s_waitcnt lgkmcnt(8)
    v_mfma_f32_16x16x32_bf16 v[76:79], v[44:47], v[240:243], v[76:79]
    v_mfma_f32_16x16x32_bf16 v[92:95], v[44:47], v[244:247], v[92:95]
    s_waitcnt lgkmcnt(6)
    s_add_u32 m0, s72, 2048
    s_nop 0
    buffer_load_dwordx4 v13, s[16:19], s71 offen lds
    s_add_u32 s71, s71, 393216
    v_mfma_f32_16x16x32_bf16 v[64:67], v[48:51], v[248:251], v[64:67]
    v_mfma_f32_16x16x32_bf16 v[80:83], v[48:51], v[252:255], v[80:83]
    s_waitcnt lgkmcnt(4)
    v_mfma_f32_16x16x32_bf16 v[68:71], v[52:55], v[248:251], v[68:71]
    v_mfma_f32_16x16x32_bf16 v[84:87], v[52:55], v[252:255], v[84:87]
    s_waitcnt lgkmcnt(2)
    v_mfma_f32_16x16x32_bf16 v[72:75], v[56:59], v[248:251], v[72:75]
    v_mfma_f32_16x16x32_bf16 v[88:91], v[56:59], v[252:255], v[88:91]
    s_waitcnt lgkmcnt(0)
    v_mfma_f32_16x16x32_bf16 v[76:79], v[60:63], v[248:251], v[76:79]
    v_mfma_f32_16x16x32_bf16 v[92:95], v[60:63], v[252:255], v[92:95]
    s_branch L_AEPI
L_AHI:
    s_barrier
    ds_read_b128 v[96:99], v16 offset:0
    ds_read_b128 v[100:103], v16 offset:2048
    ds_read_b128 v[104:107], v17 offset:0
    ds_read_b128 v[108:111], v17 offset:2048
    ds_read_b64_tr_b16 v[32:33], v20 offset:0
    ds_read_b64_tr_b16 v[34:35], v20 offset:512
    ds_read_b64_tr_b16 v[36:37], v21 offset:0
    ds_read_b64_tr_b16 v[38:39], v21 offset:512
    ds_read_b64_tr_b16 v[40:41], v22 offset:0
    ds_read_b64_tr_b16 v[42:43], v22 offset:512
    ds_read_b64_tr_b16 v[44:45], v23 offset:0
    ds_read_b64_tr_b16 v[46:47], v23 offset:512
    ds_read_b64_tr_b16 v[48:49], v20 offset:8192
    ds_read_b64_tr_b16 v[50:51], v20 offset:8704
    ds_read_b64_tr_b16 v[52:53], v21 offset:8192
    ds_read_b64_tr_b16 v[54:55], v21 offset:8704
    ds_read_b64_tr_b16 v[56:57], v22 offset:8192
    ds_read_b64_tr_b16 v[58:59], v22 offset:8704
    ds_read_b64_tr_b16 v[60:61], v23 offset:8192
    ds_read_b64_tr_b16 v[62:63], v23 offset:8704
    s_barrier
    s_cmp_lg_u32 s3, 6
    s_cbranch_scc1 L_thw0
    s_mov_b32 s73, 983040
    buffer_load_dword v255, v10, s[12:15], s73 offen
L_thw0:
    ds_read_b128 v[112:115], v16 offset:32768
    s_waitcnt lgkmcnt(15)
    v_mfma_f32_16x16x32_bf16 v[64:67], v[32:35], v[96:99], v[64:67]
    v_mfma_f32_16x16x32_bf16 v[80:83], v[32:35], v[100:103], v[80:83]
    ds_read_b64_tr_b16 v[32:33], v20 offset:32768
    ds_read_b64_tr_b16 v[34:35], v20 offset:33280
    ds_read_b128 v[116:119], v16 offset:34816
    s_waitcnt lgkmcnt(15)
    v_mfma_f32_16x16x32_bf16 v[68:71], v[36:39], v[96:99], v[68:71]
    v_mfma_f32_16x16x32_bf16 v[84:87], v[36:39], v[100:103], v[84:87]
    ds_read_b64_tr_b16 v[36:37], v21 offset:32768
    ds_read_b64_tr_b16 v[38:39], v21 offset:33280
    ds_read_b128 v[120:123], v17 offset:32768
    s_waitcnt lgkmcnt(15)
    v_mfma_f32_16x16x32_bf16 v[72:75], v[40:43], v[96:99], v[72:75]
    v_mfma_f32_16x16x32_bf16 v[88:91], v[40:43], v[100:103], v[88:91]
    ds_read_b64_tr_b16 v[40:41], v22 offset:32768
    ds_read_b64_tr_b16 v[42:43], v22 offset:33280
    ds_read_b128 v[124:127], v17 offset:34816
    s_waitcnt lgkmcnt(15)
    v_mfma_f32_16x16x32_bf16 v[76:79], v[44:47], v[96:99], v[76:79]
    v_mfma_f32_16x16x32_bf16 v[92:95], v[44:47], v[100:103], v[92:95]
    ds_read_b64_tr_b16 v[44:45], v23 offset:32768
    ds_read_b64_tr_b16 v[46:47], v23 offset:33280
    s_waitcnt lgkmcnt(15)
    v_mfma_f32_16x16x32_bf16 v[64:67], v[48:51], v[104:107], v[64:67]
    v_mfma_f32_16x16x32_bf16 v[80:83], v[48:51], v[108:111], v[80:83]
    ds_read_b64_tr_b16 v[48:49], v20 offset:40960
    ds_read_b64_tr_b16 v[50:51], v20 offset:41472
    s_waitcnt lgkmcnt(15)
    v_mfma_f32_16x16x32_bf16 v[68:71], v[52:55], v[104:107], v[68:71]
    v_mfma_f32_16x16x32_bf16 v[84:87], v[52:55], v[108:111], v[84:87]
    ds_read_b64_tr_b16 v[52:53], v21 offset:40960
    ds_read_b64_tr_b16 v[54:55], v21 offset:41472
    s_waitcnt lgkmcnt(15)
    v_mfma_f32_16x16x32_bf16 v[72:75], v[56:59], v[104:107], v[72:75]
    v_mfma_f32_16x16x32_bf16 v[88:91], v[56:59], v[108:111], v[88:91]
    ds_read_b64_tr_b16 v[56:57], v22 offset:40960
    ds_read_b64_tr_b16 v[58:59], v22 offset:41472
    s_waitcnt lgkmcnt(15)
    v_mfma_f32_16x16x32_bf16 v[76:79], v[60:63], v[104:107], v[76:79]
    v_mfma_f32_16x16x32_bf16 v[92:95], v[60:63], v[108:111], v[92:95]
    ds_read_b64_tr_b16 v[60:61], v23 offset:40960
    ds_read_b64_tr_b16 v[62:63], v23 offset:41472
    s_barrier
    ds_read_b128 v[128:131], v18 offset:0
    s_waitcnt lgkmcnt(15)
    s_add_u32 m0, s72, 131072
    s_nop 0
    buffer_load_dwordx4 v11, s[16:19], s71 offen lds
    v_mfma_f32_16x16x32_bf16 v[64:67], v[32:35], v[112:115], v[64:67]
    v_mfma_f32_16x16x32_bf16 v[80:83], v[32:35], v[116:119], v[80:83]
    ds_read_b64_tr_b16 v[32:33], v24 offset:0
    ds_read_b64_tr_b16 v[34:35], v24 offset:512
    ds_read_b128 v[132:135], v18 offset:2048
    s_waitcnt lgkmcnt(15)
    v_mfma_f32_16x16x32_bf16 v[68:71], v[36:39], v[112:115], v[68:71]
    v_mfma_f32_16x16x32_bf16 v[84:87], v[36:39], v[116:119], v[84:87]
    ds_read_b64_tr_b16 v[36:37], v25 offset:0
    ds_read_b64_tr_b16 v[38:39], v25 offset:512
    ds_read_b128 v[136:139], v19 offset:0
    s_waitcnt lgkmcnt(15)
    s_add_u32 m0, s72, 132096
    s_nop 0
    buffer_load_dwordx4 v12, s[16:19], s71 offen lds
    v_mfma_f32_16x16x32_bf16 v[72:75], v[40:43], v[112:115], v[72:75]
    v_mfma_f32_16x16x32_bf16 v[88:91], v[40:43], v[116:119], v[88:91]
    ds_read_b64_tr_b16 v[40:41], v26 offset:0
    ds_read_b64_tr_b16 v[42:43], v26 offset:512
    ds_read_b128 v[140:143], v19 offset:2048
    s_waitcnt lgkmcnt(15)
    v_mfma_f32_16x16x32_bf16 v[76:79], v[44:47], v[112:115], v[76:79]
    v_mfma_f32_16x16x32_bf16 v[92:95], v[44:47], v[116:119], v[92:95]
    ds_read_b64_tr_b16 v[44:45], v27 offset:0
    ds_read_b64_tr_b16 v[46:47], v27 offset:512
    s_waitcnt lgkmcnt(15)
    s_add_u32 m0, s72, 133120
    s_nop 0
    buffer_load_dwordx4 v13, s[16:19], s71 offen lds
    s_add_u32 s71, s71, 393216
    v_mfma_f32_16x16x32_bf16 v[64:67], v[48:51], v[120:123], v[64:67]
    v_mfma_f32_16x16x32_bf16 v[80:83], v[48:51], v[124:127], v[80:83]
    ds_read_b64_tr_b16 v[48:49], v24 offset:8192
    ds_read_b64_tr_b16 v[50:51], v24 offset:8704
    s_waitcnt lgkmcnt(15)
    v_mfma_f32_16x16x32_bf16 v[68:71], v[52:55], v[120:123], v[68:71]
    v_mfma_f32_16x16x32_bf16 v[84:87], v[52:55], v[124:127], v[84:87]
    ds_read_b64_tr_b16 v[52:53], v25 offset:8192
    ds_read_b64_tr_b16 v[54:55], v25 offset:8704
    s_waitcnt lgkmcnt(15)
    v_mfma_f32_16x16x32_bf16 v[72:75], v[56:59], v[120:123], v[72:75]
    v_mfma_f32_16x16x32_bf16 v[88:91], v[56:59], v[124:127], v[88:91]
    ds_read_b64_tr_b16 v[56:57], v26 offset:8192
    ds_read_b64_tr_b16 v[58:59], v26 offset:8704
    s_waitcnt lgkmcnt(15)
    v_mfma_f32_16x16x32_bf16 v[76:79], v[60:63], v[120:123], v[76:79]
    v_mfma_f32_16x16x32_bf16 v[92:95], v[60:63], v[124:127], v[92:95]
    ds_read_b64_tr_b16 v[60:61], v27 offset:8192
    ds_read_b64_tr_b16 v[62:63], v27 offset:8704
    s_barrier
    s_cmp_lg_u32 s3, 6
    s_cbranch_scc1 L_thw1
    s_mov_b32 s73, 1966080
    buffer_load_dword v255, v10, s[12:15], s73 offen
L_thw1:
    ds_read_b128 v[144:147], v18 offset:32768
    s_waitcnt lgkmcnt(15)
    v_mfma_f32_16x16x32_bf16 v[64:67], v[32:35], v[128:131], v[64:67]
    v_mfma_f32_16x16x32_bf16 v[80:83], v[32:35], v[132:135], v[80:83]
    ds_read_b64_tr_b16 v[32:33], v24 offset:32768
    ds_read_b64_tr_b16 v[34:35], v24 offset:33280
    ds_read_b128 v[148:151], v18 offset:34816
    s_waitcnt lgkmcnt(15)
    v_mfma_f32_16x16x32_bf16 v[68:71], v[36:39], v[128:131], v[68:71]
    v_mfma_f32_16x16x32_bf16 v[84:87], v[36:39], v[132:135], v[84:87]
    ds_read_b64_tr_b16 v[36:37], v25 offset:32768
    ds_read_b64_tr_b16 v[38:39], v25 offset:33280
    ds_read_b128 v[152:155], v19 offset:32768
    s_waitcnt lgkmcnt(15)
    v_mfma_f32_16x16x32_bf16 v[72:75], v[40:43], v[128:131], v[72:75]
    v_mfma_f32_16x16x32_bf16 v[88:91], v[40:43], v[132:135], v[88:91]
    ds_read_b64_tr_b16 v[40:41], v26 offset:32768
    ds_read_b64_tr_b16 v[42:43], v26 offset:33280
    ds_read_b128 v[156:159], v19 offset:34816
    s_waitcnt lgkmcnt(15)
    v_mfma_f32_16x16x32_bf16 v[76:79], v[44:47], v[128:131], v[76:79]
    v_mfma_f32_16x16x32_bf16 v[92:95], v[44:47], v[132:135], v[92:95]
    ds_read_b64_tr_b16 v[44:45], v27 offset:32768
    ds_read_b64_tr_b16 v[46:47], v27 offset:33280
    s_waitcnt lgkmcnt(15)
    v_mfma_f32_16x16x32_bf16 v[64:67], v[48:51], v[136:139], v[64:67]
    v_mfma_f32_16x16x32_bf16 v[80:83], v[48:51], v[140:143], v[80:83]
    ds_read_b64_tr_b16 v[48:49], v24 offset:40960
    ds_read_b64_tr_b16 v[50:51], v24 offset:41472
    s_waitcnt lgkmcnt(15)
    v_mfma_f32_16x16x32_bf16 v[68:71], v[52:55], v[136:139], v[68:71]
    v_mfma_f32_16x16x32_bf16 v[84:87], v[52:55], v[140:143], v[84:87]
    ds_read_b64_tr_b16 v[52:53], v25 offset:40960
    ds_read_b64_tr_b16 v[54:55], v25 offset:41472
    s_waitcnt lgkmcnt(15)
    v_mfma_f32_16x16x32_bf16 v[72:75], v[56:59], v[136:139], v[72:75]
    v_mfma_f32_16x16x32_bf16 v[88:91], v[56:59], v[140:143], v[88:91]
    ds_read_b64_tr_b16 v[56:57], v26 offset:40960
    ds_read_b64_tr_b16 v[58:59], v26 offset:41472
    s_waitcnt lgkmcnt(15)
    v_mfma_f32_16x16x32_bf16 v[76:79], v[60:63], v[136:139], v[76:79]
    v_mfma_f32_16x16x32_bf16 v[92:95], v[60:63], v[140:143], v[92:95]
    ds_read_b64_tr_b16 v[60:61], v27 offset:40960
    ds_read_b64_tr_b16 v[62:63], v27 offset:41472
    s_barrier
    s_cmp_lg_u32 s3, 4
    s_cbranch_scc1 L_thb0
    buffer_load_dword v255, v8, s[16:19], 0 offen
L_thb0:
    s_cmp_lg_u32 s3, 5
    s_cbranch_scc1 L_thb1
    buffer_load_dword v255, v8, s[16:19], 0 offen
L_thb1:
    ds_read_b128 v[160:163], v16 offset:0
    s_waitcnt lgkmcnt(15)
    v_mfma_f32_16x16x32_bf16 v[64:67], v[32:35], v[144:147], v[64:67]
    v_mfma_f32_16x16x32_bf16 v[80:83], v[32:35], v[148:151], v[80:83]
    ds_read_b64_tr_b16 v[32:33], v20 offset:0
    ds_read_b64_tr_b16 v[34:35], v20 offset:512
    ds_read_b128 v[164:167], v16 offset:2048
    s_waitcnt lgkmcnt(15)
    v_mfma_f32_16x16x32_bf16 v[68:71], v[36:39], v[144:147], v[68:71]
    v_mfma_f32_16x16x32_bf16 v[84:87], v[36:39], v[148:151], v[84:87]
    ds_read_b64_tr_b16 v[36:37], v21 offset:0
    ds_read_b64_tr_b16 v[38:39], v21 offset:512
    ds_read_b128 v[168:171], v17 offset:0
    s_waitcnt lgkmcnt(15)
    v_mfma_f32_16x16x32_bf16 v[72:75], v[40:43], v[144:147], v[72:75]
    v_mfma_f32_16x16x32_bf16 v[88:91], v[40:43], v[148:151], v[88:91]
    ds_read_b64_tr_b16 v[40:41], v22 offset:0
    ds_read_b64_tr_b16 v[42:43], v22 offset:512
    ds_read_b128 v[172:175], v17 offset:2048
    s_waitcnt lgkmcnt(15)
    v_mfma_f32_16x16x32_bf16 v[76:79], v[44:47], v[144:147], v[76:79]
    v_mfma_f32_16x16x32_bf16 v[92:95], v[44:47], v[148:151], v[92:95]
    ds_read_b64_tr_b16 v[44:45], v23 offset:0
    ds_read_b64_tr_b16 v[46:47], v23 offset:512
    s_waitcnt lgkmcnt(15)
    v_mfma_f32_16x16x32_bf16 v[64:67], v[48:51], v[152:155], v[64:67]
    v_mfma_f32_16x16x32_bf16 v[80:83], v[48:51], v[156:159], v[80:83]
    ds_read_b64_tr_b16 v[48:49], v20 offset:8192
    ds_read_b64_tr_b16 v[50:51], v20 offset:8704
    s_waitcnt lgkmcnt(15)
    v_mfma_f32_16x16x32_bf16 v[68:71], v[52:55], v[152:155], v[68:71]
    v_mfma_f32_16x16x32_bf16 v[84:87], v[52:55], v[156:159], v[84:87]
    ds_read_b64_tr_b16 v[52:53], v21 offset:8192
    ds_read_b64_tr_b16 v[54:55], v21 offset:8704
    s_waitcnt lgkmcnt(15)
    v_mfma_f32_16x16x32_bf16 v[72:75], v[56:59], v[152:155], v[72:75]
    v_mfma_f32_16x16x32_bf16 v[88:91], v[56:59], v[156:159], v[88:91]
    ds_read_b64_tr_b16 v[56:57], v22 offset:8192
    ds_read_b64_tr_b16 v[58:59], v22 offset:8704
    s_waitcnt lgkmcnt(15)
    v_mfma_f32_16x16x32_bf16 v[76:79], v[60:63], v[152:155], v[76:79]
    v_mfma_f32_16x16x32_bf16 v[92:95], v[60:63], v[156:159], v[92:95]
    ds_read_b64_tr_b16 v[60:61], v23 offset:8192
    ds_read_b64_tr_b16 v[62:63], v23 offset:8704
    s_barrier
    ds_read_b128 v[176:179], v16 offset:32768
    s_waitcnt lgkmcnt(15)
    v_mfma_f32_16x16x32_bf16 v[64:67], v[32:35], v[160:163], v[64:67]
    v_mfma_f32_16x16x32_bf16 v[80:83], v[32:35], v[164:167], v[80:83]
    ds_read_b64_tr_b16 v[32:33], v20 offset:32768
    ds_read_b64_tr_b16 v[34:35], v20 offset:33280
    ds_read_b128 v[180:183], v16 offset:34816
    s_waitcnt lgkmcnt(15)
    v_mfma_f32_16x16x32_bf16 v[68:71], v[36:39], v[160:163], v[68:71]
    v_mfma_f32_16x16x32_bf16 v[84:87], v[36:39], v[164:167], v[84:87]
    ds_read_b64_tr_b16 v[36:37], v21 offset:32768
    ds_read_b64_tr_b16 v[38:39], v21 offset:33280
    ds_read_b128 v[184:187], v17 offset:32768
    s_waitcnt lgkmcnt(15)
    v_mfma_f32_16x16x32_bf16 v[72:75], v[40:43], v[160:163], v[72:75]
    v_mfma_f32_16x16x32_bf16 v[88:91], v[40:43], v[164:167], v[88:91]
    ds_read_b64_tr_b16 v[40:41], v22 offset:32768
    ds_read_b64_tr_b16 v[42:43], v22 offset:33280
    ds_read_b128 v[188:191], v17 offset:34816
    s_waitcnt lgkmcnt(15)
    v_mfma_f32_16x16x32_bf16 v[76:79], v[44:47], v[160:163], v[76:79]
    v_mfma_f32_16x16x32_bf16 v[92:95], v[44:47], v[164:167], v[92:95]
    ds_read_b64_tr_b16 v[44:45], v23 offset:32768
    ds_read_b64_tr_b16 v[46:47], v23 offset:33280
    s_waitcnt lgkmcnt(15)
    v_mfma_f32_16x16x32_bf16 v[64:67], v[48:51], v[168:171], v[64:67]
    v_mfma_f32_16x16x32_bf16 v[80:83], v[48:51], v[172:175], v[80:83]
    ds_read_b64_tr_b16 v[48:49], v20 offset:40960
    ds_read_b64_tr_b16 v[50:51], v20 offset:41472
    s_waitcnt lgkmcnt(15)
    v_mfma_f32_16x16x32_bf16 v[68:71], v[52:55], v[168:171], v[68:71]
    v_mfma_f32_16x16x32_bf16 v[84:87], v[52:55], v[172:175], v[84:87]
    ds_read_b64_tr_b16 v[52:53], v21 offset:40960
    ds_read_b64_tr_b16 v[54:55], v21 offset:41472
    s_waitcnt lgkmcnt(15)
    v_mfma_f32_16x16x32_bf16 v[72:75], v[56:59], v[168:171], v[72:75]
    v_mfma_f32_16x16x32_bf16 v[88:91], v[56:59], v[172:175], v[88:91]
    ds_read_b64_tr_b16 v[56:57], v22 offset:40960
    ds_read_b64_tr_b16 v[58:59], v22 offset:41472
    s_waitcnt lgkmcnt(15)
    v_mfma_f32_16x16x32_bf16 v[76:79], v[60:63], v[168:171], v[76:79]
    v_mfma_f32_16x16x32_bf16 v[92:95], v[60:63], v[172:175], v[92:95]
    ds_read_b64_tr_b16 v[60:61], v23 offset:40960
    ds_read_b64_tr_b16 v[62:63], v23 offset:41472
    s_barrier
    ds_read_b128 v[192:195], v18 offset:0
    s_waitcnt lgkmcnt(15)
    v_mfma_f32_16x16x32_bf16 v[64:67], v[32:35], v[176:179], v[64:67]
    v_mfma_f32_16x16x32_bf16 v[80:83], v[32:35], v[180:183], v[80:83]
    ds_read_b64_tr_b16 v[32:33], v24 offset:0
    ds_read_b64_tr_b16 v[34:35], v24 offset:512
    ds_read_b128 v[196:199], v18 offset:2048
    s_waitcnt lgkmcnt(15)
    v_mfma_f32_16x16x32_bf16 v[68:71], v[36:39], v[176:179], v[68:71]
    v_mfma_f32_16x16x32_bf16 v[84:87], v[36:39], v[180:183], v[84:87]
    ds_read_b64_tr_b16 v[36:37], v25 offset:0
    ds_read_b64_tr_b16 v[38:39], v25 offset:512
    ds_read_b128 v[200:203], v19 offset:0
    s_waitcnt lgkmcnt(15)
    v_mfma_f32_16x16x32_bf16 v[72:75], v[40:43], v[176:179], v[72:75]
    v_mfma_f32_16x16x32_bf16 v[88:91], v[40:43], v[180:183], v[88:91]
    ds_read_b64_tr_b16 v[40:41], v26 offset:0
    ds_read_b64_tr_b16 v[42:43], v26 offset:512
    ds_read_b128 v[204:207], v19 offset:2048
    s_waitcnt lgkmcnt(15)
    v_mfma_f32_16x16x32_bf16 v[76:79], v[44:47], v[176:179], v[76:79]
    v_mfma_f32_16x16x32_bf16 v[92:95], v[44:47], v[180:183], v[92:95]
    ds_read_b64_tr_b16 v[44:45], v27 offset:0
    ds_read_b64_tr_b16 v[46:47], v27 offset:512
    s_waitcnt lgkmcnt(15)
    v_mfma_f32_16x16x32_bf16 v[64:67], v[48:51], v[184:187], v[64:67]
    v_mfma_f32_16x16x32_bf16 v[80:83], v[48:51], v[188:191], v[80:83]
    ds_read_b64_tr_b16 v[48:49], v24 offset:8192
    ds_read_b64_tr_b16 v[50:51], v24 offset:8704
    s_waitcnt lgkmcnt(15)
    v_mfma_f32_16x16x32_bf16 v[68:71], v[52:55], v[184:187], v[68:71]
    v_mfma_f32_16x16x32_bf16 v[84:87], v[52:55], v[188:191], v[84:87]
    ds_read_b64_tr_b16 v[52:53], v25 offset:8192
    ds_read_b64_tr_b16 v[54:55], v25 offset:8704
    s_waitcnt lgkmcnt(15)
    v_mfma_f32_16x16x32_bf16 v[72:75], v[56:59], v[184:187], v[72:75]
    v_mfma_f32_16x16x32_bf16 v[88:91], v[56:59], v[188:191], v[88:91]
    ds_read_b64_tr_b16 v[56:57], v26 offset:8192
    ds_read_b64_tr_b16 v[58:59], v26 offset:8704
    s_waitcnt lgkmcnt(15)
    v_mfma_f32_16x16x32_bf16 v[76:79], v[60:63], v[184:187], v[76:79]
    v_mfma_f32_16x16x32_bf16 v[92:95], v[60:63], v[188:191], v[92:95]
    ds_read_b64_tr_b16 v[60:61], v27 offset:8192
    ds_read_b64_tr_b16 v[62:63], v27 offset:8704
    s_barrier
    ds_read_b128 v[208:211], v18 offset:32768
    s_waitcnt lgkmcnt(15)
    v_mfma_f32_16x16x32_bf16 v[64:67], v[32:35], v[192:195], v[64:67]
    v_mfma_f32_16x16x32_bf16 v[80:83], v[32:35], v[196:199], v[80:83]
    ds_read_b64_tr_b16 v[32:33], v24 offset:32768
    ds_read_b64_tr_b16 v[34:35], v24 offset:33280
    ds_read_b128 v[212:215], v18 offset:34816
    s_waitcnt lgkmcnt(15)
    v_mfma_f32_16x16x32_bf16 v[68:71], v[36:39], v[192:195], v[68:71]
    v_mfma_f32_16x16x32_bf16 v[84:87], v[36:39], v[196:199], v[84:87]
    ds_read_b64_tr_b16 v[36:37], v25 offset:32768
    ds_read_b64_tr_b16 v[38:39], v25 offset:33280
    ds_read_b128 v[216:219], v19 offset:32768
    s_waitcnt lgkmcnt(15)
    v_mfma_f32_16x16x32_bf16 v[72:75], v[40:43], v[192:195], v[72:75]
    v_mfma_f32_16x16x32_bf16 v[88:91], v[40:43], v[196:199], v[88:91]
    ds_read_b64_tr_b16 v[40:41], v26 offset:32768
    ds_read_b64_tr_b16 v[42:43], v26 offset:33280
    ds_read_b128 v[220:223], v19 offset:34816
    s_waitcnt lgkmcnt(15)
    v_mfma_f32_16x16x32_bf16 v[76:79], v[44:47], v[192:195], v[76:79]
    v_mfma_f32_16x16x32_bf16 v[92:95], v[44:47], v[196:199], v[92:95]
    ds_read_b64_tr_b16 v[44:45], v27 offset:32768
    ds_read_b64_tr_b16 v[46:47], v27 offset:33280
    s_waitcnt lgkmcnt(15)
    v_mfma_f32_16x16x32_bf16 v[64:67], v[48:51], v[200:203], v[64:67]
    v_mfma_f32_16x16x32_bf16 v[80:83], v[48:51], v[204:207], v[80:83]
    ds_read_b64_tr_b16 v[48:49], v24 offset:40960
    ds_read_b64_tr_b16 v[50:51], v24 offset:41472
    s_waitcnt lgkmcnt(15)
    v_mfma_f32_16x16x32_bf16 v[68:71], v[52:55], v[200:203], v[68:71]
    v_mfma_f32_16x16x32_bf16 v[84:87], v[52:55], v[204:207], v[84:87]
    ds_read_b64_tr_b16 v[52:53], v25 offset:40960
    ds_read_b64_tr_b16 v[54:55], v25 offset:41472
    s_waitcnt lgkmcnt(15)
    v_mfma_f32_16x16x32_bf16 v[72:75], v[56:59], v[200:203], v[72:75]
    v_mfma_f32_16x16x32_bf16 v[88:91], v[56:59], v[204:207], v[88:91]
    ds_read_b64_tr_b16 v[56:57], v26 offset:40960
    ds_read_b64_tr_b16 v[58:59], v26 offset:41472
    s_waitcnt lgkmcnt(15)
    v_mfma_f32_16x16x32_bf16 v[76:79], v[60:63], v[200:203], v[76:79]
    v_mfma_f32_16x16x32_bf16 v[92:95], v[60:63], v[204:207], v[92:95]
    ds_read_b64_tr_b16 v[60:61], v27 offset:40960
    ds_read_b64_tr_b16 v[62:63], v27 offset:41472
    s_barrier
    ds_read_b128 v[224:227], v16 offset:0
    s_waitcnt lgkmcnt(15)
    s_add_u32 m0, s72, 65536
    s_nop 0
    buffer_load_dwordx4 v11, s[16:19], s71 offen lds
    v_mfma_f32_16x16x32_bf16 v[64:67], v[32:35], v[208:211], v[64:67]
    v_mfma_f32_16x16x32_bf16 v[80:83], v[32:35], v[212:215], v[80:83]
    ds_read_b64_tr_b16 v[32:33], v20 offset:0
    ds_read_b64_tr_b16 v[34:35], v20 offset:512
    ds_read_b128 v[228:231], v16 offset:2048
    s_waitcnt lgkmcnt(15)
    v_mfma_f32_16x16x32_bf16 v[68:71], v[36:39], v[208:211], v[68:71]
    v_mfma_f32_16x16x32_bf16 v[84:87], v[36:39], v[212:215], v[84:87]
    ds_read_b64_tr_b16 v[36:37], v21 offset:0
    ds_read_b64_tr_b16 v[38:39], v21 offset:512
    ds_read_b128 v[232:235], v17 offset:0
    s_waitcnt lgkmcnt(15)
    s_add_u32 m0, s72, 66560
    s_nop 0
    buffer_load_dwordx4 v12, s[16:19], s71 offen lds
    v_mfma_f32_16x16x32_bf16 v[72:75], v[40:43], v[208:211], v[72:75]
    v_mfma_f32_16x16x32_bf16 v[88:91], v[40:43], v[212:215], v[88:91]
    ds_read_b64_tr_b16 v[40:41], v22 offset:0
    ds_read_b64_tr_b16 v[42:43], v22 offset:512
    ds_read_b128 v[236:239], v17 offset:2048
    s_waitcnt lgkmcnt(15)
    v_mfma_f32_16x16x32_bf16 v[76:79], v[44:47], v[208:211], v[76:79]
    v_mfma_f32_16x16x32_bf16 v[92:95], v[44:47], v[212:215], v[92:95]
    ds_read_b64_tr_b16 v[44:45], v23 offset:0
    ds_read_b64_tr_b16 v[46:47], v23 offset:512
    s_waitcnt lgkmcnt(15)
    s_add_u32 m0, s72, 67584
    s_nop 0
    buffer_load_dwordx4 v13, s[16:19], s71 offen lds
    s_add_u32 s71, s71, 393216
    v_mfma_f32_16x16x32_bf16 v[64:67], v[48:51], v[216:219], v[64:67]
    v_mfma_f32_16x16x32_bf16 v[80:83], v[48:51], v[220:223], v[80:83]
    ds_read_b64_tr_b16 v[48:49], v20 offset:8192
    ds_read_b64_tr_b16 v[50:51], v20 offset:8704
    s_waitcnt lgkmcnt(15)
    v_mfma_f32_16x16x32_bf16 v[68:71], v[52:55], v[216:219], v[68:71]
    v_mfma_f32_16x16x32_bf16 v[84:87], v[52:55], v[220:223], v[84:87]
    ds_read_b64_tr_b16 v[52:53], v21 offset:8192
    ds_read_b64_tr_b16 v[54:55], v21 offset:8704
    s_waitcnt lgkmcnt(15)
    v_mfma_f32_16x16x32_bf16 v[72:75], v[56:59], v[216:219], v[72:75]
    v_mfma_f32_16x16x32_bf16 v[88:91], v[56:59], v[220:223], v[88:91]
    ds_read_b64_tr_b16 v[56:57], v22 offset:8192
    ds_read_b64_tr_b16 v[58:59], v22 offset:8704
    s_waitcnt lgkmcnt(15)
    v_mfma_f32_16x16x32_bf16 v[76:79], v[60:63], v[216:219], v[76:79]
    v_mfma_f32_16x16x32_bf16 v[92:95], v[60:63], v[220:223], v[92:95]
    ds_read_b64_tr_b16 v[60:61], v23 offset:8192
    ds_read_b64_tr_b16 v[62:63], v23 offset:8704
    s_barrier
    ds_read_b128 v[240:243], v16 offset:32768
    s_waitcnt lgkmcnt(15)
    s_add_u32 m0, s72, 98304
    s_nop 0
    buffer_load_dwordx4 v11, s[16:19], s71 offen lds
    v_mfma_f32_16x16x32_bf16 v[64:67], v[32:35], v[224:227], v[64:67]
    v_mfma_f32_16x16x32_bf16 v[80:83], v[32:35], v[228:231], v[80:83]
    ds_read_b64_tr_b16 v[32:33], v20 offset:32768
    ds_read_b64_tr_b16 v[34:35], v20 offset:33280
    ds_read_b128 v[244:247], v16 offset:34816
    s_waitcnt lgkmcnt(15)
    v_mfma_f32_16x16x32_bf16 v[68:71], v[36:39], v[224:227], v[68:71]
    v_mfma_f32_16x16x32_bf16 v[84:87], v[36:39], v[228:231], v[84:87]
    ds_read_b64_tr_b16 v[36:37], v21 offset:32768
    ds_read_b64_tr_b16 v[38:39], v21 offset:33280
    ds_read_b128 v[248:251], v17 offset:32768
    s_waitcnt lgkmcnt(15)
    s_add_u32 m0, s72, 99328
    s_nop 0
    buffer_load_dwordx4 v12, s[16:19], s71 offen lds
    v_mfma_f32_16x16x32_bf16 v[72:75], v[40:43], v[224:227], v[72:75]
    v_mfma_f32_16x16x32_bf16 v[88:91], v[40:43], v[228:231], v[88:91]
    ds_read_b64_tr_b16 v[40:41], v22 offset:32768
    ds_read_b64_tr_b16 v[42:43], v22 offset:33280
    ds_read_b128 v[252:255], v17 offset:34816
    s_waitcnt lgkmcnt(15)
    v_mfma_f32_16x16x32_bf16 v[76:79], v[44:47], v[224:227], v[76:79]
    v_mfma_f32_16x16x32_bf16 v[92:95], v[44:47], v[228:231], v[92:95]
    ds_read_b64_tr_b16 v[44:45], v23 offset:32768
    ds_read_b64_tr_b16 v[46:47], v23 offset:33280
    s_waitcnt lgkmcnt(15)
    s_add_u32 m0, s72, 100352
    s_nop 0
    buffer_load_dwordx4 v13, s[16:19], s71 offen lds
    s_add_u32 s71, s71, 393216
    v_mfma_f32_16x16x32_bf16 v[64:67], v[48:51], v[232:235], v[64:67]
    v_mfma_f32_16x16x32_bf16 v[80:83], v[48:51], v[236:239], v[80:83]
    ds_read_b64_tr_b16 v[48:49], v20 offset:40960
    ds_read_b64_tr_b16 v[50:51], v20 offset:41472
    s_waitcnt lgkmcnt(15)
    v_mfma_f32_16x16x32_bf16 v[68:71], v[52:55], v[232:235], v[68:71]
    v_mfma_f32_16x16x32_bf16 v[84:87], v[52:55], v[236:239], v[84:87]
    ds_read_b64_tr_b16 v[52:53], v21 offset:40960
    ds_read_b64_tr_b16 v[54:55], v21 offset:41472
    s_waitcnt lgkmcnt(15)
    v_mfma_f32_16x16x32_bf16 v[72:75], v[56:59], v[232:235], v[72:75]
    v_mfma_f32_16x16x32_bf16 v[88:91], v[56:59], v[236:239], v[88:91]
    ds_read_b64_tr_b16 v[56:57], v22 offset:40960
    ds_read_b64_tr_b16 v[58:59], v22 offset:41472
    s_waitcnt lgkmcnt(15)
    v_mfma_f32_16x16x32_bf16 v[76:79], v[60:63], v[232:235], v[76:79]
    v_mfma_f32_16x16x32_bf16 v[92:95], v[60:63], v[236:239], v[92:95]
    ds_read_b64_tr_b16 v[60:61], v23 offset:40960
    ds_read_b64_tr_b16 v[62:63], v23 offset:41472
    s_waitcnt lgkmcnt(0)
    s_barrier
    s_waitcnt lgkmcnt(15)
    s_add_u32 m0, s72, 0
    s_nop 0
    buffer_load_dwordx4 v11, s[16:19], s71 offen lds
    v_mfma_f32_16x16x32_bf16 v[64:67], v[32:35], v[240:243], v[64:67]
    v_mfma_f32_16x16x32_bf16 v[80:83], v[32:35], v[244:247], v[80:83]
    s_waitcnt lgkmcnt(14)
    v_mfma_f32_16x16x32_bf16 v[68:71], v[36:39], v[240:243], v[68:71]
    v_mfma_f32_16x16x32_bf16 v[84:87], v[36:39], v[244:247], v[84:87]
    s_waitcnt lgkmcnt(11)
    s_add_u32 m0, s72, 1024
    s_nop 0
    buffer_load_dwordx4 v12, s[16:19], s71 offen lds
    v_mfma_f32_16x16x32_bf16 v[72:75], v[40:43], v[240:243], v[72:75]
    v_mfma_f32_16x16x32_bf16 v[88:91], v[40:43], v[244:247], v[88:91]
    s_waitcnt lgkmcnt(8)
    v_mfma_f32_16x16x32_bf16 v[76:79], v[44:47], v[240:243], v[76:79]
    v_mfma_f32_16x16x32_bf16 v[92:95], v[44:47], v[244:247], v[92:95]
    s_waitcnt lgkmcnt(6)
    s_add_u32 m0, s72, 2048
    s_nop 0
    buffer_load_dwordx4 v13, s[16:19], s71 offen lds
    s_add_u32 s71, s71, 393216
    v_mfma_f32_16x16x32_bf16 v[64:67], v[48:51], v[248:251], v[64:67]
    v_mfma_f32_16x16x32_bf16 v[80:83], v[48:51], v[252:255], v[80:83]
    s_waitcnt lgkmcnt(4)
    v_mfma_f32_16x16x32_bf16 v[68:71], v[52:55], v[248:251], v[68:71]
    v_mfma_f32_16x16x32_bf16 v[84:87], v[52:55], v[252:255], v[84:87]
    s_waitcnt lgkmcnt(2)
    v_mfma_f32_16x16x32_bf16 v[72:75], v[56:59], v[248:251], v[72:75]
    v_mfma_f32_16x16x32_bf16 v[88:91], v[56:59], v[252:255], v[88:91]
    s_waitcnt lgkmcnt(0)
    v_mfma_f32_16x16x32_bf16 v[76:79], v[60:63], v[248:251], v[76:79]
    v_mfma_f32_16x16x32_bf16 v[92:95], v[60:63], v[252:255], v[92:95]
L_AEPI:
    v_mul_u32_u24 v8, 16640, v7
    v_and_b32 v9, 14, v6
    v_lshl_add_u32 v8, v9, 3, v8
    v_and_b32 v9, 1, v6
    v_lshl_add_u32 v8, v9, 7, v8
    v_cmp_eq_u32 s[74:75], 0, v9
    s_lshl_b32 s64, s94, 5
    s_lshr_b32 s65, s3, 2
    s_lshl_b32 s65, s65, 4
    s_add_u32 s64, s64, s65
    s_mul_i32 s64, s64, 16640
    s_lshl_b32 s65, s93, 7
    s_and_b32 s73, s3, 3
    s_lshl_b32 s73, s73, 5
    s_add_u32 s65, s65, s73
    s_lshl_b32 s65, s65, 3
    s_add_u32 s64, s64, s65
    s_add_u32 s64, s64, 0
    s_cmp_lt_u32 s94, 5
    s_cselect_b32 s65, 0x3ea52b5c, 1.0
    v_mul_f32 v64, s65, v64
    v_mul_f32 v65, s65, v65
    v_mul_f32 v66, s65, v66
    v_mul_f32 v67, s65, v67
    v_cvt_pk_bf16_f32 v64, v64, v65
    v_cvt_pk_bf16_f32 v65, v66, v67
    v_mul_f32 v80, s65, v80
    v_mul_f32 v81, s65, v81
    v_mul_f32 v82, s65, v82
    v_mul_f32 v83, s65, v83
    v_cvt_pk_bf16_f32 v80, v80, v81
    v_cvt_pk_bf16_f32 v81, v82, v83
    v_cndmask_b32 v32, v64, v80, s[74:75]
    v_cndmask_b32 v33, v65, v81, s[74:75]
    s_nop 0
    v_mov_b32_dpp v34, v32 quad_perm:[1,0,3,2] row_mask:0xf bank_mask:0xf
    v_mov_b32_dpp v35, v33 quad_perm:[1,0,3,2] row_mask:0xf bank_mask:0xf
    v_cndmask_b32 v36, v34, v64, s[74:75]
    v_cndmask_b32 v37, v35, v65, s[74:75]
    v_cndmask_b32 v38, v80, v34, s[74:75]
    v_cndmask_b32 v39, v81, v35, s[74:75]
    buffer_store_dwordx4 v[36:39], v8, s[36:39], s64 offen sc1
    s_add_u32 s64, s64, 66560
    v_mul_f32 v68, s65, v68
    v_mul_f32 v69, s65, v69
    v_mul_f32 v70, s65, v70
    v_mul_f32 v71, s65, v71
    v_cvt_pk_bf16_f32 v68, v68, v69
    v_cvt_pk_bf16_f32 v69, v70, v71
    v_mul_f32 v84, s65, v84
    v_mul_f32 v85, s65, v85
    v_mul_f32 v86, s65, v86
    v_mul_f32 v87, s65, v87
    v_cvt_pk_bf16_f32 v84, v84, v85
    v_cvt_pk_bf16_f32 v85, v86, v87
    v_cndmask_b32 v40, v68, v84, s[74:75]
    v_cndmask_b32 v41, v69, v85, s[74:75]
    s_nop 0
    v_mov_b32_dpp v42, v40 quad_perm:[1,0,3,2] row_mask:0xf bank_mask:0xf
    v_mov_b32_dpp v43, v41 quad_perm:[1,0,3,2] row_mask:0xf bank_mask:0xf
    v_cndmask_b32 v44, v42, v68, s[74:75]
    v_cndmask_b32 v45, v43, v69, s[74:75]
    v_cndmask_b32 v46, v84, v42, s[74:75]
    v_cndmask_b32 v47, v85, v43, s[74:75]
    buffer_store_dwordx4 v[44:47], v8, s[36:39], s64 offen sc1
    s_add_u32 s64, s64, 66560
    v_mul_f32 v72, s65, v72
    v_mul_f32 v73, s65, v73
    v_mul_f32 v74, s65, v74
    v_mul_f32 v75, s65, v75
    v_cvt_pk_bf16_f32 v72, v72, v73
    v_cvt_pk_bf16_f32 v73, v74, v75
    v_mul_f32 v88, s65, v88
    v_mul_f32 v89, s65, v89
    v_mul_f32 v90, s65, v90
    v_mul_f32 v91, s65, v91
    v_cvt_pk_bf16_f32 v88, v88, v89
    v_cvt_pk_bf16_f32 v89, v90, v91
    v_cndmask_b32 v48, v72, v88, s[74:75]
    v_cndmask_b32 v49, v73, v89, s[74:75]
    s_nop 0
    v_mov_b32_dpp v50, v48 quad_perm:[1,0,3,2] row_mask:0xf bank_mask:0xf
    v_mov_b32_dpp v51, v49 quad_perm:[1,0,3,2] row_mask:0xf bank_mask:0xf
    v_cndmask_b32 v52, v50, v72, s[74:75]
    v_cndmask_b32 v53, v51, v73, s[74:75]
    v_cndmask_b32 v54, v88, v50, s[74:75]
    v_cndmask_b32 v55, v89, v51, s[74:75]
    buffer_store_dwordx4 v[52:55], v8, s[36:39], s64 offen sc1
    s_add_u32 s64, s64, 66560
    v_mul_f32 v76, s65, v76
    v_mul_f32 v77, s65, v77
    v_mul_f32 v78, s65, v78
    v_mul_f32 v79, s65, v79
    v_cvt_pk_bf16_f32 v76, v76, v77
    v_cvt_pk_bf16_f32 v77, v78, v79
    v_mul_f32 v92, s65, v92
    v_mul_f32 v93, s65, v93
    v_mul_f32 v94, s65, v94
    v_mul_f32 v95, s65, v95
    v_cvt_pk_bf16_f32 v92, v92, v93
    v_cvt_pk_bf16_f32 v93, v94, v95
    v_cndmask_b32 v56, v76, v92, s[74:75]
    v_cndmask_b32 v57, v77, v93, s[74:75]
    s_nop 0
    v_mov_b32_dpp v58, v56 quad_perm:[1,0,3,2] row_mask:0xf bank_mask:0xf
    v_mov_b32_dpp v59, v57 quad_perm:[1,0,3,2] row_mask:0xf bank_mask:0xf
    v_cndmask_b32 v60, v58, v76, s[74:75]
    v_cndmask_b32 v61, v59, v77, s[74:75]
    v_cndmask_b32 v62, v92, v58, s[74:75]
    v_cndmask_b32 v63, v93, v59, s[74:75]
    buffer_store_dwordx4 v[60:63], v8, s[36:39], s64 offen sc1
    s_add_u32 s64, s64, 66560
    s_waitcnt vmcnt(13)
    s_branch L_AJOIN
L_GWG:
    v_lshlrev_b32 v20, 4, v7
    buffer_load_dwordx4 v[32:35], v20, s[28:31], 0 offen offset:0
    buffer_load_dwordx4 v[36:39], v20, s[28:31], 0 offen offset:64
    buffer_load_dwordx4 v[40:43], v20, s[28:31], 0 offen offset:128
    buffer_load_dwordx4 v[44:47], v20, s[28:31], 0 offen offset:192
    buffer_load_dwordx4 v[48:51], v20, s[28:31], 0 offen offset:256
    buffer_load_dwordx4 v[52:55], v20, s[28:31], 0 offen offset:320
    buffer_load_dwordx4 v[56:59], v20, s[28:31], 0 offen offset:384
    buffer_load_dwordx4 v[60:63], v20, s[28:31], 0 offen offset:448
    s_waitcnt vmcnt(24)
    s_barrier
    s_cmp_ge_u32 s3, 4
    s_cbranch_scc1 L_log0
    s_add_u32 m0, s68, 98304
    s_nop 0
    buffer_load_dwordx4 v4, s[8:11], s66 offen lds
    s_add_u32 m0, s68, 99328
    s_nop 0
    buffer_load_dwordx4 v5, s[8:11], s66 offen lds
    s_add_u32 m0, s68, 100352
    s_nop 0
    buffer_load_dwordx4 v4, s[8:11], s75 offen lds
    s_add_u32 m0, s68, 101376
    s_nop 0
    buffer_load_dwordx4 v5, s[8:11], s75 offen lds
    s_add_u32 s66, s66, 128
    s_add_u32 s75, s75, 128
    s_add_u32 m0, s69, 98304
    s_nop 0
    buffer_load_dwordx4 v2, s[12:15], s67 offen lds
    s_add_u32 m0, s69, 99328
    s_nop 0
    buffer_load_dwordx4 v3, s[12:15], s67 offen lds
    s_add_u32 m0, s69, 100352
    s_nop 0
    buffer_load_dwordx4 v2, s[12:15], s76 offen lds
    s_add_u32 m0, s69, 101376
    s_nop 0
    buffer_load_dwordx4 v3, s[12:15], s76 offen lds
    s_add_u32 s67, s67, s70
    s_add_u32 s76, s76, s70
L_log0:
    ds_read_b128 v[96:99], v16 offset:0
    ds_read_b128 v[100:103], v16 offset:2048
    ds_read_b128 v[104:107], v17 offset:0
    ds_read_b128 v[108:111], v17 offset:2048
    s_waitcnt vmcnt(7)
    s_waitcnt lgkmcnt(2)
    v_mfma_f32_16x16x32_bf16 v[64:67], v[32:35], v[96:99], v[64:67]
    v_mfma_f32_16x16x32_bf16 v[68:71], v[32:35], v[100:103], v[68:71]
    buffer_load_dwordx4 v[32:35], v20, s[28:31], 0 offen offset:512
    s_waitcnt vmcnt(7)
    s_waitcnt lgkmcnt(0)
    v_mfma_f32_16x16x32_bf16 v[64:67], v[36:39], v[104:107], v[64:67]
    v_mfma_f32_16x16x32_bf16 v[68:71], v[36:39], v[108:111], v[68:71]
    buffer_load_dwordx4 v[36:39], v20, s[28:31], 0 offen offset:576
    s_waitcnt vmcnt(26)
    s_barrier
    s_cmp_ge_u32 s3, 4
    s_cbranch_scc1 L_log1
    s_add_u32 m0, s68, 0
    s_nop 0
    buffer_load_dwordx4 v4, s[8:11], s66 offen lds
    s_add_u32 m0, s68, 1024
    s_nop 0
    buffer_load_dwordx4 v5, s[8:11], s66 offen lds
    s_add_u32 m0, s68, 2048
    s_nop 0
    buffer_load_dwordx4 v4, s[8:11], s75 offen lds
    s_add_u32 m0, s68, 3072
    s_nop 0
    buffer_load_dwordx4 v5, s[8:11], s75 offen lds
    s_add_u32 s66, s66, 128
    s_add_u32 s75, s75, 128
    s_add_u32 m0, s69, 0
    s_nop 0
    buffer_load_dwordx4 v2, s[12:15], s67 offen lds
    s_add_u32 m0, s69, 1024
    s_nop 0
    buffer_load_dwordx4 v3, s[12:15], s67 offen lds
    s_add_u32 m0, s69, 2048
    s_nop 0
    buffer_load_dwordx4 v2, s[12:15], s76 offen lds
    s_add_u32 m0, s69, 3072
    s_nop 0
    buffer_load_dwordx4 v3, s[12:15], s76 offen lds
    s_add_u32 s67, s67, s70
    s_add_u32 s76, s76, s70
L_log1:
    s_add_u32 m0, s72, 131072
    s_nop 0
    buffer_load_dwordx4 v11, s[16:19], s71 offen lds
    s_add_u32 m0, s72, 132096
    s_nop 0
    buffer_load_dwordx4 v12, s[16:19], s71 offen lds
    s_add_u32 m0, s72, 133120
    s_nop 0
    buffer_load_dwordx4 v13, s[16:19], s71 offen lds
    s_add_u32 s71, s71, 393216
    ds_read_b128 v[112:115], v16 offset:32768
    ds_read_b128 v[116:119], v16 offset:34816
    ds_read_b128 v[120:123], v17 offset:32768
    ds_read_b128 v[124:127], v17 offset:34816
    s_waitcnt vmcnt(10)
    s_waitcnt lgkmcnt(2)
    v_mfma_f32_16x16x32_bf16 v[64:67], v[40:43], v[112:115], v[64:67]
    v_mfma_f32_16x16x32_bf16 v[68:71], v[40:43], v[116:119], v[68:71]
    buffer_load_dwordx4 v[40:43], v20, s[28:31], 0 offen offset:640
    s_waitcnt vmcnt(10)
    s_waitcnt lgkmcnt(0)
    v_mfma_f32_16x16x32_bf16 v[64:67], v[44:47], v[120:123], v[64:67]
    v_mfma_f32_16x16x32_bf16 v[68:71], v[44:47], v[124:127], v[68:71]
    buffer_load_dwordx4 v[44:47], v20, s[28:31], 0 offen offset:704
    s_waitcnt vmcnt(31)
    s_barrier
    s_cmp_ge_u32 s3, 4
    s_cbranch_scc1 L_log2
    s_add_u32 m0, s68, 32768
    s_nop 0
    buffer_load_dwordx4 v4, s[8:11], s66 offen lds
    s_add_u32 m0, s68, 33792
    s_nop 0
    buffer_load_dwordx4 v5, s[8:11], s66 offen lds
    s_add_u32 m0, s68, 34816
    s_nop 0
    buffer_load_dwordx4 v4, s[8:11], s75 offen lds
    s_add_u32 m0, s68, 35840
    s_nop 0
    buffer_load_dwordx4 v5, s[8:11], s75 offen lds
    s_add_u32 s66, s66, 128
    s_add_u32 s75, s75, 128
    s_add_u32 m0, s69, 32768
    s_nop 0
    buffer_load_dwordx4 v2, s[12:15], s67 offen lds
    s_add_u32 m0, s69, 33792
    s_nop 0
    buffer_load_dwordx4 v3, s[12:15], s67 offen lds
    s_add_u32 m0, s69, 34816
    s_nop 0
    buffer_load_dwordx4 v2, s[12:15], s76 offen lds
    s_add_u32 m0, s69, 35840
    s_nop 0
    buffer_load_dwordx4 v3, s[12:15], s76 offen lds
    s_add_u32 s67, s67, s70
    s_add_u32 s76, s76, s70
L_log2:
    ds_read_b128 v[128:131], v18 offset:0
    ds_read_b128 v[132:135], v18 offset:2048
    ds_read_b128 v[136:139], v19 offset:0
    ds_read_b128 v[140:143], v19 offset:2048
    s_waitcnt vmcnt(10)
    s_waitcnt lgkmcnt(2)
    v_mfma_f32_16x16x32_bf16 v[64:67], v[48:51], v[128:131], v[64:67]
    v_mfma_f32_16x16x32_bf16 v[68:71], v[48:51], v[132:135], v[68:71]
    buffer_load_dwordx4 v[48:51], v20, s[28:31], 0 offen offset:768
    s_waitcnt vmcnt(10)
    s_waitcnt lgkmcnt(0)
    v_mfma_f32_16x16x32_bf16 v[64:67], v[52:55], v[136:139], v[64:67]
    v_mfma_f32_16x16x32_bf16 v[68:71], v[52:55], v[140:143], v[68:71]
    buffer_load_dwordx4 v[52:55], v20, s[28:31], 0 offen offset:832
    s_waitcnt vmcnt(25)
    s_barrier
    s_cmp_ge_u32 s3, 4
    s_cbranch_scc1 L_log3
    s_add_u32 m0, s68, 65536
    s_nop 0
    buffer_load_dwordx4 v4, s[8:11], s66 offen lds
    s_add_u32 m0, s68, 66560
    s_nop 0
    buffer_load_dwordx4 v5, s[8:11], s66 offen lds
    s_add_u32 m0, s68, 67584
    s_nop 0
    buffer_load_dwordx4 v4, s[8:11], s75 offen lds
    s_add_u32 m0, s68, 68608
    s_nop 0
    buffer_load_dwordx4 v5, s[8:11], s75 offen lds
    s_add_u32 s66, s66, 128
    s_add_u32 s75, s75, 128
    s_add_u32 m0, s69, 65536
    s_nop 0
    buffer_load_dwordx4 v2, s[12:15], s67 offen lds
    s_add_u32 m0, s69, 66560
    s_nop 0
    buffer_load_dwordx4 v3, s[12:15], s67 offen lds
    s_add_u32 m0, s69, 67584
    s_nop 0
    buffer_load_dwordx4 v2, s[12:15], s76 offen lds
    s_add_u32 m0, s69, 68608
    s_nop 0
    buffer_load_dwordx4 v3, s[12:15], s76 offen lds
    s_add_u32 s67, s67, s70
    s_add_u32 s76, s76, s70
L_log3:
    ds_read_b128 v[144:147], v18 offset:32768
    ds_read_b128 v[148:151], v18 offset:34816
    ds_read_b128 v[152:155], v19 offset:32768
    ds_read_b128 v[156:159], v19 offset:34816
    s_waitcnt vmcnt(10)
    s_waitcnt lgkmcnt(2)
    v_mfma_f32_16x16x32_bf16 v[64:67], v[56:59], v[144:147], v[64:67]
    v_mfma_f32_16x16x32_bf16 v[68:71], v[56:59], v[148:151], v[68:71]
    buffer_load_dwordx4 v[56:59], v20, s[28:31], 0 offen offset:896
    s_waitcnt vmcnt(10)
    s_waitcnt lgkmcnt(0)
    v_mfma_f32_16x16x32_bf16 v[64:67], v[60:63], v[152:155], v[64:67]
    v_mfma_f32_16x16x32_bf16 v[68:71], v[60:63], v[156:159], v[68:71]
    buffer_load_dwordx4 v[60:63], v20, s[28:31], 0 offen offset:960
    s_waitcnt vmcnt(25)
    s_barrier
    s_cmp_ge_u32 s3, 4
    s_cbranch_scc1 L_log4
    s_add_u32 m0, s68, 98304
    s_nop 0
    buffer_load_dwordx4 v4, s[8:11], s66 offen lds
    s_add_u32 m0, s68, 99328
    s_nop 0
    buffer_load_dwordx4 v5, s[8:11], s66 offen lds
    s_add_u32 m0, s68, 100352
    s_nop 0
    buffer_load_dwordx4 v4, s[8:11], s75 offen lds
    s_add_u32 m0, s68, 101376
    s_nop 0
    buffer_load_dwordx4 v5, s[8:11], s75 offen lds
    s_add_u32 s66, s66, 128
    s_add_u32 s75, s75, 128
    s_add_u32 m0, s69, 98304
    s_nop 0
    buffer_load_dwordx4 v2, s[12:15], s67 offen lds
    s_add_u32 m0, s69, 99328
    s_nop 0
    buffer_load_dwordx4 v3, s[12:15], s67 offen lds
    s_add_u32 m0, s69, 100352
    s_nop 0
    buffer_load_dwordx4 v2, s[12:15], s76 offen lds
    s_add_u32 m0, s69, 101376
    s_nop 0
    buffer_load_dwordx4 v3, s[12:15], s76 offen lds
    s_add_u32 s67, s67, s70
    s_add_u32 s76, s76, s70
L_log4:
    ds_read_b128 v[160:163], v16 offset:0
    ds_read_b128 v[164:167], v16 offset:2048
    ds_read_b128 v[168:171], v17 offset:0
    ds_read_b128 v[172:175], v17 offset:2048
    s_waitcnt vmcnt(10)
    s_waitcnt lgkmcnt(2)
    v_mfma_f32_16x16x32_bf16 v[64:67], v[32:35], v[160:163], v[64:67]
    v_mfma_f32_16x16x32_bf16 v[68:71], v[32:35], v[164:167], v[68:71]
    buffer_load_dwordx4 v[32:35], v20, s[28:31], 0 offen offset:1024
    s_waitcnt vmcnt(10)
    s_waitcnt lgkmcnt(0)
    v_mfma_f32_16x16x32_bf16 v[64:67], v[36:39], v[168:171], v[64:67]
    v_mfma_f32_16x16x32_bf16 v[68:71], v[36:39], v[172:175], v[68:71]
    buffer_load_dwordx4 v[36:39], v20, s[28:31], 0 offen offset:1088
    s_waitcnt vmcnt(22)
    s_barrier
    s_cmp_ge_u32 s3, 4
    s_cbranch_scc1 L_log5
    s_add_u32 m0, s68, 0
    s_nop 0
    buffer_load_dwordx4 v4, s[8:11], s66 offen lds
    s_add_u32 m0, s68, 1024
    s_nop 0
    buffer_load_dwordx4 v5, s[8:11], s66 offen lds
    s_add_u32 m0, s68, 2048
    s_nop 0
    buffer_load_dwordx4 v4, s[8:11], s75 offen lds
    s_add_u32 m0, s68, 3072
    s_nop 0
    buffer_load_dwordx4 v5, s[8:11], s75 offen lds
    s_add_u32 s66, s66, 128
    s_add_u32 s75, s75, 128
    s_add_u32 m0, s69, 0
    s_nop 0
    buffer_load_dwordx4 v2, s[12:15], s67 offen lds
    s_add_u32 m0, s69, 1024
    s_nop 0
    buffer_load_dwordx4 v3, s[12:15], s67 offen lds
    s_add_u32 m0, s69, 2048
    s_nop 0
    buffer_load_dwordx4 v2, s[12:15], s76 offen lds
    s_add_u32 m0, s69, 3072
    s_nop 0
    buffer_load_dwordx4 v3, s[12:15], s76 offen lds
    s_add_u32 s67, s67, s70
    s_add_u32 s76, s76, s70
L_log5:
    ds_read_b128 v[176:179], v16 offset:32768
    ds_read_b128 v[180:183], v16 offset:34816
    ds_read_b128 v[184:187], v17 offset:32768
    ds_read_b128 v[188:191], v17 offset:34816
    s_waitcnt vmcnt(7)
    s_waitcnt lgkmcnt(2)
    v_mfma_f32_16x16x32_bf16 v[64:67], v[40:43], v[176:179], v[64:67]
    v_mfma_f32_16x16x32_bf16 v[68:71], v[40:43], v[180:183], v[68:71]
    buffer_load_dwordx4 v[40:43], v20, s[28:31], 0 offen offset:1152
    s_waitcnt vmcnt(7)
    s_waitcnt lgkmcnt(0)
    v_mfma_f32_16x16x32_bf16 v[64:67], v[44:47], v[184:187], v[64:67]
    v_mfma_f32_16x16x32_bf16 v[68:71], v[44:47], v[188:191], v[68:71]
    buffer_load_dwordx4 v[44:47], v20, s[28:31], 0 offen offset:1216
    s_waitcnt vmcnt(22)
    s_barrier
    s_cmp_ge_u32 s3, 4
    s_cbranch_scc1 L_log6
    s_add_u32 m0, s68, 32768
    s_nop 0
    buffer_load_dwordx4 v4, s[8:11], s66 offen lds
    s_add_u32 m0, s68, 33792
    s_nop 0
    buffer_load_dwordx4 v5, s[8:11], s66 offen lds
    s_add_u32 m0, s68, 34816
    s_nop 0
    buffer_load_dwordx4 v4, s[8:11], s75 offen lds
    s_add_u32 m0, s68, 35840
    s_nop 0
    buffer_load_dwordx4 v5, s[8:11], s75 offen lds
    s_add_u32 s66, s66, 128
    s_add_u32 s75, s75, 128
    s_add_u32 m0, s69, 32768
    s_nop 0
    buffer_load_dwordx4 v2, s[12:15], s67 offen lds
    s_add_u32 m0, s69, 33792
    s_nop 0
    buffer_load_dwordx4 v3, s[12:15], s67 offen lds
    s_add_u32 m0, s69, 34816
    s_nop 0
    buffer_load_dwordx4 v2, s[12:15], s76 offen lds
    s_add_u32 m0, s69, 35840
    s_nop 0
    buffer_load_dwordx4 v3, s[12:15], s76 offen lds
    s_add_u32 s67, s67, s70
    s_add_u32 s76, s76, s70
L_log6:
    ds_read_b128 v[192:195], v18 offset:0
    ds_read_b128 v[196:199], v18 offset:2048
    ds_read_b128 v[200:203], v19 offset:0
    ds_read_b128 v[204:207], v19 offset:2048
    s_waitcnt vmcnt(7)
    s_waitcnt lgkmcnt(2)
    v_mfma_f32_16x16x32_bf16 v[64:67], v[48:51], v[192:195], v[64:67]
    v_mfma_f32_16x16x32_bf16 v[68:71], v[48:51], v[196:199], v[68:71]
    s_waitcnt vmcnt(6)
    s_waitcnt lgkmcnt(0)
    v_mfma_f32_16x16x32_bf16 v[64:67], v[52:55], v[200:203], v[64:67]
    v_mfma_f32_16x16x32_bf16 v[68:71], v[52:55], v[204:207], v[68:71]
    s_waitcnt vmcnt(20)
    s_barrier
    s_cmp_lg_u32 s3, 0
    s_cbranch_scc1 L_teg
    v_mov_b32 v14, 0
    buffer_load_dwordx2 v[14:15], v14, s[88:91], 0 offen sc1
L_teg:
    s_add_u32 m0, s72, 65536
    s_nop 0
    buffer_load_dwordx4 v11, s[16:19], s71 offen lds
    s_add_u32 m0, s72, 66560
    s_nop 0
    buffer_load_dwordx4 v12, s[16:19], s71 offen lds
    s_add_u32 m0, s72, 67584
    s_nop 0
    buffer_load_dwordx4 v13, s[16:19], s71 offen lds
    s_add_u32 s71, s71, 393216
    ds_read_b128 v[208:211], v18 offset:32768
    ds_read_b128 v[212:215], v18 offset:34816
    ds_read_b128 v[216:219], v19 offset:32768
    ds_read_b128 v[220:223], v19 offset:34816
    s_waitcnt vmcnt(8)
    s_waitcnt lgkmcnt(2)
    v_mfma_f32_16x16x32_bf16 v[64:67], v[56:59], v[208:211], v[64:67]
    v_mfma_f32_16x16x32_bf16 v[68:71], v[56:59], v[212:215], v[68:71]
    s_waitcnt vmcnt(7)
    s_waitcnt lgkmcnt(0)
    v_mfma_f32_16x16x32_bf16 v[64:67], v[60:63], v[216:219], v[64:67]
    v_mfma_f32_16x16x32_bf16 v[68:71], v[60:63], v[220:223], v[68:71]
    s_waitcnt vmcnt(13)
    s_barrier
    s_add_u32 m0, s72, 98304
    s_nop 0
    buffer_load_dwordx4 v11, s[16:19], s71 offen lds
    s_add_u32 m0, s72, 99328
    s_nop 0
    buffer_load_dwordx4 v12, s[16:19], s71 offen lds
    s_add_u32 m0, s72, 100352
    s_nop 0
    buffer_load_dwordx4 v13, s[16:19], s71 offen lds
    s_add_u32 s71, s71, 393216
    ds_read_b128 v[224:227], v16 offset:0
    ds_read_b128 v[228:231], v16 offset:2048
    ds_read_b128 v[232:235], v17 offset:0
    ds_read_b128 v[236:239], v17 offset:2048
    s_waitcnt vmcnt(9)
    s_waitcnt lgkmcnt(2)
    v_mfma_f32_16x16x32_bf16 v[64:67], v[32:35], v[224:227], v[64:67]
    v_mfma_f32_16x16x32_bf16 v[68:71], v[32:35], v[228:231], v[68:71]
    s_waitcnt vmcnt(8)
    s_waitcnt lgkmcnt(0)
    v_mfma_f32_16x16x32_bf16 v[64:67], v[36:39], v[232:235], v[64:67]
    v_mfma_f32_16x16x32_bf16 v[68:71], v[36:39], v[236:239], v[68:71]
    s_waitcnt vmcnt(6)
    s_barrier
    s_add_u32 m0, s72, 0
    s_nop 0
    buffer_load_dwordx4 v11, s[16:19], s71 offen lds
    s_add_u32 m0, s72, 1024
    s_nop 0
    buffer_load_dwordx4 v12, s[16:19], s71 offen lds
    s_add_u32 m0, s72, 2048
    s_nop 0
    buffer_load_dwordx4 v13, s[16:19], s71 offen lds
    s_add_u32 s71, s71, 393216
    ds_read_b128 v[240:243], v16 offset:32768
    ds_read_b128 v[244:247], v16 offset:34816
    ds_read_b128 v[248:251], v17 offset:32768
    ds_read_b128 v[252:255], v17 offset:34816
    s_waitcnt vmcnt(10)
    s_waitcnt lgkmcnt(2)
    v_mfma_f32_16x16x32_bf16 v[64:67], v[40:43], v[240:243], v[64:67]
    v_mfma_f32_16x16x32_bf16 v[68:71], v[40:43], v[244:247], v[68:71]
    s_waitcnt vmcnt(9)
    s_waitcnt lgkmcnt(0)
    v_mfma_f32_16x16x32_bf16 v[64:67], v[44:47], v[248:251], v[64:67]
    v_mfma_f32_16x16x32_bf16 v[68:71], v[44:47], v[252:255], v[68:71]
    s_nop 0
    s_nop 5
    v_mul_f32 v64, 0xbfb8aa3b, v64
    v_exp_f32 v64, v64
    s_nop 0
    v_add_f32 v64, 1.0, v64
    v_rcp_f32 v64, v64
    v_mul_f32 v68, 0xbfb8aa3b, v68
    v_exp_f32 v68, v68
    s_nop 0
    v_add_f32 v68, 1.0, v68
    v_rcp_f32 v68, v68
    v_lshlrev_b32 v8, 2, v6
    v_cmp_gt_u32 vcc, 16, v1
    v_mov_b32 v9, 0x7fffff00
    s_nop 0
    v_cndmask_b32 v8, v9, v8, vcc
    s_lshl_b32 s64, s93, 7
    s_and_b32 s65, s3, 3
    s_lshl_b32 s65, s65, 5
    s_add_u32 s64, s64, s65
    s_lshl_b32 s64, s64, 2
    s_add_u32 s64, s64, 17825792
    buffer_store_dword v64, v8, s[36:39], s64 offen sc1
    buffer_store_dword v68, v8, s[36:39], s64 offen offset:64 sc1
    s_waitcnt vmcnt(2)
L_AJOIN:
    s_cmp_lg_u32 s3, 0
    s_cbranch_scc1 L_tokdone
    v_readfirstlane_b32 s64, v15
    s_nop 0
    s_cmp_lg_u32 s64, 0
    s_cbranch_scc1 L_tokok
L_tokpoll:
    v_mov_b32 v14, 0
    buffer_load_dwordx2 v[14:15], v14, s[88:91], 0 offen sc1
    s_waitcnt vmcnt(0)
    v_readfirstlane_b32 s64, v15
    s_nop 0
    s_cmp_lg_u32 s64, 0
    s_cbranch_scc0 L_tokpoll
L_tokok:
    v_mov_b32 v8, 163480
    ds_write_b32 v8, v14
L_tokdone:
    s_waitcnt lgkmcnt(0)
    s_barrier
    ds_read_b64_tr_b16 v[32:33], v31 offset:0
    ds_read_b64_tr_b16 v[34:35], v31 offset:1536
    ds_read_b64_tr_b16 v[36:37], v31 offset:32
    ds_read_b64_tr_b16 v[38:39], v31 offset:1568
    ds_read_b64_tr_b16 v[40:41], v31 offset:64
    ds_read_b64_tr_b16 v[42:43], v31 offset:1600
    ds_read_b64_tr_b16 v[44:45], v31 offset:6144
    ds_read_b64_tr_b16 v[46:47], v31 offset:7680
    ds_read_b64_tr_b16 v[48:49], v31 offset:6176
    ds_read_b64_tr_b16 v[50:51], v31 offset:7712
    ds_read_b64_tr_b16 v[52:53], v31 offset:6208
    ds_read_b64_tr_b16 v[54:55], v31 offset:7744
    v_mov_b32 v64, 0
    v_mov_b32 v65, 0
    v_mov_b32 v66, 0
    v_mov_b32 v67, 0
    v_mov_b32 v68, 0
    v_mov_b32 v69, 0
    v_mov_b32 v70, 0
    v_mov_b32 v71, 0
    v_mov_b32 v72, 0
    v_mov_b32 v73, 0
    v_mov_b32 v74, 0
    v_mov_b32 v75, 0
    v_mov_b32 v76, 0
    v_mov_b32 v77, 0
    v_mov_b32 v78, 0
    v_mov_b32 v79, 0
    v_mov_b32 v80, 0
    v_mov_b32 v81, 0
    v_mov_b32 v82, 0
    v_mov_b32 v83, 0
    v_mov_b32 v84, 0
    v_mov_b32 v85, 0
    v_mov_b32 v86, 0
    v_mov_b32 v87, 0
    s_and_b32 s62, s2, 7
    s_lshr_b32 s63, s2, 3
    s_mul_i32 s60, s63, 52
    s_lshr_b32 s60, s60, 8
    s_mul_i32 s61, s60, 5
    s_sub_u32 s61, s63, s61
    s_and_b32 s62, s62, 1
    s_mul_i32 s62, s62, 5
    s_add_u32 s61, s61, s62
    s_lshl_b32 s61, s61, 7
    s_mul_i32 s60, s60, 1280
    s_add_u32 s61, s61, s60
    v_mul_u32_u24 v9, 7680, v1
    s_waitcnt lgkmcnt(10)
    s_add_u32 m0, s72, 32768
    s_nop 0
    buffer_load_dwordx4 v11, s[16:19], s71 offen lds
    v_mfma_f32_16x16x32_bf16 v[64:67], v[32:35], v[96:99], v[64:67]
    v_mfma_f32_16x16x32_bf16 v[76:79], v[32:35], v[100:103], v[76:79]
    ds_read_b64_tr_b16 v[32:33], v31 offset:12288
    ds_read_b64_tr_b16 v[34:35], v31 offset:13824
    s_waitcnt lgkmcnt(10)
    v_mfma_f32_16x16x32_bf16 v[68:71], v[36:39], v[96:99], v[68:71]
    v_mfma_f32_16x16x32_bf16 v[80:83], v[36:39], v[100:103], v[80:83]
    ds_read_b64_tr_b16 v[36:37], v31 offset:12320
    ds_read_b64_tr_b16 v[38:39], v31 offset:13856
    s_waitcnt lgkmcnt(10)
    s_add_u32 m0, s72, 33792
    s_nop 0
    buffer_load_dwordx4 v12, s[16:19], s71 offen lds
    v_mfma_f32_16x16x32_bf16 v[72:75], v[40:43], v[96:99], v[72:75]
    v_mfma_f32_16x16x32_bf16 v[84:87], v[40:43], v[100:103], v[84:87]
    ds_read_b64_tr_b16 v[40:41], v31 offset:12352
    ds_read_b64_tr_b16 v[42:43], v31 offset:13888
    s_waitcnt lgkmcnt(10)
    s_add_u32 m0, s72, 34816
    s_nop 0
    buffer_load_dwordx4 v13, s[16:19], s71 offen lds
    s_add_u32 s71, s71, 393216
    v_mfma_f32_16x16x32_bf16 v[64:67], v[44:47], v[104:107], v[64:67]
    v_mfma_f32_16x16x32_bf16 v[76:79], v[44:47], v[108:111], v[76:79]
    ds_read_b64_tr_b16 v[44:45], v31 offset:18432
    ds_read_b64_tr_b16 v[46:47], v31 offset:19968
    s_waitcnt lgkmcnt(10)
    v_mfma_f32_16x16x32_bf16 v[68:71], v[48:51], v[104:107], v[68:71]
    v_mfma_f32_16x16x32_bf16 v[80:83], v[48:51], v[108:111], v[80:83]
    ds_read_b64_tr_b16 v[48:49], v31 offset:18464
    ds_read_b64_tr_b16 v[50:51], v31 offset:20000
    s_waitcnt lgkmcnt(10)
    v_mfma_f32_16x16x32_bf16 v[72:75], v[52:55], v[104:107], v[72:75]
    v_mfma_f32_16x16x32_bf16 v[84:87], v[52:55], v[108:111], v[84:87]
    ds_read_b64_tr_b16 v[52:53], v31 offset:18496
    ds_read_b64_tr_b16 v[54:55], v31 offset:20032
    s_waitcnt vmcnt(13)
    s_barrier
    s_waitcnt lgkmcnt(10)
    v_mfma_f32_16x16x32_bf16 v[64:67], v[32:35], v[112:115], v[64:67]
    v_mfma_f32_16x16x32_bf16 v[76:79], v[32:35], v[116:119], v[76:79]
    ds_read_b64_tr_b16 v[32:33], v29 offset:0
    ds_read_b64_tr_b16 v[34:35], v29 offset:1536
    s_waitcnt lgkmcnt(10)
    v_mfma_f32_16x16x32_bf16 v[68:71], v[36:39], v[112:115], v[68:71]
    v_mfma_f32_16x16x32_bf16 v[80:83], v[36:39], v[116:119], v[80:83]
    ds_read_b64_tr_b16 v[36:37], v29 offset:32
    ds_read_b64_tr_b16 v[38:39], v29 offset:1568
    s_waitcnt lgkmcnt(10)
    v_mfma_f32_16x16x32_bf16 v[72:75], v[40:43], v[112:115], v[72:75]
    v_mfma_f32_16x16x32_bf16 v[84:87], v[40:43], v[116:119], v[84:87]
    ds_read_b64_tr_b16 v[40:41], v29 offset:64
    ds_read_b64_tr_b16 v[42:43], v29 offset:1600
    s_cmp_lg_u32 s3, 4
    s_cbranch_scc1 L_g2t0
    s_add_u32 s62, s61, 0
    buffer_load_dword v10, v9, s[20:23], s62 offen
L_g2t0:
    s_waitcnt lgkmcnt(10)
    v_mfma_f32_16x16x32_bf16 v[64:67], v[44:47], v[120:123], v[64:67]
    v_mfma_f32_16x16x32_bf16 v[76:79], v[44:47], v[124:127], v[76:79]
    ds_read_b64_tr_b16 v[44:45], v29 offset:6144
    ds_read_b64_tr_b16 v[46:47], v29 offset:7680
    s_waitcnt lgkmcnt(10)
    v_mfma_f32_16x16x32_bf16 v[68:71], v[48:51], v[120:123], v[68:71]
    v_mfma_f32_16x16x32_bf16 v[80:83], v[48:51], v[124:127], v[80:83]
    ds_read_b64_tr_b16 v[48:49], v29 offset:6176
    ds_read_b64_tr_b16 v[50:51], v29 offset:7712
    s_waitcnt lgkmcnt(10)
    v_mfma_f32_16x16x32_bf16 v[72:75], v[52:55], v[120:123], v[72:75]
    v_mfma_f32_16x16x32_bf16 v[84:87], v[52:55], v[124:127], v[84:87]
    ds_read_b64_tr_b16 v[52:53], v29 offset:6208
    ds_read_b64_tr_b16 v[54:55], v29 offset:7744
    s_cmp_lg_u32 s3, 5
    s_cbranch_scc1 L_g2t1
    s_add_u32 s62, s61, 491520
    buffer_load_dword v10, v9, s[20:23], s62 offen
L_g2t1:
    s_waitcnt vmcnt(3)
    s_barrier
    s_cmp_lg_u32 s3, 0
    s_cbranch_scc1 L_sigA
    v_mov_b32 v9, 163480
    ds_read_b32 v8, v9
    s_lshl_b32 s64, s92, 7
    s_add_u32 s64, s64, 18874368
    v_mov_b32 v9, s64
    s_waitcnt lgkmcnt(0)
    s_mov_b64 exec, 1
    buffer_store_dword v8, v9, s[36:39], 0 offen sc1
    s_mov_b64 exec, -1
L_sigA:
    s_waitcnt lgkmcnt(10)
    v_mfma_f32_16x16x32_bf16 v[64:67], v[32:35], v[128:131], v[64:67]
    v_mfma_f32_16x16x32_bf16 v[76:79], v[32:35], v[132:135], v[76:79]
    ds_read_b64_tr_b16 v[32:33], v29 offset:12288
    ds_read_b64_tr_b16 v[34:35], v29 offset:13824
    s_waitcnt lgkmcnt(10)
    v_mfma_f32_16x16x32_bf16 v[68:71], v[36:39], v[128:131], v[68:71]
    v_mfma_f32_16x16x32_bf16 v[80:83], v[36:39], v[132:135], v[80:83]
    ds_read_b64_tr_b16 v[36:37], v29 offset:12320
    ds_read_b64_tr_b16 v[38:39], v29 offset:13856
    s_waitcnt lgkmcnt(10)
    v_mfma_f32_16x16x32_bf16 v[72:75], v[40:43], v[128:131], v[72:75]
    v_mfma_f32_16x16x32_bf16 v[84:87], v[40:43], v[132:135], v[84:87]
    ds_read_b64_tr_b16 v[40:41], v29 offset:12352
    ds_read_b64_tr_b16 v[42:43], v29 offset:13888
    s_cmp_lg_u32 s3, 6
    s_cbranch_scc1 L_g2t2
    s_add_u32 s62, s61, 983040
    buffer_load_dword v10, v9, s[20:23], s62 offen
L_g2t2:
    s_waitcnt lgkmcnt(10)
    v_mfma_f32_16x16x32_bf16 v[64:67], v[44:47], v[136:139], v[64:67]
    v_mfma_f32_16x16x32_bf16 v[76:79], v[44:47], v[140:143], v[76:79]
    ds_read_b64_tr_b16 v[44:45], v29 offset:18432
    ds_read_b64_tr_b16 v[46:47], v29 offset:19968
    s_waitcnt lgkmcnt(10)
    v_mfma_f32_16x16x32_bf16 v[68:71], v[48:51], v[136:139], v[68:71]
    v_mfma_f32_16x16x32_bf16 v[80:83], v[48:51], v[140:143], v[80:83]
    ds_read_b64_tr_b16 v[48:49], v29 offset:18464
    ds_read_b64_tr_b16 v[50:51], v29 offset:20000
    s_waitcnt lgkmcnt(10)
    v_mfma_f32_16x16x32_bf16 v[72:75], v[52:55], v[136:139], v[72:75]
    v_mfma_f32_16x16x32_bf16 v[84:87], v[52:55], v[140:143], v[84:87]
    ds_read_b64_tr_b16 v[52:53], v29 offset:18496
    ds_read_b64_tr_b16 v[54:55], v29 offset:20032
    s_waitcnt lgkmcnt(10)
    v_mfma_f32_16x16x32_bf16 v[64:67], v[32:35], v[144:147], v[64:67]
    v_mfma_f32_16x16x32_bf16 v[76:79], v[32:35], v[148:151], v[76:79]
    ds_read_b64_tr_b16 v[32:33], v29 offset:32768
    ds_read_b64_tr_b16 v[34:35], v29 offset:34304
    s_waitcnt lgkmcnt(10)
    v_mfma_f32_16x16x32_bf16 v[68:71], v[36:39], v[144:147], v[68:71]
    v_mfma_f32_16x16x32_bf16 v[80:83], v[36:39], v[148:151], v[80:83]
    ds_read_b64_tr_b16 v[36:37], v29 offset:32800
    ds_read_b64_tr_b16 v[38:39], v29 offset:34336
    s_waitcnt lgkmcnt(10)
    v_mfma_f32_16x16x32_bf16 v[72:75], v[40:43], v[144:147], v[72:75]
    v_mfma_f32_16x16x32_bf16 v[84:87], v[40:43], v[148:151], v[84:87]
    ds_read_b64_tr_b16 v[40:41], v29 offset:32832
    ds_read_b64_tr_b16 v[42:43], v29 offset:34368
    s_cmp_lg_u32 s3, 7
    s_cbranch_scc1 L_g2t3
    s_add_u32 s62, s61, 1474560
    buffer_load_dword v10, v9, s[20:23], s62 offen
L_g2t3:
    s_waitcnt lgkmcnt(10)
    v_mfma_f32_16x16x32_bf16 v[64:67], v[44:47], v[152:155], v[64:67]
    v_mfma_f32_16x16x32_bf16 v[76:79], v[44:47], v[156:159], v[76:79]
    ds_read_b64_tr_b16 v[44:45], v29 offset:38912
    ds_read_b64_tr_b16 v[46:47], v29 offset:40448
    s_waitcnt lgkmcnt(10)
    v_mfma_f32_16x16x32_bf16 v[68:71], v[48:51], v[152:155], v[68:71]
    v_mfma_f32_16x16x32_bf16 v[80:83], v[48:51], v[156:159], v[80:83]
    ds_read_b64_tr_b16 v[48:49], v29 offset:38944
    ds_read_b64_tr_b16 v[50:51], v29 offset:40480
    s_waitcnt lgkmcnt(10)
    v_mfma_f32_16x16x32_bf16 v[72:75], v[52:55], v[152:155], v[72:75]
    v_mfma_f32_16x16x32_bf16 v[84:87], v[52:55], v[156:159], v[84:87]
    ds_read_b64_tr_b16 v[52:53], v29 offset:38976
    ds_read_b64_tr_b16 v[54:55], v29 offset:40512
    s_cmp_lg_u32 s3, 4
    s_cbranch_scc1 L_g2t4
    s_add_u32 s62, s61, 0
    buffer_load_dword v10, v9, s[24:27], s62 offen
L_g2t4:
    s_waitcnt lgkmcnt(10)
    v_mfma_f32_16x16x32_bf16 v[64:67], v[32:35], v[160:163], v[64:67]
    v_mfma_f32_16x16x32_bf16 v[76:79], v[32:35], v[164:167], v[76:79]
    ds_read_b64_tr_b16 v[32:33], v29 offset:45056
    ds_read_b64_tr_b16 v[34:35], v29 offset:46592
    s_waitcnt lgkmcnt(10)
    v_mfma_f32_16x16x32_bf16 v[68:71], v[36:39], v[160:163], v[68:71]
    v_mfma_f32_16x16x32_bf16 v[80:83], v[36:39], v[164:167], v[80:83]
    ds_read_b64_tr_b16 v[36:37], v29 offset:45088
    ds_read_b64_tr_b16 v[38:39], v29 offset:46624
    s_waitcnt lgkmcnt(10)
    v_mfma_f32_16x16x32_bf16 v[72:75], v[40:43], v[160:163], v[72:75]
    v_mfma_f32_16x16x32_bf16 v[84:87], v[40:43], v[164:167], v[84:87]
    ds_read_b64_tr_b16 v[40:41], v29 offset:45120
    ds_read_b64_tr_b16 v[42:43], v29 offset:46656
    s_cmp_lg_u32 s3, 5
    s_cbranch_scc1 L_g2t5
    s_add_u32 s62, s61, 491520
    buffer_load_dword v10, v9, s[24:27], s62 offen
L_g2t5:
    s_waitcnt lgkmcnt(10)
    v_mfma_f32_16x16x32_bf16 v[64:67], v[44:47], v[168:171], v[64:67]
    v_mfma_f32_16x16x32_bf16 v[76:79], v[44:47], v[172:175], v[76:79]
    ds_read_b64_tr_b16 v[44:45], v29 offset:51200
    ds_read_b64_tr_b16 v[46:47], v29 offset:52736
    s_waitcnt lgkmcnt(10)
    v_mfma_f32_16x16x32_bf16 v[68:71], v[48:51], v[168:171], v[68:71]
    v_mfma_f32_16x16x32_bf16 v[80:83], v[48:51], v[172:175], v[80:83]
    ds_read_b64_tr_b16 v[48:49], v29 offset:51232
    ds_read_b64_tr_b16 v[50:51], v29 offset:52768
    s_waitcnt lgkmcnt(10)
    v_mfma_f32_16x16x32_bf16 v[72:75], v[52:55], v[168:171], v[72:75]
    v_mfma_f32_16x16x32_bf16 v[84:87], v[52:55], v[172:175], v[84:87]
    ds_read_b64_tr_b16 v[52:53], v29 offset:51264
    ds_read_b64_tr_b16 v[54:55], v29 offset:52800
    s_waitcnt lgkmcnt(10)
    v_mfma_f32_16x16x32_bf16 v[64:67], v[32:35], v[176:179], v[64:67]
    v_mfma_f32_16x16x32_bf16 v[76:79], v[32:35], v[180:183], v[76:79]
    ds_read_b64_tr_b16 v[32:33], v28 offset:0
    ds_read_b64_tr_b16 v[34:35], v28 offset:1536
    s_waitcnt lgkmcnt(10)
    v_mfma_f32_16x16x32_bf16 v[68:71], v[36:39], v[176:179], v[68:71]
    v_mfma_f32_16x16x32_bf16 v[80:83], v[36:39], v[180:183], v[80:83]
    ds_read_b64_tr_b16 v[36:37], v28 offset:32
    ds_read_b64_tr_b16 v[38:39], v28 offset:1568
    s_waitcnt lgkmcnt(10)
    v_mfma_f32_16x16x32_bf16 v[72:75], v[40:43], v[176:179], v[72:75]
    v_mfma_f32_16x16x32_bf16 v[84:87], v[40:43], v[180:183], v[84:87]
    ds_read_b64_tr_b16 v[40:41], v28 offset:64
    ds_read_b64_tr_b16 v[42:43], v28 offset:1600
    s_waitcnt lgkmcnt(10)
    v_mfma_f32_16x16x32_bf16 v[64:67], v[44:47], v[184:187], v[64:67]
    v_mfma_f32_16x16x32_bf16 v[76:79], v[44:47], v[188:191], v[76:79]
    ds_read_b64_tr_b16 v[44:45], v28 offset:6144
    ds_read_b64_tr_b16 v[46:47], v28 offset:7680
    s_waitcnt lgkmcnt(10)
    v_mfma_f32_16x16x32_bf16 v[68:71], v[48:51], v[184:187], v[68:71]
    v_mfma_f32_16x16x32_bf16 v[80:83], v[48:51], v[188:191], v[80:83]
    ds_read_b64_tr_b16 v[48:49], v28 offset:6176
    ds_read_b64_tr_b16 v[50:51], v28 offset:7712
    s_waitcnt lgkmcnt(10)
    v_mfma_f32_16x16x32_bf16 v[72:75], v[52:55], v[184:187], v[72:75]
    v_mfma_f32_16x16x32_bf16 v[84:87], v[52:55], v[188:191], v[84:87]
    ds_read_b64_tr_b16 v[52:53], v28 offset:6208
    ds_read_b64_tr_b16 v[54:55], v28 offset:7744
    s_waitcnt lgkmcnt(10)
    v_mfma_f32_16x16x32_bf16 v[64:67], v[32:35], v[192:195], v[64:67]
    v_mfma_f32_16x16x32_bf16 v[76:79], v[32:35], v[196:199], v[76:79]
    ds_read_b64_tr_b16 v[32:33], v28 offset:12288
    ds_read_b64_tr_b16 v[34:35], v28 offset:13824
    s_waitcnt lgkmcnt(10)
    v_mfma_f32_16x16x32_bf16 v[68:71], v[36:39], v[192:195], v[68:71]
    v_mfma_f32_16x16x32_bf16 v[80:83], v[36:39], v[196:199], v[80:83]
    ds_read_b64_tr_b16 v[36:37], v28 offset:12320
    ds_read_b64_tr_b16 v[38:39], v28 offset:13856
    s_waitcnt lgkmcnt(10)
    v_mfma_f32_16x16x32_bf16 v[72:75], v[40:43], v[192:195], v[72:75]
    v_mfma_f32_16x16x32_bf16 v[84:87], v[40:43], v[196:199], v[84:87]
    ds_read_b64_tr_b16 v[40:41], v28 offset:12352
    ds_read_b64_tr_b16 v[42:43], v28 offset:13888
    s_waitcnt lgkmcnt(10)
    v_mfma_f32_16x16x32_bf16 v[64:67], v[44:47], v[200:203], v[64:67]
    v_mfma_f32_16x16x32_bf16 v[76:79], v[44:47], v[204:207], v[76:79]
    ds_read_b64_tr_b16 v[44:45], v28 offset:18432
    ds_read_b64_tr_b16 v[46:47], v28 offset:19968
    s_waitcnt lgkmcnt(10)
    v_mfma_f32_16x16x32_bf16 v[68:71], v[48:51], v[200:203], v[68:71]
    v_mfma_f32_16x16x32_bf16 v[80:83], v[48:51], v[204:207], v[80:83]
    ds_read_b64_tr_b16 v[48:49], v28 offset:18464
    ds_read_b64_tr_b16 v[50:51], v28 offset:20000
    s_waitcnt lgkmcnt(10)
    v_mfma_f32_16x16x32_bf16 v[72:75], v[52:55], v[200:203], v[72:75]
    v_mfma_f32_16x16x32_bf16 v[84:87], v[52:55], v[204:207], v[84:87]
    ds_read_b64_tr_b16 v[52:53], v28 offset:18496
    ds_read_b64_tr_b16 v[54:55], v28 offset:20032
    s_waitcnt vmcnt(0)
    s_barrier
    s_waitcnt lgkmcnt(10)
    v_mfma_f32_16x16x32_bf16 v[64:67], v[32:35], v[208:211], v[64:67]
    v_mfma_f32_16x16x32_bf16 v[76:79], v[32:35], v[212:215], v[76:79]
    ds_read_b64_tr_b16 v[32:33], v28 offset:32768
    ds_read_b64_tr_b16 v[34:35], v28 offset:34304
    s_waitcnt lgkmcnt(10)
    v_mfma_f32_16x16x32_bf16 v[68:71], v[36:39], v[208:211], v[68:71]
    v_mfma_f32_16x16x32_bf16 v[80:83], v[36:39], v[212:215], v[80:83]
    ds_read_b64_tr_b16 v[36:37], v28 offset:32800
    ds_read_b64_tr_b16 v[38:39], v28 offset:34336
    s_waitcnt lgkmcnt(10)
    v_mfma_f32_16x16x32_bf16 v[72:75], v[40:43], v[208:211], v[72:75]
    v_mfma_f32_16x16x32_bf16 v[84:87], v[40:43], v[212:215], v[84:87]
    ds_read_b64_tr_b16 v[40:41], v28 offset:32832
    ds_read_b64_tr_b16 v[42:43], v28 offset:34368
    s_waitcnt lgkmcnt(10)
    v_mfma_f32_16x16x32_bf16 v[64:67], v[44:47], v[216:219], v[64:67]
    v_mfma_f32_16x16x32_bf16 v[76:79], v[44:47], v[220:223], v[76:79]
    ds_read_b64_tr_b16 v[44:45], v28 offset:38912
    ds_read_b64_tr_b16 v[46:47], v28 offset:40448
    s_waitcnt lgkmcnt(10)
    v_mfma_f32_16x16x32_bf16 v[68:71], v[48:51], v[216:219], v[68:71]
    v_mfma_f32_16x16x32_bf16 v[80:83], v[48:51], v[220:223], v[80:83]
    ds_read_b64_tr_b16 v[48:49], v28 offset:38944
    ds_read_b64_tr_b16 v[50:51], v28 offset:40480
    s_waitcnt lgkmcnt(10)
    v_mfma_f32_16x16x32_bf16 v[72:75], v[52:55], v[216:219], v[72:75]
    v_mfma_f32_16x16x32_bf16 v[84:87], v[52:55], v[220:223], v[84:87]
    ds_read_b64_tr_b16 v[52:53], v28 offset:38976
    ds_read_b64_tr_b16 v[54:55], v28 offset:40512
    s_waitcnt lgkmcnt(10)
    v_mfma_f32_16x16x32_bf16 v[64:67], v[32:35], v[224:227], v[64:67]
    v_mfma_f32_16x16x32_bf16 v[76:79], v[32:35], v[228:231], v[76:79]
    ds_read_b64_tr_b16 v[32:33], v28 offset:45056
    ds_read_b64_tr_b16 v[34:35], v28 offset:46592
    s_waitcnt lgkmcnt(10)
    v_mfma_f32_16x16x32_bf16 v[68:71], v[36:39], v[224:227], v[68:71]
    v_mfma_f32_16x16x32_bf16 v[80:83], v[36:39], v[228:231], v[80:83]
    ds_read_b64_tr_b16 v[36:37], v28 offset:45088
    ds_read_b64_tr_b16 v[38:39], v28 offset:46624
    s_waitcnt lgkmcnt(10)
    v_mfma_f32_16x16x32_bf16 v[72:75], v[40:43], v[224:227], v[72:75]
    v_mfma_f32_16x16x32_bf16 v[84:87], v[40:43], v[228:231], v[84:87]
    ds_read_b64_tr_b16 v[40:41], v28 offset:45120
    ds_read_b64_tr_b16 v[42:43], v28 offset:46656
    s_waitcnt lgkmcnt(10)
    v_mfma_f32_16x16x32_bf16 v[64:67], v[44:47], v[232:235], v[64:67]
    v_mfma_f32_16x16x32_bf16 v[76:79], v[44:47], v[236:239], v[76:79]
    ds_read_b64_tr_b16 v[44:45], v28 offset:51200
    ds_read_b64_tr_b16 v[46:47], v28 offset:52736
    s_waitcnt lgkmcnt(10)
    v_mfma_f32_16x16x32_bf16 v[68:71], v[48:51], v[232:235], v[68:71]
    v_mfma_f32_16x16x32_bf16 v[80:83], v[48:51], v[236:239], v[80:83]
    ds_read_b64_tr_b16 v[48:49], v28 offset:51232
    ds_read_b64_tr_b16 v[50:51], v28 offset:52768
    s_waitcnt lgkmcnt(10)
    v_mfma_f32_16x16x32_bf16 v[72:75], v[52:55], v[232:235], v[72:75]
    v_mfma_f32_16x16x32_bf16 v[84:87], v[52:55], v[236:239], v[84:87]
    ds_read_b64_tr_b16 v[52:53], v28 offset:51264
    ds_read_b64_tr_b16 v[54:55], v28 offset:52800
    s_waitcnt lgkmcnt(10)
    v_mfma_f32_16x16x32_bf16 v[64:67], v[32:35], v[240:243], v[64:67]
    v_mfma_f32_16x16x32_bf16 v[76:79], v[32:35], v[244:247], v[76:79]
    s_waitcnt lgkmcnt(8)
    v_mfma_f32_16x16x32_bf16 v[68:71], v[36:39], v[240:243], v[68:71]
    v_mfma_f32_16x16x32_bf16 v[80:83], v[36:39], v[244:247], v[80:83]
    s_waitcnt lgkmcnt(6)
    v_mfma_f32_16x16x32_bf16 v[72:75], v[40:43], v[240:243], v[72:75]
    v_mfma_f32_16x16x32_bf16 v[84:87], v[40:43], v[244:247], v[84:87]
    s_waitcnt lgkmcnt(4)
    v_mfma_f32_16x16x32_bf16 v[64:67], v[44:47], v[248:251], v[64:67]
    v_mfma_f32_16x16x32_bf16 v[76:79], v[44:47], v[252:255], v[76:79]
    s_waitcnt lgkmcnt(2)
    v_mfma_f32_16x16x32_bf16 v[68:71], v[48:51], v[248:251], v[68:71]
    v_mfma_f32_16x16x32_bf16 v[80:83], v[48:51], v[252:255], v[80:83]
    s_waitcnt lgkmcnt(0)
    v_mfma_f32_16x16x32_bf16 v[72:75], v[52:55], v[248:251], v[72:75]
    v_mfma_f32_16x16x32_bf16 v[84:87], v[52:55], v[252:255], v[84:87]
    s_lshl_b32 s64, s93, 2
    s_and_b32 s65, s3, 3
    s_add_u32 s64, s64, s65
    s_mul_i32 s64, s64, 96
    s_mul_i32 s65, s94, 6
    s_add_u32 s64, s64, s65
    s_lshr_b32 s65, s3, 2
    s_mul_i32 s65, s65, 3
    s_add_u32 s64, s64, s65
    s_lshl_b32 s64, s64, 10
    s_add_u32 s64, s64, 8388608
    v_max_f32 v64, 0, v64
    v_max_f32 v65, 0, v65
    v_max_f32 v66, 0, v66
    v_max_f32 v67, 0, v67
    v_cvt_pk_bf16_f32 v32, v64, v65
    v_cvt_pk_bf16_f32 v33, v66, v67
    v_max_f32 v76, 0, v76
    v_max_f32 v77, 0, v77
    v_max_f32 v78, 0, v78
    v_max_f32 v79, 0, v79
    v_cvt_pk_bf16_f32 v34, v76, v77
    v_cvt_pk_bf16_f32 v35, v78, v79
    buffer_store_dwordx4 v[32:35], v30, s[36:39], s64 offen offset:0 sc1
    v_max_f32 v68, 0, v68
    v_max_f32 v69, 0, v69
    v_max_f32 v70, 0, v70
    v_max_f32 v71, 0, v71
    v_cvt_pk_bf16_f32 v36, v68, v69
    v_cvt_pk_bf16_f32 v37, v70, v71
    v_max_f32 v80, 0, v80
    v_max_f32 v81, 0, v81
    v_max_f32 v82, 0, v82
    v_max_f32 v83, 0, v83
    v_cvt_pk_bf16_f32 v38, v80, v81
    v_cvt_pk_bf16_f32 v39, v82, v83
    buffer_store_dwordx4 v[36:39], v30, s[36:39], s64 offen offset:1024 sc1
    v_max_f32 v72, 0, v72
    v_max_f32 v73, 0, v73
    v_max_f32 v74, 0, v74
    v_max_f32 v75, 0, v75
    v_cvt_pk_bf16_f32 v40, v72, v73
    v_cvt_pk_bf16_f32 v41, v74, v75
    v_max_f32 v84, 0, v84
    v_max_f32 v85, 0, v85
    v_max_f32 v86, 0, v86
    v_max_f32 v87, 0, v87
    v_cvt_pk_bf16_f32 v42, v84, v85
    v_cvt_pk_bf16_f32 v43, v86, v87
    buffer_store_dwordx4 v[40:43], v30, s[36:39], s64 offen offset:2048 sc1
    s_barrier
    s_cmp_ge_u32 s3, 4
    s_cbranch_scc1 L_G2ROLE
    s_setprio 2
    s_sub_i32 s64, s93, 2
    s_max_i32 s64, s64, 0
    s_lshl_b32 s64, s64, 4
    v_lshlrev_b32 v30, 4, v1
    s_lshr_b32 s65, s3, 1
    s_mul_i32 s65, s65, 160
    s_add_u32 s65, s65, 160
    s_mul_i32 s70, s94, 10
    s_add_u32 s65, s65, s70
    s_and_b32 s70, s3, 1
    s_mul_i32 s70, s70, 5
    s_add_u32 s65, s65, s70
    s_mul_i32 s65, s65, 16640
    s_mul_i32 s66, s3, 15520
    s_add_u32 s66, s66, 98304
    s_add_u32 s70, s93, 0
    s_sub_i32 s70, s70, 2
    s_lshl_b32 s71, s70, 10
    s_add_u32 s71, s71, s65
    s_cmp_lt_i32 s70, 0
    s_cselect_b32 s67, 0x7ff00000, s71
    s_cselect_b32 s60, 0, 16640
    s_add_u32 s70, s93, 1
    s_sub_i32 s70, s70, 2
    s_lshl_b32 s71, s70, 10
    s_add_u32 s71, s71, s65
    s_cmp_lt_i32 s70, 0
    s_cselect_b32 s68, 0x7ff00000, s71
    s_cselect_b32 s61, 0, 16640
    s_add_u32 s70, s93, 2
    s_sub_i32 s70, s70, 2
    s_lshl_b32 s71, s70, 10
    s_add_u32 s71, s71, s65
    s_cmp_lt_i32 s70, 0
    s_cselect_b32 s69, 0x7ff00000, s71
    s_cselect_b32 s62, 0, 16640
    s_mov_b32 s59, s64
    s_waitcnt vmcnt(0)
    v_mov_b32 v8, 163460
    v_mov_b32 v9, 1
    s_mov_b64 exec, 1
    ds_add_rtn_u32 v10, v8, v9
    s_waitcnt lgkmcnt(0)
    v_readfirstlane_b32 s64, v10
    s_mov_b64 exec, -1
    s_cmp_lg_u32 s64, 7
    s_cbranch_scc1 L_csB1
    v_mov_b32 v9, 163480
    ds_read_b32 v8, v9
    s_lshl_b32 s64, s92, 7
    s_add_u32 s64, s64, 18907136
    v_mov_b32 v9, s64
    s_waitcnt lgkmcnt(0)
    s_mov_b64 exec, 1
    buffer_store_dword v8, v9, s[36:39], 0 offen sc1
    s_mov_b64 exec, -1
L_csB1:
    s_cmp_lg_u32 s3, 0
    s_cbranch_scc1 L_pbwKV
    v_mov_b32 v8, 163480
    ds_read_b32 v9, v8
    v_cmp_gt_u32 vcc, 48, v1
    s_nop 1
    v_cndmask_b32 v8, 0, v1, vcc
    v_add_u32 v8, s59, v8
    v_lshlrev_b32 v8, 7, v8
    v_add_u32 v8, 18874368, v8
    s_waitcnt lgkmcnt(0)
    v_readfirstlane_b32 s85, v9
L_pollKV:
    buffer_load_dword v9, v8, s[36:39], 0 offen sc1
    s_waitcnt vmcnt(0)
    v_cmp_ne_u32 vcc, s85, v9
    s_nop 0
    s_cmp_eq_u64 vcc, 0
    s_cbranch_scc1 L_polldKV
    s_sleep 2
    s_branch L_pollKV
L_polldKV:
    v_mov_b32 v8, 163468
    v_mov_b32 v9, 1
    ds_write_b32 v8, v9
    s_waitcnt lgkmcnt(0)
    s_branch L_pbdKV
L_pbwKV:
    v_mov_b32 v8, 163468
L_pbsKV:
    ds_read_b32 v9, v8
    s_waitcnt lgkmcnt(0)
    v_readfirstlane_b32 s64, v9
    s_nop 0
    s_cmp_lg_u32 s64, 0
    s_cbranch_scc1 L_pbdKV
    s_sleep 1
    s_branch L_pbsKV
L_pbdKV:
    s_add_u32 m0, s66, 0
    s_nop 0
    buffer_load_dwordx4 v30, s[36:39], s67 offen sc1 lds
    s_add_u32 s67, s67, s60
    s_add_u32 m0, s66, 1024
    s_nop 0
    buffer_load_dwordx4 v30, s[36:39], s68 offen sc1 lds
    s_add_u32 s68, s68, s61
    s_add_u32 m0, s66, 2048
    s_nop 0
    buffer_load_dwordx4 v30, s[36:39], s69 offen sc1 lds
    s_add_u32 s69, s69, s62
    s_add_u32 m0, s66, 3104
    s_nop 0
    buffer_load_dwordx4 v30, s[36:39], s67 offen sc1 lds
    s_add_u32 s67, s67, s60
    s_add_u32 m0, s66, 4128
    s_nop 0
    buffer_load_dwordx4 v30, s[36:39], s68 offen sc1 lds
    s_add_u32 s68, s68, s61
    s_add_u32 m0, s66, 5152
    s_nop 0
    buffer_load_dwordx4 v30, s[36:39], s69 offen sc1 lds
    s_add_u32 s69, s69, s62
    s_add_u32 m0, s66, 6208
    s_nop 0
    buffer_load_dwordx4 v30, s[36:39], s67 offen sc1 lds
    s_add_u32 s67, s67, s60
    s_add_u32 m0, s66, 7232
    s_nop 0
    buffer_load_dwordx4 v30, s[36:39], s68 offen sc1 lds
    s_add_u32 s68, s68, s61
    s_add_u32 m0, s66, 8256
    s_nop 0
    buffer_load_dwordx4 v30, s[36:39], s69 offen sc1 lds
    s_add_u32 s69, s69, s62
    s_add_u32 m0, s66, 9312
    s_nop 0
    buffer_load_dwordx4 v30, s[36:39], s67 offen sc1 lds
    s_add_u32 s67, s67, s60
    s_add_u32 m0, s66, 10336
    s_nop 0
    buffer_load_dwordx4 v30, s[36:39], s68 offen sc1 lds
    s_add_u32 s68, s68, s61
    s_add_u32 m0, s66, 11360
    s_nop 0
    buffer_load_dwordx4 v30, s[36:39], s69 offen sc1 lds
    s_add_u32 s69, s69, s62
    s_add_u32 m0, s66, 12416
    s_nop 0
    buffer_load_dwordx4 v30, s[36:39], s67 offen sc1 lds
    s_add_u32 s67, s67, s60
    s_add_u32 m0, s66, 13440
    s_nop 0
    buffer_load_dwordx4 v30, s[36:39], s68 offen sc1 lds
    s_add_u32 s68, s68, s61
    s_add_u32 m0, s66, 14464
    s_nop 0
    buffer_load_dwordx4 v30, s[36:39], s69 offen sc1 lds
    s_add_u32 s69, s69, s62
    s_lshl_b32 s74, s93, 7
    s_lshl_b32 s70, s3, 5
    s_add_u32 s74, s74, s70
    v_and_b32 v5, 31, v1
    v_lshrrev_b32 v6, 5, v1
    v_add_u32 v7, s74, v5
    v_lshlrev_b32 v8, 3, v7
    v_mul_u32_u24 v9, 33280, v6
    v_add_u32 v9, v9, v8
    v_add_u32 v10, 66560, v8
    v_cmp_eq_u32 vcc, 0, v6
    v_mov_b32 v11, 0x7fffff00
    s_nop 0
    v_cndmask_b32 v10, v11, v10, vcc
    s_mul_i32 s70, s94, 166400
    s_add_u32 s70, s70, 0
    s_add_u32 s71, s70, 16640
    buffer_load_dwordx2 v[104:105], v9, s[36:39], s70 offen sc1
    buffer_load_dwordx2 v[106:107], v9, s[36:39], s71 offen sc1
    buffer_load_dwordx2 v[108:109], v10, s[36:39], s70 offen sc1
    s_add_u32 s70, s70, 83200
    s_add_u32 s71, s70, 16640
    buffer_load_dwordx2 v[232:233], v9, s[36:39], s70 offen sc1
    buffer_load_dwordx2 v[234:235], v9, s[36:39], s71 offen sc1
    buffer_load_dwordx2 v[236:237], v10, s[36:39], s70 offen sc1
    s_add_u32 s70, s70, 83200
    v_lshlrev_b32 v12, 2, v7
    s_mov_b32 s70, 17825792
    buffer_load_dword v13, v12, s[36:39], s70 offen sc1
    v_mov_b32 v11, 0x3f80
    v_cndmask_b32 v110, 0, v11, vcc
    v_mov_b32 v111, 0
    v_cndmask_b32 v238, 0, v11, vcc
    v_mov_b32 v239, 0
    s_lshl_b32 s70, s3, 8
    s_add_u32 s70, s70, 98304
    v_lshlrev_b32 v19, 3, v5
    v_add_u32 v19, s70, v19
    v_add_u32 v20, 12416, v19
    v_mul_u32_u24 v21, 6208, v6
    v_add_u32 v19, v19, v21
    v_lshlrev_b32 v14, 2, v6
    v_sub_u32 v14, v5, v14
    v_cmp_le_i32 s[40:41], 0, v14
    v_cmp_le_i32 s[42:43], 1, v14
    v_cmp_le_i32 s[44:45], 2, v14
    v_cmp_le_i32 s[46:47], 3, v14
    v_cmp_le_i32 s[48:49], 8, v14
    v_cmp_le_i32 s[50:51], 9, v14
    v_cmp_le_i32 s[52:53], 10, v14
    v_cmp_le_i32 s[54:55], 11, v14
    v_cmp_le_i32 s[56:57], 16, v14
    v_cmp_le_i32 s[58:59], 17, v14
    v_cmp_le_i32 s[76:77], 18, v14
    v_cmp_le_i32 s[78:79], 19, v14
    v_cmp_le_i32 s[80:81], 24, v14
    v_cmp_le_i32 s[82:83], 25, v14
    v_cmp_le_i32 s[84:85], 26, v14
    v_cmp_le_i32 s[86:87], 27, v14
    v_mov_b32 v15, 0xffff
    v_mov_b32 v16, 0xffff0000
    v_cndmask_b32 v17, 0, v15, s[40:41]
    v_cndmask_b32 v18, 0, v16, s[42:43]
    v_or_b32 v224, v17, v18
    v_cndmask_b32 v17, 0, v15, s[44:45]
    v_cndmask_b32 v18, 0, v16, s[46:47]
    v_or_b32 v225, v17, v18
    v_cndmask_b32 v17, 0, v15, s[48:49]
    v_cndmask_b32 v18, 0, v16, s[50:51]
    v_or_b32 v226, v17, v18
    v_cndmask_b32 v17, 0, v15, s[52:53]
    v_cndmask_b32 v18, 0, v16, s[54:55]
    v_or_b32 v227, v17, v18
    v_cndmask_b32 v17, 0, v15, s[56:57]
    v_cndmask_b32 v18, 0, v16, s[58:59]
    v_or_b32 v228, v17, v18
    v_cndmask_b32 v17, 0, v15, s[76:77]
    v_cndmask_b32 v18, 0, v16, s[78:79]
    v_or_b32 v229, v17, v18
    v_cndmask_b32 v17, 0, v15, s[80:81]
    v_cndmask_b32 v18, 0, v16, s[82:83]
    v_or_b32 v230, v17, v18
    v_cndmask_b32 v17, 0, v15, s[84:85]
    v_cndmask_b32 v18, 0, v16, s[86:87]
    v_or_b32 v231, v17, v18
    s_lshr_b32 s75, s74, 5
    s_sub_i32 s75, 8, s75
    s_max_i32 s75, s75, 0
    s_cmp_gt_u32 s75, 0
    s_cselect_b32 s70, 0xf149, 0
    v_mov_b32 v38, s70
    v_mov_b32 v39, 0
    s_cmp_gt_u32 s75, 1
    s_cselect_b32 s70, 0xf149, 0
    v_mov_b32 v46, s70
    v_mov_b32 v47, 0
    s_cmp_gt_u32 s75, 2
    s_cselect_b32 s70, 0xf149, 0
    v_mov_b32 v54, s70
    v_mov_b32 v55, 0
    s_cmp_gt_u32 s75, 3
    s_cselect_b32 s70, 0xf149, 0
    v_mov_b32 v62, s70
    v_mov_b32 v63, 0
    s_cmp_gt_u32 s75, 4
    s_cselect_b32 s70, 0xf149, 0
    v_mov_b32 v70, s70
    v_mov_b32 v71, 0
    s_cmp_gt_u32 s75, 5
    s_cselect_b32 s70, 0xf149, 0
    v_mov_b32 v78, s70
    v_mov_b32 v79, 0
    s_cmp_gt_u32 s75, 6
    s_cselect_b32 s70, 0xf149, 0
    v_mov_b32 v86, s70
    v_mov_b32 v87, 0
    s_cmp_gt_u32 s75, 7
    s_cselect_b32 s70, 0xf149, 0
    v_mov_b32 v94, s70
    v_mov_b32 v95, 0
    s_cmp_gt_u32 s75, 8
    s_cselect_b32 s70, 0xf149, 0
    v_mov_b32 v102, s70
    v_mov_b32 v103, 0
    s_lshl_b32 s70, s3, 8
    s_add_u32 s70, s70, 98304
    v_bfe_u32 v21, v1, 4, 1
    v_bfe_u32 v22, v1, 2, 2
    v_and_b32 v23, 3, v1
    v_lshl_add_u32 v23, v21, 2, v23
    v_lshl_add_u32 v22, v6, 2, v22
    v_lshlrev_b32 v22, 3, v22
    v_add_u32 v22, s70, v22
    v_cmp_gt_u32 vcc, 5, v23
    v_add_u32 v24, 10, v23
    v_mov_b32 v25, 20
    v_cndmask_b32 v24, v25, v24, vcc
    v_add_u32 v26, 15, v23
    v_cndmask_b32 v26, v25, v26, vcc
    v_mul_u32_u24 v24, 3104, v24
    v_mul_u32_u24 v26, 3104, v26
    v_add_u32 v23, v22, v26
    v_add_u32 v22, v22, v24
    s_mul_i32 s70, s3, 2560
    s_add_u32 s70, s70, 81920
    v_mul_u32_u24 v24, 80, v5
    v_add_u32 v24, s70, v24
    v_lshl_add_u32 v24, v6, 3, v24
    s_waitcnt vmcnt(7)
    v_mov_b32 v8, 163464
    v_mov_b32 v9, 1
    s_mov_b64 exec, 1
    ds_add_u32 v8, v9
    s_mov_b64 exec, -1
L_kvsync:
    ds_read_b32 v9, v8
    s_waitcnt lgkmcnt(0)
    v_readfirstlane_b32 s70, v9
    s_nop 0
    s_cmp_lt_u32 s70, 4
    s_cbranch_scc1 L_kvsync
    ds_read_b64 v[32:33], v19 offset:0
    ds_read_b64 v[34:35], v19 offset:3104
    ds_read_b64 v[36:37], v20 offset:0
    ds_read_b64 v[96:97], v19 offset:2048
    ds_read_b64 v[98:99], v19 offset:5152
    ds_read_b64 v[100:101], v20 offset:2048
    ds_read_b64 v[40:41], v19 offset:256
    ds_read_b64 v[42:43], v19 offset:3360
    ds_read_b64 v[44:45], v20 offset:256
    ds_read_b64 v[48:49], v19 offset:512
    ds_read_b64 v[50:51], v19 offset:3616
    ds_read_b64 v[52:53], v20 offset:512
    ds_read_b64 v[56:57], v19 offset:768
    ds_read_b64 v[58:59], v19 offset:3872
    ds_read_b64 v[60:61], v20 offset:768
    ds_read_b64 v[64:65], v19 offset:1024
    ds_read_b64 v[66:67], v19 offset:4128
    ds_read_b64 v[68:69], v20 offset:1024
    ds_read_b64 v[72:73], v19 offset:1280
    ds_read_b64 v[74:75], v19 offset:4384
    ds_read_b64 v[76:77], v20 offset:1280
    ds_read_b64 v[80:81], v19 offset:1536
    ds_read_b64 v[82:83], v19 offset:4640
    ds_read_b64 v[84:85], v20 offset:1536
    ds_read_b64 v[88:89], v19 offset:1792
    ds_read_b64 v[90:91], v19 offset:4896
    ds_read_b64 v[92:93], v20 offset:1792
    s_waitcnt vmcnt(4)
    s_waitcnt lgkmcnt(0)
    v_mfma_f32_32x32x16_bf16 v[112:127], v[32:35], v[104:107], 0
    v_mfma_f32_32x32x16_bf16 v[112:127], v[36:39], v[108:111], v[112:127]
    v_mfma_f32_32x32x16_bf16 v[128:143], v[96:99], v[104:107], 0
    v_mfma_f32_32x32x16_bf16 v[128:143], v[100:103], v[108:111], v[128:143]
    ds_read_b64_tr_b16 v[192:193], v22 offset:0
    ds_read_b64_tr_b16 v[194:195], v22 offset:64
    ds_read_b64_tr_b16 v[196:197], v22 offset:128
    ds_read_b64_tr_b16 v[198:199], v22 offset:192
    ds_read_b64_tr_b16 v[200:201], v22 offset:2048
    ds_read_b64_tr_b16 v[202:203], v22 offset:2112
    ds_read_b64_tr_b16 v[204:205], v22 offset:2176
    ds_read_b64_tr_b16 v[206:207], v22 offset:2240
    s_nop 3
    v_cndmask_b32 v112, v112, v128, s[40:41]
    v_cndmask_b32 v113, v113, v129, s[42:43]
    v_cndmask_b32 v114, v114, v130, s[44:45]
    v_cndmask_b32 v115, v115, v131, s[46:47]
    v_cndmask_b32 v116, v116, v132, s[48:49]
    v_cndmask_b32 v117, v117, v133, s[50:51]
    v_cndmask_b32 v118, v118, v134, s[52:53]
    v_cndmask_b32 v119, v119, v135, s[54:55]
    v_cndmask_b32 v120, v120, v136, s[56:57]
    v_cndmask_b32 v121, v121, v137, s[58:59]
    v_cndmask_b32 v122, v122, v138, s[76:77]
    v_cndmask_b32 v123, v123, v139, s[78:79]
    v_cndmask_b32 v124, v124, v140, s[80:81]
    v_cndmask_b32 v125, v125, v141, s[82:83]
    v_cndmask_b32 v126, v126, v142, s[84:85]
    v_cndmask_b32 v127, v127, v143, s[86:87]
    v_max_f32 v28, v112, v113
    v_max3_f32 v28, v28, v114, v115
    v_max3_f32 v28, v28, v116, v117
    v_max3_f32 v28, v28, v118, v119
    v_max3_f32 v28, v28, v120, v121
    v_max3_f32 v28, v28, v122, v123
    v_max3_f32 v28, v28, v124, v125
    v_max3_f32 v28, v28, v126, v127
    v_mov_b32 v29, v28
    v_mov_b32 v30, v28
    s_nop 1
    v_permlane32_swap_b32 v29, v30
    v_max_f32 v28, v29, v30
    v_sub_f32 v28, 0, v28
    v_mov_b32 v160, v28
    v_mov_b32 v161, v28
    v_mov_b32 v162, v28
    v_mov_b32 v163, v28
    v_mov_b32 v164, v28
    v_mov_b32 v165, v28
    v_mov_b32 v166, v28
    v_mov_b32 v167, v28
    v_mov_b32 v168, v28
    v_mov_b32 v169, v28
    v_mov_b32 v170, v28
    v_mov_b32 v171, v28
    v_mov_b32 v172, v28
    v_mov_b32 v173, v28
    v_mov_b32 v174, v28
    v_mov_b32 v175, v28
    s_nop 1
    v_mfma_f32_32x32x16_bf16 v[144:159], v[40:43], v[104:107], v[160:175]
    v_mfma_f32_32x32x16_bf16 v[144:159], v[44:47], v[108:111], v[144:159]
    v_add_f32 v112, v112, v28
    v_add_f32 v113, v113, v28
    v_add_f32 v114, v114, v28
    v_add_f32 v115, v115, v28
    v_add_f32 v116, v116, v28
    v_add_f32 v117, v117, v28
    v_add_f32 v118, v118, v28
    v_add_f32 v119, v119, v28
    v_add_f32 v120, v120, v28
    v_add_f32 v121, v121, v28
    v_add_f32 v122, v122, v28
    v_add_f32 v123, v123, v28
    v_add_f32 v124, v124, v28
    v_add_f32 v125, v125, v28
    v_add_f32 v126, v126, v28
    v_add_f32 v127, v127, v28
    v_exp_f32 v112, v112
    v_exp_f32 v113, v113
    v_mfma_f32_32x32x16_bf16 v[128:143], v[48:51], v[104:107], v[160:175]
    v_exp_f32 v114, v114
    v_exp_f32 v115, v115
    v_cvt_pk_bf16_f32 v176, v112, v113
    v_cvt_pk_bf16_f32 v177, v114, v115
    v_exp_f32 v116, v116
    v_exp_f32 v117, v117
    v_exp_f32 v118, v118
    v_exp_f32 v119, v119
    v_mfma_f32_32x32x16_bf16 v[128:143], v[52:55], v[108:111], v[128:143]
    v_cvt_pk_bf16_f32 v178, v116, v117
    v_cvt_pk_bf16_f32 v179, v118, v119
    v_exp_f32 v120, v120
    v_exp_f32 v121, v121
    v_exp_f32 v122, v122
    v_exp_f32 v123, v123
    v_cvt_pk_bf16_f32 v180, v120, v121
    v_cvt_pk_bf16_f32 v181, v122, v123
    v_exp_f32 v124, v124
    v_exp_f32 v125, v125
    v_exp_f32 v126, v126
    v_exp_f32 v127, v127
    v_cvt_pk_bf16_f32 v182, v124, v125
    v_cvt_pk_bf16_f32 v183, v126, v127
    v_and_b32 v184, v176, v224
    v_xor_b32 v176, v176, v184
    v_and_b32 v185, v177, v225
    v_xor_b32 v177, v177, v185
    v_and_b32 v186, v178, v226
    v_xor_b32 v178, v178, v186
    v_and_b32 v187, v179, v227
    v_xor_b32 v179, v179, v187
    v_and_b32 v188, v180, v228
    v_xor_b32 v180, v180, v188
    v_and_b32 v189, v181, v229
    v_xor_b32 v181, v181, v189
    v_and_b32 v190, v182, v230
    v_xor_b32 v182, v182, v190
    v_and_b32 v191, v183, v231
    v_xor_b32 v183, v183, v191
    s_waitcnt lgkmcnt(0)
    v_mfma_f32_32x32x16_bf16 v[208:223], v[192:195], v[176:179], 0
    v_exp_f32 v144, v144
    v_exp_f32 v145, v145
    v_exp_f32 v146, v146
    v_exp_f32 v147, v147
    v_cvt_pk_bf16_f32 v240, v144, v145
    v_mfma_f32_32x32x16_bf16 v[208:223], v[196:199], v[180:183], v[208:223]
    v_cvt_pk_bf16_f32 v241, v146, v147
    v_exp_f32 v148, v148
    v_exp_f32 v149, v149
    v_exp_f32 v150, v150
    v_exp_f32 v151, v151
    v_mfma_f32_32x32x16_bf16 v[208:223], v[200:203], v[184:187], v[208:223]
    v_cvt_pk_bf16_f32 v242, v148, v149
    v_cvt_pk_bf16_f32 v243, v150, v151
    v_exp_f32 v152, v152
    v_exp_f32 v153, v153
    v_exp_f32 v154, v154
    v_mfma_f32_32x32x16_bf16 v[208:223], v[204:207], v[188:191], v[208:223]
    v_exp_f32 v155, v155
    v_cvt_pk_bf16_f32 v244, v152, v153
    v_cvt_pk_bf16_f32 v245, v154, v155
    ds_read_b64_tr_b16 v[192:193], v22 offset:256
    ds_read_b64_tr_b16 v[194:195], v22 offset:320
    ds_read_b64_tr_b16 v[196:197], v22 offset:384
    ds_read_b64_tr_b16 v[198:199], v22 offset:448
    v_exp_f32 v156, v156
    v_exp_f32 v157, v157
    v_mfma_f32_32x32x16_bf16 v[112:127], v[56:59], v[104:107], v[160:175]
    v_exp_f32 v158, v158
    v_exp_f32 v159, v159
    v_cvt_pk_bf16_f32 v246, v156, v157
    v_cvt_pk_bf16_f32 v247, v158, v159
    v_mfma_f32_32x32x16_bf16 v[112:127], v[60:63], v[108:111], v[112:127]
    ds_read_b64_tr_b16 v[200:201], v22 offset:512
    ds_read_b64_tr_b16 v[202:203], v22 offset:576
    ds_read_b64_tr_b16 v[204:205], v22 offset:640
    ds_read_b64_tr_b16 v[206:207], v22 offset:704
    v_exp_f32 v128, v128
    v_exp_f32 v129, v129
    v_exp_f32 v130, v130
    s_waitcnt lgkmcnt(4)
    v_mfma_f32_32x32x16_bf16 v[208:223], v[192:195], v[240:243], v[208:223]
    v_exp_f32 v131, v131
    v_cvt_pk_bf16_f32 v176, v128, v129
    v_cvt_pk_bf16_f32 v177, v130, v131
    v_exp_f32 v132, v132
    v_exp_f32 v133, v133
    v_exp_f32 v134, v134
    v_mfma_f32_32x32x16_bf16 v[208:223], v[196:199], v[244:247], v[208:223]
    v_exp_f32 v135, v135
    v_cvt_pk_bf16_f32 v178, v132, v133
    v_cvt_pk_bf16_f32 v179, v134, v135
    v_exp_f32 v136, v136
    v_exp_f32 v137, v137
    v_exp_f32 v138, v138
    v_mfma_f32_32x32x16_bf16 v[144:159], v[64:67], v[104:107], v[160:175]
    v_exp_f32 v139, v139
    v_cvt_pk_bf16_f32 v180, v136, v137
    v_cvt_pk_bf16_f32 v181, v138, v139
    v_exp_f32 v140, v140
    v_exp_f32 v141, v141
    v_exp_f32 v142, v142
    v_mfma_f32_32x32x16_bf16 v[144:159], v[68:71], v[108:111], v[144:159]
    v_exp_f32 v143, v143
    v_cvt_pk_bf16_f32 v182, v140, v141
    v_cvt_pk_bf16_f32 v183, v142, v143
    ds_read_b64_tr_b16 v[192:193], v22 offset:768
    ds_read_b64_tr_b16 v[194:195], v22 offset:832
    ds_read_b64_tr_b16 v[196:197], v22 offset:896
    ds_read_b64_tr_b16 v[198:199], v22 offset:960
    v_exp_f32 v112, v112
    v_exp_f32 v113, v113
    v_exp_f32 v114, v114
    s_waitcnt lgkmcnt(4)
    v_mfma_f32_32x32x16_bf16 v[208:223], v[200:203], v[176:179], v[208:223]
    v_exp_f32 v115, v115
    v_cvt_pk_bf16_f32 v184, v112, v113
    v_cvt_pk_bf16_f32 v185, v114, v115
    v_exp_f32 v116, v116
    v_exp_f32 v117, v117
    v_exp_f32 v118, v118
    v_mfma_f32_32x32x16_bf16 v[208:223], v[204:207], v[180:183], v[208:223]
    v_exp_f32 v119, v119
    v_cvt_pk_bf16_f32 v186, v116, v117
    v_cvt_pk_bf16_f32 v187, v118, v119
    v_exp_f32 v120, v120
    v_exp_f32 v121, v121
    v_exp_f32 v122, v122
    v_mfma_f32_32x32x16_bf16 v[128:143], v[72:75], v[104:107], v[160:175]
    v_exp_f32 v123, v123
    v_cvt_pk_bf16_f32 v188, v120, v121
    v_cvt_pk_bf16_f32 v189, v122, v123
    v_exp_f32 v124, v124
    v_exp_f32 v125, v125
    v_exp_f32 v126, v126
    v_mfma_f32_32x32x16_bf16 v[128:143], v[76:79], v[108:111], v[128:143]
    v_exp_f32 v127, v127
    v_cvt_pk_bf16_f32 v190, v124, v125
    v_cvt_pk_bf16_f32 v191, v126, v127
    ds_read_b64_tr_b16 v[200:201], v22 offset:1024
    ds_read_b64_tr_b16 v[202:203], v22 offset:1088
    ds_read_b64_tr_b16 v[204:205], v22 offset:1152
    ds_read_b64_tr_b16 v[206:207], v22 offset:1216
    v_exp_f32 v144, v144
    v_exp_f32 v145, v145
    v_exp_f32 v146, v146
    s_waitcnt lgkmcnt(4)
    v_mfma_f32_32x32x16_bf16 v[208:223], v[192:195], v[184:187], v[208:223]
    v_exp_f32 v147, v147
    v_cvt_pk_bf16_f32 v176, v144, v145
    v_cvt_pk_bf16_f32 v177, v146, v147
    v_exp_f32 v148, v148
    v_exp_f32 v149, v149
    v_exp_f32 v150, v150
    v_mfma_f32_32x32x16_bf16 v[208:223], v[196:199], v[188:191], v[208:223]
    v_exp_f32 v151, v151
    v_cvt_pk_bf16_f32 v178, v148, v149
    v_cvt_pk_bf16_f32 v179, v150, v151
    v_exp_f32 v152, v152
    v_exp_f32 v153, v153
    v_exp_f32 v154, v154
    v_mfma_f32_32x32x16_bf16 v[112:127], v[80:83], v[104:107], v[160:175]
    v_exp_f32 v155, v155
    v_cvt_pk_bf16_f32 v180, v152, v153
    v_cvt_pk_bf16_f32 v181, v154, v155
    v_exp_f32 v156, v156
    v_exp_f32 v157, v157
    v_exp_f32 v158, v158
    v_mfma_f32_32x32x16_bf16 v[112:127], v[84:87], v[108:111], v[112:127]
    v_exp_f32 v159, v159
    v_cvt_pk_bf16_f32 v182, v156, v157
    v_cvt_pk_bf16_f32 v183, v158, v159
    ds_read_b64_tr_b16 v[192:193], v22 offset:1280
    ds_read_b64_tr_b16 v[194:195], v22 offset:1344
    ds_read_b64_tr_b16 v[196:197], v22 offset:1408
    ds_read_b64_tr_b16 v[198:199], v22 offset:1472
    v_exp_f32 v128, v128
    v_exp_f32 v129, v129
    v_exp_f32 v130, v130
    s_waitcnt lgkmcnt(4)
    v_mfma_f32_32x32x16_bf16 v[208:223], v[200:203], v[176:179], v[208:223]
    v_exp_f32 v131, v131
    v_cvt_pk_bf16_f32 v184, v128, v129
    v_cvt_pk_bf16_f32 v185, v130, v131
    v_exp_f32 v132, v132
    v_exp_f32 v133, v133
    v_exp_f32 v134, v134
    v_mfma_f32_32x32x16_bf16 v[208:223], v[204:207], v[180:183], v[208:223]
    v_exp_f32 v135, v135
    v_cvt_pk_bf16_f32 v186, v132, v133
    v_cvt_pk_bf16_f32 v187, v134, v135
    v_exp_f32 v136, v136
    v_exp_f32 v137, v137
    v_exp_f32 v138, v138
    v_mfma_f32_32x32x16_bf16 v[144:159], v[88:91], v[104:107], v[160:175]
    v_exp_f32 v139, v139
    v_cvt_pk_bf16_f32 v188, v136, v137
    v_cvt_pk_bf16_f32 v189, v138, v139
    v_exp_f32 v140, v140
    v_exp_f32 v141, v141
    v_exp_f32 v142, v142
    v_mfma_f32_32x32x16_bf16 v[144:159], v[92:95], v[108:111], v[144:159]
    v_exp_f32 v143, v143
    v_cvt_pk_bf16_f32 v190, v140, v141
    v_cvt_pk_bf16_f32 v191, v142, v143
    ds_read_b64_tr_b16 v[200:201], v22 offset:1536
    ds_read_b64_tr_b16 v[202:203], v22 offset:1600
    ds_read_b64_tr_b16 v[204:205], v22 offset:1664
    ds_read_b64_tr_b16 v[206:207], v22 offset:1728
    v_exp_f32 v112, v112
    v_exp_f32 v113, v113
    v_exp_f32 v114, v114
    s_waitcnt lgkmcnt(4)
    v_mfma_f32_32x32x16_bf16 v[208:223], v[192:195], v[184:187], v[208:223]
    v_exp_f32 v115, v115
    v_cvt_pk_bf16_f32 v176, v112, v113
    v_cvt_pk_bf16_f32 v177, v114, v115
    v_exp_f32 v116, v116
    v_exp_f32 v117, v117
    v_exp_f32 v118, v118
    v_mfma_f32_32x32x16_bf16 v[208:223], v[196:199], v[188:191], v[208:223]
    v_exp_f32 v119, v119
    v_cvt_pk_bf16_f32 v178, v116, v117
    v_cvt_pk_bf16_f32 v179, v118, v119
    v_exp_f32 v120, v120
    v_exp_f32 v121, v121
    v_exp_f32 v122, v122
    v_exp_f32 v123, v123
    v_cvt_pk_bf16_f32 v180, v120, v121
    v_cvt_pk_bf16_f32 v181, v122, v123
    v_exp_f32 v124, v124
    v_exp_f32 v125, v125
    v_exp_f32 v126, v126
    v_exp_f32 v127, v127
    v_cvt_pk_bf16_f32 v182, v124, v125
    v_cvt_pk_bf16_f32 v183, v126, v127
    ds_read_b64_tr_b16 v[192:193], v22 offset:1792
    ds_read_b64_tr_b16 v[194:195], v22 offset:1856
    ds_read_b64_tr_b16 v[196:197], v22 offset:1920
    ds_read_b64_tr_b16 v[198:199], v22 offset:1984
    v_exp_f32 v144, v144
    v_exp_f32 v145, v145
    v_exp_f32 v146, v146
    s_waitcnt lgkmcnt(4)
    v_mfma_f32_32x32x16_bf16 v[208:223], v[200:203], v[176:179], v[208:223]
    v_exp_f32 v147, v147
    v_cvt_pk_bf16_f32 v184, v144, v145
    v_cvt_pk_bf16_f32 v185, v146, v147
    v_exp_f32 v148, v148
    v_exp_f32 v149, v149
    v_exp_f32 v150, v150
    v_mfma_f32_32x32x16_bf16 v[208:223], v[204:207], v[180:183], v[208:223]
    v_exp_f32 v151, v151
    v_cvt_pk_bf16_f32 v186, v148, v149
    v_cvt_pk_bf16_f32 v187, v150, v151
    v_exp_f32 v152, v152
    v_exp_f32 v153, v153
    v_exp_f32 v154, v154
    v_exp_f32 v155, v155
    v_cvt_pk_bf16_f32 v188, v152, v153
    v_cvt_pk_bf16_f32 v189, v154, v155
    v_exp_f32 v156, v156
    v_exp_f32 v157, v157
    v_exp_f32 v158, v158
    v_exp_f32 v159, v159
    v_cvt_pk_bf16_f32 v190, v156, v157
    v_cvt_pk_bf16_f32 v191, v158, v159
    s_waitcnt lgkmcnt(0)
    v_mfma_f32_32x32x16_bf16 v[208:223], v[192:195], v[184:187], v[208:223]
    v_mfma_f32_32x32x16_bf16 v[208:223], v[196:199], v[188:191], v[208:223]
    s_nop 11
    v_mov_b32 v29, v216
    v_mov_b32 v30, v216
    s_nop 1
    v_permlane32_swap_b32 v29, v30
    v_mov_b32 v29, 0x71800000
    v_cmp_nlt_f32 vcc, v30, v29
    s_nop 0
    s_cmp_lg_u64 vcc, 0
    s_cbranch_scc1 L_fb0
L_fbret0:
    s_nop 1
    ds_read_b64 v[32:33], v19 offset:15520
    ds_read_b64 v[34:35], v19 offset:18624
    ds_read_b64 v[36:37], v20 offset:15520
    ds_read_b64 v[96:97], v19 offset:17568
    ds_read_b64 v[98:99], v19 offset:20672
    ds_read_b64 v[100:101], v20 offset:17568
    ds_read_b64 v[40:41], v19 offset:15776
    ds_read_b64 v[42:43], v19 offset:18880
    ds_read_b64 v[44:45], v20 offset:15776
    ds_read_b64 v[48:49], v19 offset:16032
    ds_read_b64 v[50:51], v19 offset:19136
    ds_read_b64 v[52:53], v20 offset:16032
    ds_read_b64 v[56:57], v19 offset:16288
    ds_read_b64 v[58:59], v19 offset:19392
    ds_read_b64 v[60:61], v20 offset:16288
    ds_read_b64 v[64:65], v19 offset:16544
    ds_read_b64 v[66:67], v19 offset:19648
    ds_read_b64 v[68:69], v20 offset:16544
    ds_read_b64 v[72:73], v19 offset:16800
    ds_read_b64 v[74:75], v19 offset:19904
    ds_read_b64 v[76:77], v20 offset:16800
    ds_read_b64 v[80:81], v19 offset:17056
    ds_read_b64 v[82:83], v19 offset:20160
    ds_read_b64 v[84:85], v20 offset:17056
    ds_read_b64 v[88:89], v19 offset:17312
    ds_read_b64 v[90:91], v19 offset:20416
    ds_read_b64 v[92:93], v20 offset:17312
    v_rcp_f32 v30, v30
    s_waitcnt vmcnt(0)
    v_mul_f32 v30, v30, v13
    v_mul_f32 v208, v208, v30
    v_mul_f32 v209, v209, v30
    v_mul_f32 v210, v210, v30
    v_mul_f32 v211, v211, v30
    v_cvt_pk_bf16_f32 v208, v208, v209
    v_cvt_pk_bf16_f32 v209, v210, v211
    v_mul_f32 v212, v212, v30
    v_mul_f32 v213, v213, v30
    v_mul_f32 v214, v214, v30
    v_mul_f32 v215, v215, v30
    v_cvt_pk_bf16_f32 v212, v212, v213
    v_cvt_pk_bf16_f32 v213, v214, v215
    v_mul_f32 v216, v216, v30
    v_mul_f32 v217, v217, v30
    v_mul_f32 v218, v218, v30
    v_mul_f32 v219, v219, v30
    v_cvt_pk_bf16_f32 v216, v216, v217
    v_cvt_pk_bf16_f32 v217, v218, v219
    ds_write_b64 v24, v[208:209] offset:0
    ds_write_b64 v24, v[212:213] offset:16
    s_mov_b64 exec, 0xffffffff
    ds_write_b64 v24, v[216:217] offset:32
    s_mov_b64 exec, -1
    s_waitcnt vmcnt(1)
    s_waitcnt lgkmcnt(0)
    v_mfma_f32_32x32x16_bf16 v[112:127], v[32:35], v[232:235], 0
    v_mfma_f32_32x32x16_bf16 v[112:127], v[36:39], v[236:239], v[112:127]
    v_mfma_f32_32x32x16_bf16 v[128:143], v[96:99], v[232:235], 0
    v_mfma_f32_32x32x16_bf16 v[128:143], v[100:103], v[236:239], v[128:143]
    ds_read_b64_tr_b16 v[192:193], v23 offset:0
    ds_read_b64_tr_b16 v[194:195], v23 offset:64
    ds_read_b64_tr_b16 v[196:197], v23 offset:128
    ds_read_b64_tr_b16 v[198:199], v23 offset:192
    ds_read_b64_tr_b16 v[200:201], v23 offset:2048
    ds_read_b64_tr_b16 v[202:203], v23 offset:2112
    ds_read_b64_tr_b16 v[204:205], v23 offset:2176
    ds_read_b64_tr_b16 v[206:207], v23 offset:2240
    s_nop 3
    v_cndmask_b32 v112, v112, v128, s[40:41]
    v_cndmask_b32 v113, v113, v129, s[42:43]
    v_cndmask_b32 v114, v114, v130, s[44:45]
    v_cndmask_b32 v115, v115, v131, s[46:47]
    v_cndmask_b32 v116, v116, v132, s[48:49]
    v_cndmask_b32 v117, v117, v133, s[50:51]
    v_cndmask_b32 v118, v118, v134, s[52:53]
    v_cndmask_b32 v119, v119, v135, s[54:55]
    v_cndmask_b32 v120, v120, v136, s[56:57]
    v_cndmask_b32 v121, v121, v137, s[58:59]
    v_cndmask_b32 v122, v122, v138, s[76:77]
    v_cndmask_b32 v123, v123, v139, s[78:79]
    v_cndmask_b32 v124, v124, v140, s[80:81]
    v_cndmask_b32 v125, v125, v141, s[82:83]
    v_cndmask_b32 v126, v126, v142, s[84:85]
    v_cndmask_b32 v127, v127, v143, s[86:87]
    v_max_f32 v28, v112, v113
    v_max3_f32 v28, v28, v114, v115
    v_max3_f32 v28, v28, v116, v117
    v_max3_f32 v28, v28, v118, v119
    v_max3_f32 v28, v28, v120, v121
    v_max3_f32 v28, v28, v122, v123
    v_max3_f32 v28, v28, v124, v125
    v_max3_f32 v28, v28, v126, v127
    v_mov_b32 v29, v28
    v_mov_b32 v30, v28
    s_nop 1
    v_permlane32_swap_b32 v29, v30
    v_max_f32 v28, v29, v30
    v_sub_f32 v28, 0, v28
    v_mov_b32 v160, v28
    v_mov_b32 v161, v28
    v_mov_b32 v162, v28
    v_mov_b32 v163, v28
    v_mov_b32 v164, v28
    v_mov_b32 v165, v28
    v_mov_b32 v166, v28
    v_mov_b32 v167, v28
    v_mov_b32 v168, v28
    v_mov_b32 v169, v28
    v_mov_b32 v170, v28
    v_mov_b32 v171, v28
    v_mov_b32 v172, v28
    v_mov_b32 v173, v28
    v_mov_b32 v174, v28
    v_mov_b32 v175, v28
    s_nop 1
    v_mfma_f32_32x32x16_bf16 v[144:159], v[40:43], v[232:235], v[160:175]
    v_mfma_f32_32x32x16_bf16 v[144:159], v[44:47], v[236:239], v[144:159]
    v_add_f32 v112, v112, v28
    v_add_f32 v113, v113, v28
    v_add_f32 v114, v114, v28
    v_add_f32 v115, v115, v28
    v_add_f32 v116, v116, v28
    v_add_f32 v117, v117, v28
    v_add_f32 v118, v118, v28
    v_add_f32 v119, v119, v28
    v_add_f32 v120, v120, v28
    v_add_f32 v121, v121, v28
    v_add_f32 v122, v122, v28
    v_add_f32 v123, v123, v28
    v_add_f32 v124, v124, v28
    v_add_f32 v125, v125, v28
    v_add_f32 v126, v126, v28
    v_add_f32 v127, v127, v28
    v_exp_f32 v112, v112
    v_exp_f32 v113, v113
    v_mfma_f32_32x32x16_bf16 v[128:143], v[48:51], v[232:235], v[160:175]
    v_exp_f32 v114, v114
    v_exp_f32 v115, v115
    v_cvt_pk_bf16_f32 v176, v112, v113
    v_cvt_pk_bf16_f32 v177, v114, v115
    v_exp_f32 v116, v116
    v_exp_f32 v117, v117
    v_exp_f32 v118, v118
    v_exp_f32 v119, v119
    v_mfma_f32_32x32x16_bf16 v[128:143], v[52:55], v[236:239], v[128:143]
    v_cvt_pk_bf16_f32 v178, v116, v117
    v_cvt_pk_bf16_f32 v179, v118, v119
    v_exp_f32 v120, v120
    v_exp_f32 v121, v121
    v_exp_f32 v122, v122
    v_exp_f32 v123, v123
    v_cvt_pk_bf16_f32 v180, v120, v121
    v_cvt_pk_bf16_f32 v181, v122, v123
    v_exp_f32 v124, v124
    v_exp_f32 v125, v125
    v_exp_f32 v126, v126
    v_exp_f32 v127, v127
    v_cvt_pk_bf16_f32 v182, v124, v125
    v_cvt_pk_bf16_f32 v183, v126, v127
    v_and_b32 v184, v176, v224
    v_xor_b32 v176, v176, v184
    v_and_b32 v185, v177, v225
    v_xor_b32 v177, v177, v185
    v_and_b32 v186, v178, v226
    v_xor_b32 v178, v178, v186
    v_and_b32 v187, v179, v227
    v_xor_b32 v179, v179, v187
    v_and_b32 v188, v180, v228
    v_xor_b32 v180, v180, v188
    v_and_b32 v189, v181, v229
    v_xor_b32 v181, v181, v189
    v_and_b32 v190, v182, v230
    v_xor_b32 v182, v182, v190
    v_and_b32 v191, v183, v231
    v_xor_b32 v183, v183, v191
    s_waitcnt lgkmcnt(0)
    v_mfma_f32_32x32x16_bf16 v[208:223], v[192:195], v[176:179], 0
    v_exp_f32 v144, v144
    v_exp_f32 v145, v145
    v_exp_f32 v146, v146
    v_exp_f32 v147, v147
    v_cvt_pk_bf16_f32 v240, v144, v145
    v_mfma_f32_32x32x16_bf16 v[208:223], v[196:199], v[180:183], v[208:223]
    v_cvt_pk_bf16_f32 v241, v146, v147
    v_exp_f32 v148, v148
    v_exp_f32 v149, v149
    v_exp_f32 v150, v150
    v_exp_f32 v151, v151
    v_mfma_f32_32x32x16_bf16 v[208:223], v[200:203], v[184:187], v[208:223]
    v_cvt_pk_bf16_f32 v242, v148, v149
    v_cvt_pk_bf16_f32 v243, v150, v151
    v_exp_f32 v152, v152
    v_exp_f32 v153, v153
    v_exp_f32 v154, v154
    v_mfma_f32_32x32x16_bf16 v[208:223], v[204:207], v[188:191], v[208:223]
    v_exp_f32 v155, v155
    v_cvt_pk_bf16_f32 v244, v152, v153
    v_cvt_pk_bf16_f32 v245, v154, v155
    ds_read_b64_tr_b16 v[192:193], v23 offset:256
    ds_read_b64_tr_b16 v[194:195], v23 offset:320
    ds_read_b64_tr_b16 v[196:197], v23 offset:384
    ds_read_b64_tr_b16 v[198:199], v23 offset:448
    v_exp_f32 v156, v156
    v_exp_f32 v157, v157
    v_mfma_f32_32x32x16_bf16 v[112:127], v[56:59], v[232:235], v[160:175]
    v_exp_f32 v158, v158
    v_exp_f32 v159, v159
    v_cvt_pk_bf16_f32 v246, v156, v157
    v_cvt_pk_bf16_f32 v247, v158, v159
    v_mfma_f32_32x32x16_bf16 v[112:127], v[60:63], v[236:239], v[112:127]
    ds_read_b64_tr_b16 v[200:201], v23 offset:512
    ds_read_b64_tr_b16 v[202:203], v23 offset:576
    ds_read_b64_tr_b16 v[204:205], v23 offset:640
    ds_read_b64_tr_b16 v[206:207], v23 offset:704
    v_exp_f32 v128, v128
    v_exp_f32 v129, v129
    v_exp_f32 v130, v130
    s_waitcnt lgkmcnt(4)
    v_mfma_f32_32x32x16_bf16 v[208:223], v[192:195], v[240:243], v[208:223]
    v_exp_f32 v131, v131
    v_cvt_pk_bf16_f32 v176, v128, v129
    v_cvt_pk_bf16_f32 v177, v130, v131
    v_exp_f32 v132, v132
    v_exp_f32 v133, v133
    v_exp_f32 v134, v134
    v_mfma_f32_32x32x16_bf16 v[208:223], v[196:199], v[244:247], v[208:223]
    v_exp_f32 v135, v135
    v_cvt_pk_bf16_f32 v178, v132, v133
    v_cvt_pk_bf16_f32 v179, v134, v135
    v_exp_f32 v136, v136
    v_exp_f32 v137, v137
    v_exp_f32 v138, v138
    v_mfma_f32_32x32x16_bf16 v[144:159], v[64:67], v[232:235], v[160:175]
    v_exp_f32 v139, v139
    v_cvt_pk_bf16_f32 v180, v136, v137
    v_cvt_pk_bf16_f32 v181, v138, v139
    v_exp_f32 v140, v140
    v_exp_f32 v141, v141
    v_exp_f32 v142, v142
    v_mfma_f32_32x32x16_bf16 v[144:159], v[68:71], v[236:239], v[144:159]
    v_exp_f32 v143, v143
    v_cvt_pk_bf16_f32 v182, v140, v141
    v_cvt_pk_bf16_f32 v183, v142, v143
    ds_read_b64_tr_b16 v[192:193], v23 offset:768
    ds_read_b64_tr_b16 v[194:195], v23 offset:832
    ds_read_b64_tr_b16 v[196:197], v23 offset:896
    ds_read_b64_tr_b16 v[198:199], v23 offset:960
    v_exp_f32 v112, v112
    v_exp_f32 v113, v113
    v_exp_f32 v114, v114
    s_waitcnt lgkmcnt(4)
    v_mfma_f32_32x32x16_bf16 v[208:223], v[200:203], v[176:179], v[208:223]
    v_exp_f32 v115, v115
    v_cvt_pk_bf16_f32 v184, v112, v113
    v_cvt_pk_bf16_f32 v185, v114, v115
    v_exp_f32 v116, v116
    v_exp_f32 v117, v117
    v_exp_f32 v118, v118
    v_mfma_f32_32x32x16_bf16 v[208:223], v[204:207], v[180:183], v[208:223]
    v_exp_f32 v119, v119
    v_cvt_pk_bf16_f32 v186, v116, v117
    v_cvt_pk_bf16_f32 v187, v118, v119
    v_exp_f32 v120, v120
    v_exp_f32 v121, v121
    v_exp_f32 v122, v122
    v_mfma_f32_32x32x16_bf16 v[128:143], v[72:75], v[232:235], v[160:175]
    v_exp_f32 v123, v123
    v_cvt_pk_bf16_f32 v188, v120, v121
    v_cvt_pk_bf16_f32 v189, v122, v123
    v_exp_f32 v124, v124
    v_exp_f32 v125, v125
    v_exp_f32 v126, v126
    v_mfma_f32_32x32x16_bf16 v[128:143], v[76:79], v[236:239], v[128:143]
    v_exp_f32 v127, v127
    v_cvt_pk_bf16_f32 v190, v124, v125
    v_cvt_pk_bf16_f32 v191, v126, v127
    ds_read_b64_tr_b16 v[200:201], v23 offset:1024
    ds_read_b64_tr_b16 v[202:203], v23 offset:1088
    ds_read_b64_tr_b16 v[204:205], v23 offset:1152
    ds_read_b64_tr_b16 v[206:207], v23 offset:1216
    v_exp_f32 v144, v144
    v_exp_f32 v145, v145
    v_exp_f32 v146, v146
    s_waitcnt lgkmcnt(4)
    v_mfma_f32_32x32x16_bf16 v[208:223], v[192:195], v[184:187], v[208:223]
    v_exp_f32 v147, v147
    v_cvt_pk_bf16_f32 v176, v144, v145
    v_cvt_pk_bf16_f32 v177, v146, v147
    v_exp_f32 v148, v148
    v_exp_f32 v149, v149
    v_exp_f32 v150, v150
    v_mfma_f32_32x32x16_bf16 v[208:223], v[196:199], v[188:191], v[208:223]
    v_exp_f32 v151, v151
    v_cvt_pk_bf16_f32 v178, v148, v149
    v_cvt_pk_bf16_f32 v179, v150, v151
    v_exp_f32 v152, v152
    v_exp_f32 v153, v153
    v_exp_f32 v154, v154
    v_mfma_f32_32x32x16_bf16 v[112:127], v[80:83], v[232:235], v[160:175]
    v_exp_f32 v155, v155
    v_cvt_pk_bf16_f32 v180, v152, v153
    v_cvt_pk_bf16_f32 v181, v154, v155
    v_exp_f32 v156, v156
    v_exp_f32 v157, v157
    v_exp_f32 v158, v158
    v_mfma_f32_32x32x16_bf16 v[112:127], v[84:87], v[236:239], v[112:127]
    v_exp_f32 v159, v159
    v_cvt_pk_bf16_f32 v182, v156, v157
    v_cvt_pk_bf16_f32 v183, v158, v159
    ds_read_b64_tr_b16 v[192:193], v23 offset:1280
    ds_read_b64_tr_b16 v[194:195], v23 offset:1344
    ds_read_b64_tr_b16 v[196:197], v23 offset:1408
    ds_read_b64_tr_b16 v[198:199], v23 offset:1472
    v_exp_f32 v128, v128
    v_exp_f32 v129, v129
    v_exp_f32 v130, v130
    s_waitcnt lgkmcnt(4)
    v_mfma_f32_32x32x16_bf16 v[208:223], v[200:203], v[176:179], v[208:223]
    v_exp_f32 v131, v131
    v_cvt_pk_bf16_f32 v184, v128, v129
    v_cvt_pk_bf16_f32 v185, v130, v131
    v_exp_f32 v132, v132
    v_exp_f32 v133, v133
    v_exp_f32 v134, v134
    v_mfma_f32_32x32x16_bf16 v[208:223], v[204:207], v[180:183], v[208:223]
    v_exp_f32 v135, v135
    v_cvt_pk_bf16_f32 v186, v132, v133
    v_cvt_pk_bf16_f32 v187, v134, v135
    v_exp_f32 v136, v136
    v_exp_f32 v137, v137
    v_exp_f32 v138, v138
    v_mfma_f32_32x32x16_bf16 v[144:159], v[88:91], v[232:235], v[160:175]
    v_exp_f32 v139, v139
    v_cvt_pk_bf16_f32 v188, v136, v137
    v_cvt_pk_bf16_f32 v189, v138, v139
    v_exp_f32 v140, v140
    v_exp_f32 v141, v141
    v_exp_f32 v142, v142
    v_mfma_f32_32x32x16_bf16 v[144:159], v[92:95], v[236:239], v[144:159]
    v_exp_f32 v143, v143
    v_cvt_pk_bf16_f32 v190, v140, v141
    v_cvt_pk_bf16_f32 v191, v142, v143
    ds_read_b64_tr_b16 v[200:201], v23 offset:1536
    ds_read_b64_tr_b16 v[202:203], v23 offset:1600
    ds_read_b64_tr_b16 v[204:205], v23 offset:1664
    ds_read_b64_tr_b16 v[206:207], v23 offset:1728
    v_exp_f32 v112, v112
    v_exp_f32 v113, v113
    v_exp_f32 v114, v114
    s_waitcnt lgkmcnt(4)
    v_mfma_f32_32x32x16_bf16 v[208:223], v[192:195], v[184:187], v[208:223]
    v_exp_f32 v115, v115
    v_cvt_pk_bf16_f32 v176, v112, v113
    v_cvt_pk_bf16_f32 v177, v114, v115
    v_exp_f32 v116, v116
    v_exp_f32 v117, v117
    v_exp_f32 v118, v118
    v_mfma_f32_32x32x16_bf16 v[208:223], v[196:199], v[188:191], v[208:223]
    v_exp_f32 v119, v119
    v_cvt_pk_bf16_f32 v178, v116, v117
    v_cvt_pk_bf16_f32 v179, v118, v119
    v_exp_f32 v120, v120
    v_exp_f32 v121, v121
    v_exp_f32 v122, v122
    v_exp_f32 v123, v123
    v_cvt_pk_bf16_f32 v180, v120, v121
    v_cvt_pk_bf16_f32 v181, v122, v123
    v_exp_f32 v124, v124
    v_exp_f32 v125, v125
    v_exp_f32 v126, v126
    v_exp_f32 v127, v127
    v_cvt_pk_bf16_f32 v182, v124, v125
    v_cvt_pk_bf16_f32 v183, v126, v127
    ds_read_b64_tr_b16 v[192:193], v23 offset:1792
    ds_read_b64_tr_b16 v[194:195], v23 offset:1856
    ds_read_b64_tr_b16 v[196:197], v23 offset:1920
    ds_read_b64_tr_b16 v[198:199], v23 offset:1984
    v_exp_f32 v144, v144
    v_exp_f32 v145, v145
    v_exp_f32 v146, v146
    s_waitcnt lgkmcnt(4)
    v_mfma_f32_32x32x16_bf16 v[208:223], v[200:203], v[176:179], v[208:223]
    v_exp_f32 v147, v147
    v_cvt_pk_bf16_f32 v184, v144, v145
    v_cvt_pk_bf16_f32 v185, v146, v147
    v_exp_f32 v148, v148
    v_exp_f32 v149, v149
    v_exp_f32 v150, v150
    v_mfma_f32_32x32x16_bf16 v[208:223], v[204:207], v[180:183], v[208:223]
    v_exp_f32 v151, v151
    v_cvt_pk_bf16_f32 v186, v148, v149
    v_cvt_pk_bf16_f32 v187, v150, v151
    v_exp_f32 v152, v152
    v_exp_f32 v153, v153
    v_exp_f32 v154, v154
    v_exp_f32 v155, v155
    v_cvt_pk_bf16_f32 v188, v152, v153
    v_cvt_pk_bf16_f32 v189, v154, v155
    v_exp_f32 v156, v156
    v_exp_f32 v157, v157
    v_exp_f32 v158, v158
    v_exp_f32 v159, v159
    v_cvt_pk_bf16_f32 v190, v156, v157
    v_cvt_pk_bf16_f32 v191, v158, v159
    s_waitcnt lgkmcnt(0)
    v_mfma_f32_32x32x16_bf16 v[208:223], v[192:195], v[184:187], v[208:223]
    v_mfma_f32_32x32x16_bf16 v[208:223], v[196:199], v[188:191], v[208:223]
    s_nop 11
    v_mov_b32 v29, v216
    v_mov_b32 v30, v216
    s_nop 1
    v_permlane32_swap_b32 v29, v30
    v_mov_b32 v29, 0x71800000
    v_cmp_nlt_f32 vcc, v30, v29
    s_nop 0
    s_cmp_lg_u64 vcc, 0
    s_cbranch_scc1 L_fb1
L_fbret1:
    s_nop 1
    v_rcp_f32 v30, v30
    s_nop 0
    v_mul_f32 v30, v30, v13
    v_mul_f32 v208, v208, v30
    v_mul_f32 v209, v209, v30
    v_mul_f32 v210, v210, v30
    v_mul_f32 v211, v211, v30
    v_cvt_pk_bf16_f32 v208, v208, v209
    v_cvt_pk_bf16_f32 v209, v210, v211
    v_mul_f32 v212, v212, v30
    v_mul_f32 v213, v213, v30
    v_mul_f32 v214, v214, v30
    v_mul_f32 v215, v215, v30
    v_cvt_pk_bf16_f32 v212, v212, v213
    v_cvt_pk_bf16_f32 v213, v214, v215
    v_mul_f32 v216, v216, v30
    v_mul_f32 v217, v217, v30
    v_mul_f32 v218, v218, v30
    v_mul_f32 v219, v219, v30
    v_cvt_pk_bf16_f32 v216, v216, v217
    v_cvt_pk_bf16_f32 v217, v218, v219
    ds_write_b64 v24, v[208:209] offset:40
    ds_write_b64 v24, v[212:213] offset:56
    s_mov_b64 exec, 0xffffffff
    ds_write_b64 v24, v[216:217] offset:72
    s_mov_b64 exec, -1
    s_waitcnt lgkmcnt(0)
    s_lshl_b32 s70, s93, 3
    s_lshl_b32 s64, s3, 1
    s_add_u32 s70, s70, s64
    s_mul_i32 s70, s70, 20480
    s_mul_i32 s64, s94, 1280
    s_add_u32 s70, s70, s64
    s_add_u32 s70, s70, 14942208
    s_mul_i32 s64, s3, 2560
    s_add_u32 s64, s64, 81920
    v_add_u32 v2, 0, v1
    v_and_b32 v3, 15, v2
    v_lshrrev_b32 v4, 4, v2
    v_cmp_le_u32 vcc, 5, v4
    s_nop 1
    v_cndmask_b32 v5, 0, 1, vcc
    v_mul_u32_u24 v6, 5, v5
    v_sub_u32 v6, v4, v6
    v_lshl_add_u32 v9, v5, 4, v3
    v_mul_u32_u24 v9, 80, v9
    v_lshl_add_u32 v9, v6, 4, v9
    v_add_u32 v9, s64, v9
    ds_read_b128 v[32:35], v9
    v_mul_u32_u24 v10, 20480, v5
    v_lshl_add_u32 v6, v6, 4, v3
    v_lshl_add_u32 v10, v6, 4, v10
    v_add_u32 v2, 64, v1
    v_and_b32 v3, 15, v2
    v_lshrrev_b32 v4, 4, v2
    v_cmp_le_u32 vcc, 5, v4
    s_nop 1
    v_cndmask_b32 v5, 0, 1, vcc
    v_mul_u32_u24 v6, 5, v5
    v_sub_u32 v6, v4, v6
    v_lshl_add_u32 v9, v5, 4, v3
    v_mul_u32_u24 v9, 80, v9
    v_lshl_add_u32 v9, v6, 4, v9
    v_add_u32 v9, s64, v9
    ds_read_b128 v[36:39], v9
    v_mul_u32_u24 v11, 20480, v5
    v_lshl_add_u32 v6, v6, 4, v3
    v_lshl_add_u32 v11, v6, 4, v11
    v_add_u32 v2, 128, v1
    v_and_b32 v3, 15, v2
    v_lshrrev_b32 v4, 4, v2
    v_cmp_le_u32 vcc, 5, v4
    s_nop 1
    v_cndmask_b32 v5, 0, 1, vcc
    v_mul_u32_u24 v6, 5, v5
    v_sub_u32 v6, v4, v6
    v_lshl_add_u32 v9, v5, 4, v3
    v_mul_u32_u24 v9, 80, v9
    v_lshl_add_u32 v9, v6, 4, v9
    v_add_u32 v9, s64, v9
    ds_read_b128 v[40:43], v9
    v_mul_u32_u24 v12, 20480, v5
    v_lshl_add_u32 v6, v6, 4, v3
    v_lshl_add_u32 v12, v6, 4, v12
    v_cmp_le_u32 vcc, 32, v1
    v_mov_b32 v9, 0x7fffff00
    s_nop 0
    v_cndmask_b32 v12, v12, v9, vcc
    s_waitcnt lgkmcnt(2)
    buffer_store_dwordx4 v[32:35], v10, s[36:39], s70 offen sc1
    s_waitcnt lgkmcnt(1)
    buffer_store_dwordx4 v[36:39], v11, s[36:39], s70 offen sc1
    s_waitcnt lgkmcnt(0)
    buffer_store_dwordx4 v[40:43], v12, s[36:39], s70 offen sc1
    s_waitcnt vmcnt(0)
    v_mov_b32 v8, 163456
    v_mov_b32 v9, 1
    s_mov_b64 exec, 1
    ds_add_rtn_u32 v10, v8, v9
    s_waitcnt lgkmcnt(0)
    v_readfirstlane_b32 s64, v10
    s_mov_b64 exec, -1
    s_cmp_lg_u32 s64, 3
    s_cbranch_scc1 L_csO
    v_mov_b32 v9, 163480
    ds_read_b32 v8, v9
    s_lshl_b32 s64, s92, 7
    s_add_u32 s64, s64, 18939904
    v_mov_b32 v9, s64
    s_waitcnt lgkmcnt(0)
    s_mov_b64 exec, 1
    buffer_store_dword v8, v9, s[36:39], 0 offen sc1
    s_mov_b64 exec, -1
L_csO:
    s_branch L_END
L_fb0:
    s_nop 7
    s_nop 7
    s_waitcnt lgkmcnt(0)
    v_mfma_f32_32x32x16_bf16 v[112:127], v[32:35], v[104:107], 0
    v_mfma_f32_32x32x16_bf16 v[112:127], v[36:39], v[108:111], v[112:127]
    v_mfma_f32_32x32x16_bf16 v[128:143], v[96:99], v[104:107], 0
    v_mfma_f32_32x32x16_bf16 v[128:143], v[100:103], v[108:111], v[128:143]
    ds_read_b64_tr_b16 v[192:193], v22 offset:0
    ds_read_b64_tr_b16 v[194:195], v22 offset:64
    ds_read_b64_tr_b16 v[196:197], v22 offset:128
    ds_read_b64_tr_b16 v[198:199], v22 offset:192
    ds_read_b64_tr_b16 v[200:201], v22 offset:2048
    ds_read_b64_tr_b16 v[202:203], v22 offset:2112
    ds_read_b64_tr_b16 v[204:205], v22 offset:2176
    ds_read_b64_tr_b16 v[206:207], v22 offset:2240
    v_mfma_f32_32x32x16_bf16 v[144:159], v[40:43], v[104:107], 0
    v_mfma_f32_32x32x16_bf16 v[144:159], v[44:47], v[108:111], v[144:159]
    s_nop 1
    v_cndmask_b32 v112, v112, v128, s[40:41]
    v_cndmask_b32 v113, v113, v129, s[42:43]
    v_cndmask_b32 v114, v114, v130, s[44:45]
    v_cndmask_b32 v115, v115, v131, s[46:47]
    v_cndmask_b32 v116, v116, v132, s[48:49]
    v_cndmask_b32 v117, v117, v133, s[50:51]
    v_cndmask_b32 v118, v118, v134, s[52:53]
    v_cndmask_b32 v119, v119, v135, s[54:55]
    v_cndmask_b32 v120, v120, v136, s[56:57]
    v_cndmask_b32 v121, v121, v137, s[58:59]
    v_cndmask_b32 v122, v122, v138, s[76:77]
    v_cndmask_b32 v123, v123, v139, s[78:79]
    v_cndmask_b32 v124, v124, v140, s[80:81]
    v_cndmask_b32 v125, v125, v141, s[82:83]
    v_cndmask_b32 v126, v126, v142, s[84:85]
    v_cndmask_b32 v127, v127, v143, s[86:87]
    v_mfma_f32_32x32x16_bf16 v[128:143], v[48:51], v[104:107], 0
    v_max_f32 v28, v112, v113
    v_max3_f32 v28, v28, v114, v115
    v_max3_f32 v28, v28, v116, v117
    v_max3_f32 v28, v28, v118, v119
    v_mfma_f32_32x32x16_bf16 v[128:143], v[52:55], v[108:111], v[128:143]
    v_max3_f32 v28, v28, v120, v121
    v_max3_f32 v28, v28, v122, v123
    v_max3_f32 v28, v28, v124, v125
    v_max3_f32 v28, v28, v126, v127
    v_mfma_f32_32x32x16_bf16 v[112:127], v[56:59], v[104:107], 0
    v_max3_f32 v28, v28, v144, v145
    v_max3_f32 v28, v28, v146, v147
    v_max3_f32 v28, v28, v148, v149
    v_max3_f32 v28, v28, v150, v151
    v_mfma_f32_32x32x16_bf16 v[112:127], v[60:63], v[108:111], v[112:127]
    v_max3_f32 v28, v28, v152, v153
    v_max3_f32 v28, v28, v154, v155
    v_max3_f32 v28, v28, v156, v157
    v_max3_f32 v28, v28, v158, v159
    v_mfma_f32_32x32x16_bf16 v[144:159], v[64:67], v[104:107], 0
    v_max3_f32 v28, v28, v128, v129
    v_max3_f32 v28, v28, v130, v131
    v_max3_f32 v28, v28, v132, v133
    v_max3_f32 v28, v28, v134, v135
    v_mfma_f32_32x32x16_bf16 v[144:159], v[68:71], v[108:111], v[144:159]
    v_max3_f32 v28, v28, v136, v137
    v_max3_f32 v28, v28, v138, v139
    v_max3_f32 v28, v28, v140, v141
    v_max3_f32 v28, v28, v142, v143
    v_mfma_f32_32x32x16_bf16 v[128:143], v[72:75], v[104:107], 0
    v_max3_f32 v28, v28, v112, v113
    v_max3_f32 v28, v28, v114, v115
    v_max3_f32 v28, v28, v116, v117
    v_max3_f32 v28, v28, v118, v119
    v_mfma_f32_32x32x16_bf16 v[128:143], v[76:79], v[108:111], v[128:143]
    v_max3_f32 v28, v28, v120, v121
    v_max3_f32 v28, v28, v122, v123
    v_max3_f32 v28, v28, v124, v125
    v_max3_f32 v28, v28, v126, v127
    v_mfma_f32_32x32x16_bf16 v[112:127], v[80:83], v[104:107], 0
    v_max3_f32 v28, v28, v144, v145
    v_max3_f32 v28, v28, v146, v147
    v_max3_f32 v28, v28, v148, v149
    v_max3_f32 v28, v28, v150, v151
    v_mfma_f32_32x32x16_bf16 v[112:127], v[84:87], v[108:111], v[112:127]
    v_max3_f32 v28, v28, v152, v153
    v_max3_f32 v28, v28, v154, v155
    v_max3_f32 v28, v28, v156, v157
    v_max3_f32 v28, v28, v158, v159
    v_mfma_f32_32x32x16_bf16 v[144:159], v[88:91], v[104:107], 0
    v_max3_f32 v28, v28, v128, v129
    v_max3_f32 v28, v28, v130, v131
    v_max3_f32 v28, v28, v132, v133
    v_max3_f32 v28, v28, v134, v135
    v_mfma_f32_32x32x16_bf16 v[144:159], v[92:95], v[108:111], v[144:159]
    v_max3_f32 v28, v28, v136, v137
    v_max3_f32 v28, v28, v138, v139
    v_max3_f32 v28, v28, v140, v141
    v_max3_f32 v28, v28, v142, v143
    v_max3_f32 v28, v28, v112, v113
    v_max3_f32 v28, v28, v114, v115
    v_max3_f32 v28, v28, v116, v117
    v_max3_f32 v28, v28, v118, v119
    v_max3_f32 v28, v28, v120, v121
    v_max3_f32 v28, v28, v122, v123
    v_max3_f32 v28, v28, v124, v125
    v_max3_f32 v28, v28, v126, v127
    v_max3_f32 v28, v28, v144, v145
    v_max3_f32 v28, v28, v146, v147
    v_max3_f32 v28, v28, v148, v149
    v_max3_f32 v28, v28, v150, v151
    v_max3_f32 v28, v28, v152, v153
    v_max3_f32 v28, v28, v154, v155
    v_max3_f32 v28, v28, v156, v157
    v_max3_f32 v28, v28, v158, v159
    v_mov_b32 v29, v28
    v_mov_b32 v30, v28
    s_nop 1
    v_permlane32_swap_b32 v29, v30
    v_max_f32 v28, v29, v30
    v_sub_f32 v28, 0, v28
    v_mov_b32 v160, v28
    v_mov_b32 v161, v28
    v_mov_b32 v162, v28
    v_mov_b32 v163, v28
    v_mov_b32 v164, v28
    v_mov_b32 v165, v28
    v_mov_b32 v166, v28
    v_mov_b32 v167, v28
    v_mov_b32 v168, v28
    v_mov_b32 v169, v28
    v_mov_b32 v170, v28
    v_mov_b32 v171, v28
    v_mov_b32 v172, v28
    v_mov_b32 v173, v28
    v_mov_b32 v174, v28
    v_mov_b32 v175, v28
    s_nop 1
    v_mfma_f32_32x32x16_bf16 v[112:127], v[32:35], v[104:107], v[160:175]
    v_mfma_f32_32x32x16_bf16 v[112:127], v[36:39], v[108:111], v[112:127]
    v_mfma_f32_32x32x16_bf16 v[128:143], v[96:99], v[104:107], v[160:175]
    v_mfma_f32_32x32x16_bf16 v[128:143], v[100:103], v[108:111], v[128:143]
    v_mfma_f32_32x32x16_bf16 v[144:159], v[40:43], v[104:107], v[160:175]
    v_mfma_f32_32x32x16_bf16 v[144:159], v[44:47], v[108:111], v[144:159]
    s_nop 9
    v_cndmask_b32 v112, v112, v128, s[40:41]
    v_cndmask_b32 v113, v113, v129, s[42:43]
    v_cndmask_b32 v114, v114, v130, s[44:45]
    v_cndmask_b32 v115, v115, v131, s[46:47]
    v_cndmask_b32 v116, v116, v132, s[48:49]
    v_cndmask_b32 v117, v117, v133, s[50:51]
    v_cndmask_b32 v118, v118, v134, s[52:53]
    v_cndmask_b32 v119, v119, v135, s[54:55]
    v_cndmask_b32 v120, v120, v136, s[56:57]
    v_cndmask_b32 v121, v121, v137, s[58:59]
    v_cndmask_b32 v122, v122, v138, s[76:77]
    v_cndmask_b32 v123, v123, v139, s[78:79]
    v_cndmask_b32 v124, v124, v140, s[80:81]
    v_cndmask_b32 v125, v125, v141, s[82:83]
    v_cndmask_b32 v126, v126, v142, s[84:85]
    v_cndmask_b32 v127, v127, v143, s[86:87]
    v_exp_f32 v112, v112
    v_exp_f32 v113, v113
    v_mfma_f32_32x32x16_bf16 v[128:143], v[48:51], v[104:107], v[160:175]
    v_exp_f32 v114, v114
    v_exp_f32 v115, v115
    v_cvt_pk_bf16_f32 v176, v112, v113
    v_cvt_pk_bf16_f32 v177, v114, v115
    v_exp_f32 v116, v116
    v_exp_f32 v117, v117
    v_exp_f32 v118, v118
    v_exp_f32 v119, v119
    v_mfma_f32_32x32x16_bf16 v[128:143], v[52:55], v[108:111], v[128:143]
    v_cvt_pk_bf16_f32 v178, v116, v117
    v_cvt_pk_bf16_f32 v179, v118, v119
    v_exp_f32 v120, v120
    v_exp_f32 v121, v121
    v_exp_f32 v122, v122
    v_exp_f32 v123, v123
    v_cvt_pk_bf16_f32 v180, v120, v121
    v_cvt_pk_bf16_f32 v181, v122, v123
    v_exp_f32 v124, v124
    v_exp_f32 v125, v125
    v_exp_f32 v126, v126
    v_exp_f32 v127, v127
    v_cvt_pk_bf16_f32 v182, v124, v125
    v_cvt_pk_bf16_f32 v183, v126, v127
    v_and_b32 v184, v176, v224
    v_xor_b32 v176, v176, v184
    v_and_b32 v185, v177, v225
    v_xor_b32 v177, v177, v185
    v_and_b32 v186, v178, v226
    v_xor_b32 v178, v178, v186
    v_and_b32 v187, v179, v227
    v_xor_b32 v179, v179, v187
    v_and_b32 v188, v180, v228
    v_xor_b32 v180, v180, v188
    v_and_b32 v189, v181, v229
    v_xor_b32 v181, v181, v189
    v_and_b32 v190, v182, v230
    v_xor_b32 v182, v182, v190
    v_and_b32 v191, v183, v231
    v_xor_b32 v183, v183, v191
    s_waitcnt lgkmcnt(0)
    v_mfma_f32_32x32x16_bf16 v[208:223], v[192:195], v[176:179], 0
    v_exp_f32 v144, v144
    v_exp_f32 v145, v145
    v_exp_f32 v146, v146
    v_exp_f32 v147, v147
    v_cvt_pk_bf16_f32 v240, v144, v145
    v_mfma_f32_32x32x16_bf16 v[208:223], v[196:199], v[180:183], v[208:223]
    v_cvt_pk_bf16_f32 v241, v146, v147
    v_exp_f32 v148, v148
    v_exp_f32 v149, v149
    v_exp_f32 v150, v150
    v_exp_f32 v151, v151
    v_mfma_f32_32x32x16_bf16 v[208:223], v[200:203], v[184:187], v[208:223]
    v_cvt_pk_bf16_f32 v242, v148, v149
    v_cvt_pk_bf16_f32 v243, v150, v151
    v_exp_f32 v152, v152
    v_exp_f32 v153, v153
    v_exp_f32 v154, v154
    v_mfma_f32_32x32x16_bf16 v[208:223], v[204:207], v[188:191], v[208:223]
    v_exp_f32 v155, v155
    v_cvt_pk_bf16_f32 v244, v152, v153
    v_cvt_pk_bf16_f32 v245, v154, v155
    ds_read_b64_tr_b16 v[192:193], v22 offset:256
    ds_read_b64_tr_b16 v[194:195], v22 offset:320
    ds_read_b64_tr_b16 v[196:197], v22 offset:384
    ds_read_b64_tr_b16 v[198:199], v22 offset:448
    v_exp_f32 v156, v156
    v_exp_f32 v157, v157
    v_mfma_f32_32x32x16_bf16 v[112:127], v[56:59], v[104:107], v[160:175]
    v_exp_f32 v158, v158
    v_exp_f32 v159, v159
    v_cvt_pk_bf16_f32 v246, v156, v157
    v_cvt_pk_bf16_f32 v247, v158, v159
    v_mfma_f32_32x32x16_bf16 v[112:127], v[60:63], v[108:111], v[112:127]
    ds_read_b64_tr_b16 v[200:201], v22 offset:512
    ds_read_b64_tr_b16 v[202:203], v22 offset:576
    ds_read_b64_tr_b16 v[204:205], v22 offset:640
    ds_read_b64_tr_b16 v[206:207], v22 offset:704
    v_exp_f32 v128, v128
    v_exp_f32 v129, v129
    v_exp_f32 v130, v130
    s_waitcnt lgkmcnt(4)
    v_mfma_f32_32x32x16_bf16 v[208:223], v[192:195], v[240:243], v[208:223]
    v_exp_f32 v131, v131
    v_cvt_pk_bf16_f32 v176, v128, v129
    v_cvt_pk_bf16_f32 v177, v130, v131
    v_exp_f32 v132, v132
    v_exp_f32 v133, v133
    v_exp_f32 v134, v134
    v_mfma_f32_32x32x16_bf16 v[208:223], v[196:199], v[244:247], v[208:223]
    v_exp_f32 v135, v135
    v_cvt_pk_bf16_f32 v178, v132, v133
    v_cvt_pk_bf16_f32 v179, v134, v135
    v_exp_f32 v136, v136
    v_exp_f32 v137, v137
    v_exp_f32 v138, v138
    v_mfma_f32_32x32x16_bf16 v[144:159], v[64:67], v[104:107], v[160:175]
    v_exp_f32 v139, v139
    v_cvt_pk_bf16_f32 v180, v136, v137
    v_cvt_pk_bf16_f32 v181, v138, v139
    v_exp_f32 v140, v140
    v_exp_f32 v141, v141
    v_exp_f32 v142, v142
    v_mfma_f32_32x32x16_bf16 v[144:159], v[68:71], v[108:111], v[144:159]
    v_exp_f32 v143, v143
    v_cvt_pk_bf16_f32 v182, v140, v141
    v_cvt_pk_bf16_f32 v183, v142, v143
    ds_read_b64_tr_b16 v[192:193], v22 offset:768
    ds_read_b64_tr_b16 v[194:195], v22 offset:832
    ds_read_b64_tr_b16 v[196:197], v22 offset:896
    ds_read_b64_tr_b16 v[198:199], v22 offset:960
    v_exp_f32 v112, v112
    v_exp_f32 v113, v113
    v_exp_f32 v114, v114
    s_waitcnt lgkmcnt(4)
    v_mfma_f32_32x32x16_bf16 v[208:223], v[200:203], v[176:179], v[208:223]
    v_exp_f32 v115, v115
    v_cvt_pk_bf16_f32 v184, v112, v113
    v_cvt_pk_bf16_f32 v185, v114, v115
    v_exp_f32 v116, v116
    v_exp_f32 v117, v117
    v_exp_f32 v118, v118
    v_mfma_f32_32x32x16_bf16 v[208:223], v[204:207], v[180:183], v[208:223]
    v_exp_f32 v119, v119
    v_cvt_pk_bf16_f32 v186, v116, v117
    v_cvt_pk_bf16_f32 v187, v118, v119
    v_exp_f32 v120, v120
    v_exp_f32 v121, v121
    v_exp_f32 v122, v122
    v_mfma_f32_32x32x16_bf16 v[128:143], v[72:75], v[104:107], v[160:175]
    v_exp_f32 v123, v123
    v_cvt_pk_bf16_f32 v188, v120, v121
    v_cvt_pk_bf16_f32 v189, v122, v123
    v_exp_f32 v124, v124
    v_exp_f32 v125, v125
    v_exp_f32 v126, v126
    v_mfma_f32_32x32x16_bf16 v[128:143], v[76:79], v[108:111], v[128:143]
    v_exp_f32 v127, v127
    v_cvt_pk_bf16_f32 v190, v124, v125
    v_cvt_pk_bf16_f32 v191, v126, v127
    ds_read_b64_tr_b16 v[200:201], v22 offset:1024
    ds_read_b64_tr_b16 v[202:203], v22 offset:1088
    ds_read_b64_tr_b16 v[204:205], v22 offset:1152
    ds_read_b64_tr_b16 v[206:207], v22 offset:1216
    v_exp_f32 v144, v144
    v_exp_f32 v145, v145
    v_exp_f32 v146, v146
    s_waitcnt lgkmcnt(4)
    v_mfma_f32_32x32x16_bf16 v[208:223], v[192:195], v[184:187], v[208:223]
    v_exp_f32 v147, v147
    v_cvt_pk_bf16_f32 v176, v144, v145
    v_cvt_pk_bf16_f32 v177, v146, v147
    v_exp_f32 v148, v148
    v_exp_f32 v149, v149
    v_exp_f32 v150, v150
    v_mfma_f32_32x32x16_bf16 v[208:223], v[196:199], v[188:191], v[208:223]
    v_exp_f32 v151, v151
    v_cvt_pk_bf16_f32 v178, v148, v149
    v_cvt_pk_bf16_f32 v179, v150, v151
    v_exp_f32 v152, v152
    v_exp_f32 v153, v153
    v_exp_f32 v154, v154
    v_mfma_f32_32x32x16_bf16 v[112:127], v[80:83], v[104:107], v[160:175]
    v_exp_f32 v155, v155
    v_cvt_pk_bf16_f32 v180, v152, v153
    v_cvt_pk_bf16_f32 v181, v154, v155
    v_exp_f32 v156, v156
    v_exp_f32 v157, v157
    v_exp_f32 v158, v158
    v_mfma_f32_32x32x16_bf16 v[112:127], v[84:87], v[108:111], v[112:127]
    v_exp_f32 v159, v159
    v_cvt_pk_bf16_f32 v182, v156, v157
    v_cvt_pk_bf16_f32 v183, v158, v159
    ds_read_b64_tr_b16 v[192:193], v22 offset:1280
    ds_read_b64_tr_b16 v[194:195], v22 offset:1344
    ds_read_b64_tr_b16 v[196:197], v22 offset:1408
    ds_read_b64_tr_b16 v[198:199], v22 offset:1472
    v_exp_f32 v128, v128
    v_exp_f32 v129, v129
    v_exp_f32 v130, v130
    s_waitcnt lgkmcnt(4)
    v_mfma_f32_32x32x16_bf16 v[208:223], v[200:203], v[176:179], v[208:223]
    v_exp_f32 v131, v131
    v_cvt_pk_bf16_f32 v184, v128, v129
    v_cvt_pk_bf16_f32 v185, v130, v131
    v_exp_f32 v132, v132
    v_exp_f32 v133, v133
    v_exp_f32 v134, v134
    v_mfma_f32_32x32x16_bf16 v[208:223], v[204:207], v[180:183], v[208:223]
    v_exp_f32 v135, v135
    v_cvt_pk_bf16_f32 v186, v132, v133
    v_cvt_pk_bf16_f32 v187, v134, v135
    v_exp_f32 v136, v136
    v_exp_f32 v137, v137
    v_exp_f32 v138, v138
    v_mfma_f32_32x32x16_bf16 v[144:159], v[88:91], v[104:107], v[160:175]
    v_exp_f32 v139, v139
    v_cvt_pk_bf16_f32 v188, v136, v137
    v_cvt_pk_bf16_f32 v189, v138, v139
    v_exp_f32 v140, v140
    v_exp_f32 v141, v141
    v_exp_f32 v142, v142
    v_mfma_f32_32x32x16_bf16 v[144:159], v[92:95], v[108:111], v[144:159]
    v_exp_f32 v143, v143
    v_cvt_pk_bf16_f32 v190, v140, v141
    v_cvt_pk_bf16_f32 v191, v142, v143
    ds_read_b64_tr_b16 v[200:201], v22 offset:1536
    ds_read_b64_tr_b16 v[202:203], v22 offset:1600
    ds_read_b64_tr_b16 v[204:205], v22 offset:1664
    ds_read_b64_tr_b16 v[206:207], v22 offset:1728
    v_exp_f32 v112, v112
    v_exp_f32 v113, v113
    v_exp_f32 v114, v114
    s_waitcnt lgkmcnt(4)
    v_mfma_f32_32x32x16_bf16 v[208:223], v[192:195], v[184:187], v[208:223]
    v_exp_f32 v115, v115
    v_cvt_pk_bf16_f32 v176, v112, v113
    v_cvt_pk_bf16_f32 v177, v114, v115
    v_exp_f32 v116, v116
    v_exp_f32 v117, v117
    v_exp_f32 v118, v118
    v_mfma_f32_32x32x16_bf16 v[208:223], v[196:199], v[188:191], v[208:223]
    v_exp_f32 v119, v119
    v_cvt_pk_bf16_f32 v178, v116, v117
    v_cvt_pk_bf16_f32 v179, v118, v119
    v_exp_f32 v120, v120
    v_exp_f32 v121, v121
    v_exp_f32 v122, v122
    v_exp_f32 v123, v123
    v_cvt_pk_bf16_f32 v180, v120, v121
    v_cvt_pk_bf16_f32 v181, v122, v123
    v_exp_f32 v124, v124
    v_exp_f32 v125, v125
    v_exp_f32 v126, v126
    v_exp_f32 v127, v127
    v_cvt_pk_bf16_f32 v182, v124, v125
    v_cvt_pk_bf16_f32 v183, v126, v127
    ds_read_b64_tr_b16 v[192:193], v22 offset:1792
    ds_read_b64_tr_b16 v[194:195], v22 offset:1856
    ds_read_b64_tr_b16 v[196:197], v22 offset:1920
    ds_read_b64_tr_b16 v[198:199], v22 offset:1984
    v_exp_f32 v144, v144
    v_exp_f32 v145, v145
    v_exp_f32 v146, v146
    s_waitcnt lgkmcnt(4)
    v_mfma_f32_32x32x16_bf16 v[208:223], v[200:203], v[176:179], v[208:223]
    v_exp_f32 v147, v147
    v_cvt_pk_bf16_f32 v184, v144, v145
    v_cvt_pk_bf16_f32 v185, v146, v147
    v_exp_f32 v148, v148
    v_exp_f32 v149, v149
    v_exp_f32 v150, v150
    v_mfma_f32_32x32x16_bf16 v[208:223], v[204:207], v[180:183], v[208:223]
    v_exp_f32 v151, v151
    v_cvt_pk_bf16_f32 v186, v148, v149
    v_cvt_pk_bf16_f32 v187, v150, v151
    v_exp_f32 v152, v152
    v_exp_f32 v153, v153
    v_exp_f32 v154, v154
    v_exp_f32 v155, v155
    v_cvt_pk_bf16_f32 v188, v152, v153
    v_cvt_pk_bf16_f32 v189, v154, v155
    v_exp_f32 v156, v156
    v_exp_f32 v157, v157
    v_exp_f32 v158, v158
    v_exp_f32 v159, v159
    v_cvt_pk_bf16_f32 v190, v156, v157
    v_cvt_pk_bf16_f32 v191, v158, v159
    s_waitcnt lgkmcnt(0)
    v_mfma_f32_32x32x16_bf16 v[208:223], v[192:195], v[184:187], v[208:223]
    v_mfma_f32_32x32x16_bf16 v[208:223], v[196:199], v[188:191], v[208:223]
    s_nop 11
    v_mov_b32 v29, v216
    v_mov_b32 v30, v216
    s_nop 1
    v_permlane32_swap_b32 v29, v30
    s_nop 7
    s_nop 7
    s_branch L_fbret0
L_fb1:
    s_nop 7
    s_nop 7
    s_waitcnt lgkmcnt(0)
    v_mfma_f32_32x32x16_bf16 v[112:127], v[32:35], v[232:235], 0
    v_mfma_f32_32x32x16_bf16 v[112:127], v[36:39], v[236:239], v[112:127]
    v_mfma_f32_32x32x16_bf16 v[128:143], v[96:99], v[232:235], 0
    v_mfma_f32_32x32x16_bf16 v[128:143], v[100:103], v[236:239], v[128:143]
    ds_read_b64_tr_b16 v[192:193], v23 offset:0
    ds_read_b64_tr_b16 v[194:195], v23 offset:64
    ds_read_b64_tr_b16 v[196:197], v23 offset:128
    ds_read_b64_tr_b16 v[198:199], v23 offset:192
    ds_read_b64_tr_b16 v[200:201], v23 offset:2048
    ds_read_b64_tr_b16 v[202:203], v23 offset:2112
    ds_read_b64_tr_b16 v[204:205], v23 offset:2176
    ds_read_b64_tr_b16 v[206:207], v23 offset:2240
    v_mfma_f32_32x32x16_bf16 v[144:159], v[40:43], v[232:235], 0
    v_mfma_f32_32x32x16_bf16 v[144:159], v[44:47], v[236:239], v[144:159]
    s_nop 1
    v_cndmask_b32 v112, v112, v128, s[40:41]
    v_cndmask_b32 v113, v113, v129, s[42:43]
    v_cndmask_b32 v114, v114, v130, s[44:45]
    v_cndmask_b32 v115, v115, v131, s[46:47]
    v_cndmask_b32 v116, v116, v132, s[48:49]
    v_cndmask_b32 v117, v117, v133, s[50:51]
    v_cndmask_b32 v118, v118, v134, s[52:53]
    v_cndmask_b32 v119, v119, v135, s[54:55]
    v_cndmask_b32 v120, v120, v136, s[56:57]
    v_cndmask_b32 v121, v121, v137, s[58:59]
    v_cndmask_b32 v122, v122, v138, s[76:77]
    v_cndmask_b32 v123, v123, v139, s[78:79]
    v_cndmask_b32 v124, v124, v140, s[80:81]
    v_cndmask_b32 v125, v125, v141, s[82:83]
    v_cndmask_b32 v126, v126, v142, s[84:85]
    v_cndmask_b32 v127, v127, v143, s[86:87]
    v_mfma_f32_32x32x16_bf16 v[128:143], v[48:51], v[232:235], 0
    v_max_f32 v28, v112, v113
    v_max3_f32 v28, v28, v114, v115
    v_max3_f32 v28, v28, v116, v117
    v_max3_f32 v28, v28, v118, v119
    v_mfma_f32_32x32x16_bf16 v[128:143], v[52:55], v[236:239], v[128:143]
    v_max3_f32 v28, v28, v120, v121
    v_max3_f32 v28, v28, v122, v123
    v_max3_f32 v28, v28, v124, v125
    v_max3_f32 v28, v28, v126, v127
    v_mfma_f32_32x32x16_bf16 v[112:127], v[56:59], v[232:235], 0
    v_max3_f32 v28, v28, v144, v145
    v_max3_f32 v28, v28, v146, v147
    v_max3_f32 v28, v28, v148, v149
    v_max3_f32 v28, v28, v150, v151
    v_mfma_f32_32x32x16_bf16 v[112:127], v[60:63], v[236:239], v[112:127]
    v_max3_f32 v28, v28, v152, v153
    v_max3_f32 v28, v28, v154, v155
    v_max3_f32 v28, v28, v156, v157
    v_max3_f32 v28, v28, v158, v159
    v_mfma_f32_32x32x16_bf16 v[144:159], v[64:67], v[232:235], 0
    v_max3_f32 v28, v28, v128, v129
    v_max3_f32 v28, v28, v130, v131
    v_max3_f32 v28, v28, v132, v133
    v_max3_f32 v28, v28, v134, v135
    v_mfma_f32_32x32x16_bf16 v[144:159], v[68:71], v[236:239], v[144:159]
    v_max3_f32 v28, v28, v136, v137
    v_max3_f32 v28, v28, v138, v139
    v_max3_f32 v28, v28, v140, v141
    v_max3_f32 v28, v28, v142, v143
    v_mfma_f32_32x32x16_bf16 v[128:143], v[72:75], v[232:235], 0
    v_max3_f32 v28, v28, v112, v113
    v_max3_f32 v28, v28, v114, v115
    v_max3_f32 v28, v28, v116, v117
    v_max3_f32 v28, v28, v118, v119
    v_mfma_f32_32x32x16_bf16 v[128:143], v[76:79], v[236:239], v[128:143]
    v_max3_f32 v28, v28, v120, v121
    v_max3_f32 v28, v28, v122, v123
    v_max3_f32 v28, v28, v124, v125
    v_max3_f32 v28, v28, v126, v127
    v_mfma_f32_32x32x16_bf16 v[112:127], v[80:83], v[232:235], 0
    v_max3_f32 v28, v28, v144, v145
    v_max3_f32 v28, v28, v146, v147
    v_max3_f32 v28, v28, v148, v149
    v_max3_f32 v28, v28, v150, v151
    v_mfma_f32_32x32x16_bf16 v[112:127], v[84:87], v[236:239], v[112:127]
    v_max3_f32 v28, v28, v152, v153
    v_max3_f32 v28, v28, v154, v155
    v_max3_f32 v28, v28, v156, v157
    v_max3_f32 v28, v28, v158, v159
    v_mfma_f32_32x32x16_bf16 v[144:159], v[88:91], v[232:235], 0
    v_max3_f32 v28, v28, v128, v129
    v_max3_f32 v28, v28, v130, v131
    v_max3_f32 v28, v28, v132, v133
    v_max3_f32 v28, v28, v134, v135
    v_mfma_f32_32x32x16_bf16 v[144:159], v[92:95], v[236:239], v[144:159]
    v_max3_f32 v28, v28, v136, v137
    v_max3_f32 v28, v28, v138, v139
    v_max3_f32 v28, v28, v140, v141
    v_max3_f32 v28, v28, v142, v143
    v_max3_f32 v28, v28, v112, v113
    v_max3_f32 v28, v28, v114, v115
    v_max3_f32 v28, v28, v116, v117
    v_max3_f32 v28, v28, v118, v119
    v_max3_f32 v28, v28, v120, v121
    v_max3_f32 v28, v28, v122, v123
    v_max3_f32 v28, v28, v124, v125
    v_max3_f32 v28, v28, v126, v127
    v_max3_f32 v28, v28, v144, v145
    v_max3_f32 v28, v28, v146, v147
    v_max3_f32 v28, v28, v148, v149
    v_max3_f32 v28, v28, v150, v151
    v_max3_f32 v28, v28, v152, v153
    v_max3_f32 v28, v28, v154, v155
    v_max3_f32 v28, v28, v156, v157
    v_max3_f32 v28, v28, v158, v159
    v_mov_b32 v29, v28
    v_mov_b32 v30, v28
    s_nop 1
    v_permlane32_swap_b32 v29, v30
    v_max_f32 v28, v29, v30
    v_sub_f32 v28, 0, v28
    v_mov_b32 v160, v28
    v_mov_b32 v161, v28
    v_mov_b32 v162, v28
    v_mov_b32 v163, v28
    v_mov_b32 v164, v28
    v_mov_b32 v165, v28
    v_mov_b32 v166, v28
    v_mov_b32 v167, v28
    v_mov_b32 v168, v28
    v_mov_b32 v169, v28
    v_mov_b32 v170, v28
    v_mov_b32 v171, v28
    v_mov_b32 v172, v28
    v_mov_b32 v173, v28
    v_mov_b32 v174, v28
    v_mov_b32 v175, v28
    s_nop 1
    v_mfma_f32_32x32x16_bf16 v[112:127], v[32:35], v[232:235], v[160:175]
    v_mfma_f32_32x32x16_bf16 v[112:127], v[36:39], v[236:239], v[112:127]
    v_mfma_f32_32x32x16_bf16 v[128:143], v[96:99], v[232:235], v[160:175]
    v_mfma_f32_32x32x16_bf16 v[128:143], v[100:103], v[236:239], v[128:143]
    v_mfma_f32_32x32x16_bf16 v[144:159], v[40:43], v[232:235], v[160:175]
    v_mfma_f32_32x32x16_bf16 v[144:159], v[44:47], v[236:239], v[144:159]
    s_nop 9
    v_cndmask_b32 v112, v112, v128, s[40:41]
    v_cndmask_b32 v113, v113, v129, s[42:43]
    v_cndmask_b32 v114, v114, v130, s[44:45]
    v_cndmask_b32 v115, v115, v131, s[46:47]
    v_cndmask_b32 v116, v116, v132, s[48:49]
    v_cndmask_b32 v117, v117, v133, s[50:51]
    v_cndmask_b32 v118, v118, v134, s[52:53]
    v_cndmask_b32 v119, v119, v135, s[54:55]
    v_cndmask_b32 v120, v120, v136, s[56:57]
    v_cndmask_b32 v121, v121, v137, s[58:59]
    v_cndmask_b32 v122, v122, v138, s[76:77]
    v_cndmask_b32 v123, v123, v139, s[78:79]
    v_cndmask_b32 v124, v124, v140, s[80:81]
    v_cndmask_b32 v125, v125, v141, s[82:83]
    v_cndmask_b32 v126, v126, v142, s[84:85]
    v_cndmask_b32 v127, v127, v143, s[86:87]
    v_exp_f32 v112, v112
    v_exp_f32 v113, v113
    v_mfma_f32_32x32x16_bf16 v[128:143], v[48:51], v[232:235], v[160:175]
    v_exp_f32 v114, v114
    v_exp_f32 v115, v115
    v_cvt_pk_bf16_f32 v176, v112, v113
    v_cvt_pk_bf16_f32 v177, v114, v115
    v_exp_f32 v116, v116
    v_exp_f32 v117, v117
    v_exp_f32 v118, v118
    v_exp_f32 v119, v119
    v_mfma_f32_32x32x16_bf16 v[128:143], v[52:55], v[236:239], v[128:143]
    v_cvt_pk_bf16_f32 v178, v116, v117
    v_cvt_pk_bf16_f32 v179, v118, v119
    v_exp_f32 v120, v120
    v_exp_f32 v121, v121
    v_exp_f32 v122, v122
    v_exp_f32 v123, v123
    v_cvt_pk_bf16_f32 v180, v120, v121
    v_cvt_pk_bf16_f32 v181, v122, v123
    v_exp_f32 v124, v124
    v_exp_f32 v125, v125
    v_exp_f32 v126, v126
    v_exp_f32 v127, v127
    v_cvt_pk_bf16_f32 v182, v124, v125
    v_cvt_pk_bf16_f32 v183, v126, v127
    v_and_b32 v184, v176, v224
    v_xor_b32 v176, v176, v184
    v_and_b32 v185, v177, v225
    v_xor_b32 v177, v177, v185
    v_and_b32 v186, v178, v226
    v_xor_b32 v178, v178, v186
    v_and_b32 v187, v179, v227
    v_xor_b32 v179, v179, v187
    v_and_b32 v188, v180, v228
    v_xor_b32 v180, v180, v188
    v_and_b32 v189, v181, v229
    v_xor_b32 v181, v181, v189
    v_and_b32 v190, v182, v230
    v_xor_b32 v182, v182, v190
    v_and_b32 v191, v183, v231
    v_xor_b32 v183, v183, v191
    s_waitcnt lgkmcnt(0)
    v_mfma_f32_32x32x16_bf16 v[208:223], v[192:195], v[176:179], 0
    v_exp_f32 v144, v144
    v_exp_f32 v145, v145
    v_exp_f32 v146, v146
    v_exp_f32 v147, v147
    v_cvt_pk_bf16_f32 v240, v144, v145
    v_mfma_f32_32x32x16_bf16 v[208:223], v[196:199], v[180:183], v[208:223]
    v_cvt_pk_bf16_f32 v241, v146, v147
    v_exp_f32 v148, v148
    v_exp_f32 v149, v149
    v_exp_f32 v150, v150
    v_exp_f32 v151, v151
    v_mfma_f32_32x32x16_bf16 v[208:223], v[200:203], v[184:187], v[208:223]
    v_cvt_pk_bf16_f32 v242, v148, v149
    v_cvt_pk_bf16_f32 v243, v150, v151
    v_exp_f32 v152, v152
    v_exp_f32 v153, v153
    v_exp_f32 v154, v154
    v_mfma_f32_32x32x16_bf16 v[208:223], v[204:207], v[188:191], v[208:223]
    v_exp_f32 v155, v155
    v_cvt_pk_bf16_f32 v244, v152, v153
    v_cvt_pk_bf16_f32 v245, v154, v155
    ds_read_b64_tr_b16 v[192:193], v23 offset:256
    ds_read_b64_tr_b16 v[194:195], v23 offset:320
    ds_read_b64_tr_b16 v[196:197], v23 offset:384
    ds_read_b64_tr_b16 v[198:199], v23 offset:448
    v_exp_f32 v156, v156
    v_exp_f32 v157, v157
    v_mfma_f32_32x32x16_bf16 v[112:127], v[56:59], v[232:235], v[160:175]
    v_exp_f32 v158, v158
    v_exp_f32 v159, v159
    v_cvt_pk_bf16_f32 v246, v156, v157
    v_cvt_pk_bf16_f32 v247, v158, v159
    v_mfma_f32_32x32x16_bf16 v[112:127], v[60:63], v[236:239], v[112:127]
    ds_read_b64_tr_b16 v[200:201], v23 offset:512
    ds_read_b64_tr_b16 v[202:203], v23 offset:576
    ds_read_b64_tr_b16 v[204:205], v23 offset:640
    ds_read_b64_tr_b16 v[206:207], v23 offset:704
    v_exp_f32 v128, v128
    v_exp_f32 v129, v129
    v_exp_f32 v130, v130
    s_waitcnt lgkmcnt(4)
    v_mfma_f32_32x32x16_bf16 v[208:223], v[192:195], v[240:243], v[208:223]
    v_exp_f32 v131, v131
    v_cvt_pk_bf16_f32 v176, v128, v129
    v_cvt_pk_bf16_f32 v177, v130, v131
    v_exp_f32 v132, v132
    v_exp_f32 v133, v133
    v_exp_f32 v134, v134
    v_mfma_f32_32x32x16_bf16 v[208:223], v[196:199], v[244:247], v[208:223]
    v_exp_f32 v135, v135
    v_cvt_pk_bf16_f32 v178, v132, v133
    v_cvt_pk_bf16_f32 v179, v134, v135
    v_exp_f32 v136, v136
    v_exp_f32 v137, v137
    v_exp_f32 v138, v138
    v_mfma_f32_32x32x16_bf16 v[144:159], v[64:67], v[232:235], v[160:175]
    v_exp_f32 v139, v139
    v_cvt_pk_bf16_f32 v180, v136, v137
    v_cvt_pk_bf16_f32 v181, v138, v139
    v_exp_f32 v140, v140
    v_exp_f32 v141, v141
    v_exp_f32 v142, v142
    v_mfma_f32_32x32x16_bf16 v[144:159], v[68:71], v[236:239], v[144:159]
    v_exp_f32 v143, v143
    v_cvt_pk_bf16_f32 v182, v140, v141
    v_cvt_pk_bf16_f32 v183, v142, v143
    ds_read_b64_tr_b16 v[192:193], v23 offset:768
    ds_read_b64_tr_b16 v[194:195], v23 offset:832
    ds_read_b64_tr_b16 v[196:197], v23 offset:896
    ds_read_b64_tr_b16 v[198:199], v23 offset:960
    v_exp_f32 v112, v112
    v_exp_f32 v113, v113
    v_exp_f32 v114, v114
    s_waitcnt lgkmcnt(4)
    v_mfma_f32_32x32x16_bf16 v[208:223], v[200:203], v[176:179], v[208:223]
    v_exp_f32 v115, v115
    v_cvt_pk_bf16_f32 v184, v112, v113
    v_cvt_pk_bf16_f32 v185, v114, v115
    v_exp_f32 v116, v116
    v_exp_f32 v117, v117
    v_exp_f32 v118, v118
    v_mfma_f32_32x32x16_bf16 v[208:223], v[204:207], v[180:183], v[208:223]
    v_exp_f32 v119, v119
    v_cvt_pk_bf16_f32 v186, v116, v117
    v_cvt_pk_bf16_f32 v187, v118, v119
    v_exp_f32 v120, v120
    v_exp_f32 v121, v121
    v_exp_f32 v122, v122
    v_mfma_f32_32x32x16_bf16 v[128:143], v[72:75], v[232:235], v[160:175]
    v_exp_f32 v123, v123
    v_cvt_pk_bf16_f32 v188, v120, v121
    v_cvt_pk_bf16_f32 v189, v122, v123
    v_exp_f32 v124, v124
    v_exp_f32 v125, v125
    v_exp_f32 v126, v126
    v_mfma_f32_32x32x16_bf16 v[128:143], v[76:79], v[236:239], v[128:143]
    v_exp_f32 v127, v127
    v_cvt_pk_bf16_f32 v190, v124, v125
    v_cvt_pk_bf16_f32 v191, v126, v127
    ds_read_b64_tr_b16 v[200:201], v23 offset:1024
    ds_read_b64_tr_b16 v[202:203], v23 offset:1088
    ds_read_b64_tr_b16 v[204:205], v23 offset:1152
    ds_read_b64_tr_b16 v[206:207], v23 offset:1216
    v_exp_f32 v144, v144
    v_exp_f32 v145, v145
    v_exp_f32 v146, v146
    s_waitcnt lgkmcnt(4)
    v_mfma_f32_32x32x16_bf16 v[208:223], v[192:195], v[184:187], v[208:223]
    v_exp_f32 v147, v147
    v_cvt_pk_bf16_f32 v176, v144, v145
    v_cvt_pk_bf16_f32 v177, v146, v147
    v_exp_f32 v148, v148
    v_exp_f32 v149, v149
    v_exp_f32 v150, v150
    v_mfma_f32_32x32x16_bf16 v[208:223], v[196:199], v[188:191], v[208:223]
    v_exp_f32 v151, v151
    v_cvt_pk_bf16_f32 v178, v148, v149
    v_cvt_pk_bf16_f32 v179, v150, v151
    v_exp_f32 v152, v152
    v_exp_f32 v153, v153
    v_exp_f32 v154, v154
    v_mfma_f32_32x32x16_bf16 v[112:127], v[80:83], v[232:235], v[160:175]
    v_exp_f32 v155, v155
    v_cvt_pk_bf16_f32 v180, v152, v153
    v_cvt_pk_bf16_f32 v181, v154, v155
    v_exp_f32 v156, v156
    v_exp_f32 v157, v157
    v_exp_f32 v158, v158
    v_mfma_f32_32x32x16_bf16 v[112:127], v[84:87], v[236:239], v[112:127]
    v_exp_f32 v159, v159
    v_cvt_pk_bf16_f32 v182, v156, v157
    v_cvt_pk_bf16_f32 v183, v158, v159
    ds_read_b64_tr_b16 v[192:193], v23 offset:1280
    ds_read_b64_tr_b16 v[194:195], v23 offset:1344
    ds_read_b64_tr_b16 v[196:197], v23 offset:1408
    ds_read_b64_tr_b16 v[198:199], v23 offset:1472
    v_exp_f32 v128, v128
    v_exp_f32 v129, v129
    v_exp_f32 v130, v130
    s_waitcnt lgkmcnt(4)
    v_mfma_f32_32x32x16_bf16 v[208:223], v[200:203], v[176:179], v[208:223]
    v_exp_f32 v131, v131
    v_cvt_pk_bf16_f32 v184, v128, v129
    v_cvt_pk_bf16_f32 v185, v130, v131
    v_exp_f32 v132, v132
    v_exp_f32 v133, v133
    v_exp_f32 v134, v134
    v_mfma_f32_32x32x16_bf16 v[208:223], v[204:207], v[180:183], v[208:223]
    v_exp_f32 v135, v135
    v_cvt_pk_bf16_f32 v186, v132, v133
    v_cvt_pk_bf16_f32 v187, v134, v135
    v_exp_f32 v136, v136
    v_exp_f32 v137, v137
    v_exp_f32 v138, v138
    v_mfma_f32_32x32x16_bf16 v[144:159], v[88:91], v[232:235], v[160:175]
    v_exp_f32 v139, v139
    v_cvt_pk_bf16_f32 v188, v136, v137
    v_cvt_pk_bf16_f32 v189, v138, v139
    v_exp_f32 v140, v140
    v_exp_f32 v141, v141
    v_exp_f32 v142, v142
    v_mfma_f32_32x32x16_bf16 v[144:159], v[92:95], v[236:239], v[144:159]
    v_exp_f32 v143, v143
    v_cvt_pk_bf16_f32 v190, v140, v141
    v_cvt_pk_bf16_f32 v191, v142, v143
    ds_read_b64_tr_b16 v[200:201], v23 offset:1536
    ds_read_b64_tr_b16 v[202:203], v23 offset:1600
    ds_read_b64_tr_b16 v[204:205], v23 offset:1664
    ds_read_b64_tr_b16 v[206:207], v23 offset:1728
    v_exp_f32 v112, v112
    v_exp_f32 v113, v113
    v_exp_f32 v114, v114
    s_waitcnt lgkmcnt(4)
    v_mfma_f32_32x32x16_bf16 v[208:223], v[192:195], v[184:187], v[208:223]
    v_exp_f32 v115, v115
    v_cvt_pk_bf16_f32 v176, v112, v113
    v_cvt_pk_bf16_f32 v177, v114, v115
    v_exp_f32 v116, v116
    v_exp_f32 v117, v117
    v_exp_f32 v118, v118
    v_mfma_f32_32x32x16_bf16 v[208:223], v[196:199], v[188:191], v[208:223]
    v_exp_f32 v119, v119
    v_cvt_pk_bf16_f32 v178, v116, v117
    v_cvt_pk_bf16_f32 v179, v118, v119
    v_exp_f32 v120, v120
    v_exp_f32 v121, v121
    v_exp_f32 v122, v122
    v_exp_f32 v123, v123
    v_cvt_pk_bf16_f32 v180, v120, v121
    v_cvt_pk_bf16_f32 v181, v122, v123
    v_exp_f32 v124, v124
    v_exp_f32 v125, v125
    v_exp_f32 v126, v126
    v_exp_f32 v127, v127
    v_cvt_pk_bf16_f32 v182, v124, v125
    v_cvt_pk_bf16_f32 v183, v126, v127
    ds_read_b64_tr_b16 v[192:193], v23 offset:1792
    ds_read_b64_tr_b16 v[194:195], v23 offset:1856
    ds_read_b64_tr_b16 v[196:197], v23 offset:1920
    ds_read_b64_tr_b16 v[198:199], v23 offset:1984
    v_exp_f32 v144, v144
    v_exp_f32 v145, v145
    v_exp_f32 v146, v146
    s_waitcnt lgkmcnt(4)
    v_mfma_f32_32x32x16_bf16 v[208:223], v[200:203], v[176:179], v[208:223]
    v_exp_f32 v147, v147
    v_cvt_pk_bf16_f32 v184, v144, v145
    v_cvt_pk_bf16_f32 v185, v146, v147
    v_exp_f32 v148, v148
    v_exp_f32 v149, v149
    v_exp_f32 v150, v150
    v_mfma_f32_32x32x16_bf16 v[208:223], v[204:207], v[180:183], v[208:223]
    v_exp_f32 v151, v151
    v_cvt_pk_bf16_f32 v186, v148, v149
    v_cvt_pk_bf16_f32 v187, v150, v151
    v_exp_f32 v152, v152
    v_exp_f32 v153, v153
    v_exp_f32 v154, v154
    v_exp_f32 v155, v155
    v_cvt_pk_bf16_f32 v188, v152, v153
    v_cvt_pk_bf16_f32 v189, v154, v155
    v_exp_f32 v156, v156
    v_exp_f32 v157, v157
    v_exp_f32 v158, v158
    v_exp_f32 v159, v159
    v_cvt_pk_bf16_f32 v190, v156, v157
    v_cvt_pk_bf16_f32 v191, v158, v159
    s_waitcnt lgkmcnt(0)
    v_mfma_f32_32x32x16_bf16 v[208:223], v[192:195], v[184:187], v[208:223]
    v_mfma_f32_32x32x16_bf16 v[208:223], v[196:199], v[188:191], v[208:223]
    s_nop 11
    v_mov_b32 v29, v216
    v_mov_b32 v30, v216
    s_nop 1
    v_permlane32_swap_b32 v29, v30
    s_nop 7
    s_nop 7
    s_branch L_fbret1
L_G2ROLE:
    s_sub_u32 s87, s3, 4
    s_and_b32 s62, s2, 7
    s_lshr_b32 s63, s2, 3
    s_mul_i32 s64, s63, 52
    s_lshr_b32 s64, s64, 8
    s_mul_i32 s65, s64, 5
    s_sub_u32 s65, s63, s65
    s_and_b32 s61, s62, 1
    s_mul_i32 s61, s61, 5
    s_add_u32 s61, s61, s65
    s_lshr_b32 s62, s62, 1
    s_mul_i32 s60, s62, 6
    s_cmp_eq_u32 s62, 3
    s_cselect_b32 s65, 17, s60
    s_mov_b32 s60, s65
    s_cmp_ge_u32 s62, 2
    s_cselect_b32 s65, 5, 6
    s_cmp_ge_u32 s64, s65
    s_cselect_b32 s86, 1, 0
    s_add_u32 s60, s60, s64
    s_cmp_eq_u32 s86, 0
    s_cbranch_scc1 L_g2_active
    s_waitcnt vmcnt(0)
    v_mov_b32 v8, 163460
    v_mov_b32 v9, 1
    s_mov_b64 exec, 1
    ds_add_rtn_u32 v10, v8, v9
    s_waitcnt lgkmcnt(0)
    v_readfirstlane_b32 s64, v10
    s_mov_b64 exec, -1
    s_cmp_lg_u32 s64, 7
    s_cbranch_scc1 L_csB2
    v_mov_b32 v9, 163480
    ds_read_b32 v8, v9
    s_lshl_b32 s64, s92, 7
    s_add_u32 s64, s64, 18907136
    v_mov_b32 v9, s64
    s_waitcnt lgkmcnt(0)
    s_mov_b64 exec, 1
    buffer_store_dword v8, v9, s[36:39], 0 offen sc1
    s_mov_b64 exec, -1
L_csB2:
    s_branch L_END
L_g2_active:
    v_and_b32 v2, 15, v1
    v_lshrrev_b32 v3, 4, v1
    v_lshlrev_b32 v4, 4, v1
    v_lshrrev_b32 v5, 3, v1
    v_and_b32 v6, 7, v1
    v_lshlrev_b32 v7, 1, v3
    v_xor_b32 v6, v6, v7
    v_lshlrev_b32 v6, 4, v6
    v_add_u32 v7, 0, v5
    v_mul_u32_u24 v10, 1280, v7
    v_add_u32 v10, v10, v6
    v_add_u32 v7, 8, v5
    v_mul_u32_u24 v11, 1280, v7
    v_add_u32 v11, v11, v6
    v_add_u32 v7, 16, v5
    v_mul_u32_u24 v12, 1280, v7
    v_add_u32 v12, v12, v6
    v_add_u32 v7, 24, v5
    v_mul_u32_u24 v13, 1280, v7
    v_add_u32 v13, v13, v6
    s_mul_i32 s65, s87, 20480
    s_mul_i32 s69, s87, 491520
    s_lshl_b32 s64, s61, 7
    s_add_u32 s69, s69, s64
    s_mul_i32 s70, s87, 204800
    s_add_u32 s70, s70, s64
    s_waitcnt vmcnt(0)
    v_mov_b32 v7, 163460
    v_mov_b32 v8, 1
    s_mov_b64 exec, 1
    ds_add_rtn_u32 v9, v7, v8
    s_waitcnt lgkmcnt(0)
    v_readfirstlane_b32 s64, v9
    s_mov_b64 exec, -1
    s_cmp_lg_u32 s64, 7
    s_cbranch_scc1 L_csB3
    v_mov_b32 v8, 163480
    ds_read_b32 v7, v8
    s_lshl_b32 s64, s92, 7
    s_add_u32 s64, s64, 18907136
    v_mov_b32 v8, s64
    s_waitcnt lgkmcnt(0)
    s_mov_b64 exec, 1
    buffer_store_dword v7, v8, s[36:39], 0 offen sc1
    s_mov_b64 exec, -1
L_csB3:
    s_add_u32 m0, s65, 0
    s_nop 0
    buffer_load_dwordx4 v10, s[20:23], s69 offen lds
    s_add_u32 m0, s65, 1024
    s_nop 0
    buffer_load_dwordx4 v11, s[20:23], s69 offen lds
    s_add_u32 m0, s65, 2048
    s_nop 0
    buffer_load_dwordx4 v12, s[20:23], s69 offen lds
    s_add_u32 m0, s65, 3072
    s_nop 0
    buffer_load_dwordx4 v13, s[20:23], s69 offen lds
    s_add_u32 s69, s69, 40960
    s_add_u32 m0, s65, 4096
    s_nop 0
    buffer_load_dwordx4 v10, s[20:23], s69 offen lds
    s_add_u32 m0, s65, 5120
    s_nop 0
    buffer_load_dwordx4 v11, s[20:23], s69 offen lds
    s_add_u32 m0, s65, 6144
    s_nop 0
    buffer_load_dwordx4 v12, s[20:23], s69 offen lds
    s_add_u32 m0, s65, 7168
    s_nop 0
    buffer_load_dwordx4 v13, s[20:23], s69 offen lds
    s_add_u32 s69, s69, 40960
    s_add_u32 m0, s65, 8192
    s_nop 0
    buffer_load_dwordx4 v10, s[20:23], s69 offen lds
    s_add_u32 m0, s65, 9216
    s_nop 0
    buffer_load_dwordx4 v11, s[20:23], s69 offen lds
    s_add_u32 m0, s65, 10240
    s_nop 0
    buffer_load_dwordx4 v12, s[20:23], s69 offen lds
    s_add_u32 m0, s65, 11264
    s_nop 0
    buffer_load_dwordx4 v13, s[20:23], s69 offen lds
    s_add_u32 s69, s69, 40960
    s_add_u32 m0, s65, 12288
    s_nop 0
    buffer_load_dwordx4 v10, s[20:23], s69 offen lds
    s_add_u32 m0, s65, 13312
    s_nop 0
    buffer_load_dwordx4 v11, s[20:23], s69 offen lds
    s_add_u32 m0, s65, 14336
    s_nop 0
    buffer_load_dwordx4 v12, s[20:23], s69 offen lds
    s_add_u32 m0, s65, 15360
    s_nop 0
    buffer_load_dwordx4 v13, s[20:23], s69 offen lds
    s_add_u32 s69, s69, 40960
    v_add_u32 v7, 0, v5
    v_bfe_u32 v8, v7, 2, 2
    v_lshlrev_b32 v8, 3, v8
    v_lshrrev_b32 v9, 4, v7
    v_lshl_add_u32 v8, v9, 2, v8
    v_and_b32 v9, 3, v7
    v_add_u32 v8, v8, v9
    v_mul_u32_u24 v14, 1280, v8
    v_add_u32 v14, v14, v6
    v_add_u32 v7, 8, v5
    v_bfe_u32 v8, v7, 2, 2
    v_lshlrev_b32 v8, 3, v8
    v_lshrrev_b32 v9, 4, v7
    v_lshl_add_u32 v8, v9, 2, v8
    v_and_b32 v9, 3, v7
    v_add_u32 v8, v8, v9
    v_mul_u32_u24 v15, 1280, v8
    v_add_u32 v15, v15, v6
    v_add_u32 v7, 16, v5
    v_bfe_u32 v8, v7, 2, 2
    v_lshlrev_b32 v8, 3, v8
    v_lshrrev_b32 v9, 4, v7
    v_lshl_add_u32 v8, v9, 2, v8
    v_and_b32 v9, 3, v7
    v_add_u32 v8, v8, v9
    v_mul_u32_u24 v16, 1280, v8
    v_add_u32 v16, v16, v6
    v_add_u32 v7, 24, v5
    v_bfe_u32 v8, v7, 2, 2
    v_lshlrev_b32 v8, 3, v8
    v_lshrrev_b32 v9, 4, v7
    v_lshl_add_u32 v8, v9, 2, v8
    v_and_b32 v9, 3, v7
    v_add_u32 v8, v8, v9
    v_mul_u32_u24 v17, 1280, v8
    v_add_u32 v17, v17, v6
    s_mul_i32 s66, s60, 288
    s_mul_i32 s64, s87, 24
    s_add_u32 s66, s66, s64
    s_lshl_b32 s66, s66, 10
    s_add_u32 s66, s66, 8388608
    s_add_u32 s67, s66, 98304
    s_add_u32 s68, s67, 98304
    s_cmp_eq_u32 s60, 21
    s_cselect_b32 s67, 0x7ff00000, s67
    s_cselect_b32 s68, 0x7ff00000, s68
    s_cselect_b32 s73, 1, 0
    s_mul_i32 s71, s60, 122880
    s_mul_i32 s64, s87, 5120
    s_add_u32 s71, s71, s64
    s_add_u32 s71, s71, 14942208
    s_mul_i32 s72, s60, 96
    s_lshr_b32 s72, s72, 7
    s_min_u32 s72, s72, 14
    s_lshl_b32 s72, s72, 4
    v_bfe_u32 v5, v1, 2, 2
    v_and_b32 v6, 3, v1
    v_lshl_add_u32 v7, v3, 2, v5
    v_bfe_u32 v8, v7, 1, 2
    v_lshlrev_b32 v7, 7, v7
    v_lshl_add_u32 v7, v6, 3, v7
    v_add_u32 v7, s65, v7
    v_add_u32 v18, 0, v4
    v_add_u32 v19, 20480, v4
    v_add_u32 v20, 40960, v4
    v_add_u32 v21, 61440, v4
    v_add_u32 v22, 81920, v4
    v_add_u32 v23, 102400, v4
    s_cmp_eq_u32 s73, 0
    s_cbranch_scc1 L_rbok
    v_mov_b32 v20, 0x7fffff00
    v_mov_b32 v21, 0x7fffff00
    v_mov_b32 v22, 0x7fffff00
    v_mov_b32 v23, 0x7fffff00
L_rbok:
    v_xor_b32 v9, 0, v8
    v_lshl_add_u32 v24, v9, 5, v7
    v_xor_b32 v9, 1, v8
    v_lshl_add_u32 v25, v9, 5, v7
    v_xor_b32 v9, 2, v8
    v_lshl_add_u32 v26, v9, 5, v7
    v_xor_b32 v9, 3, v8
    v_lshl_add_u32 v27, v9, 5, v7
    v_mov_b32 v160, 0
    v_mov_b32 v161, 0
    v_mov_b32 v162, 0
    v_mov_b32 v163, 0
    v_mov_b32 v164, 0
    v_mov_b32 v165, 0
    v_mov_b32 v166, 0
    v_mov_b32 v167, 0
    v_mov_b32 v168, 0
    v_mov_b32 v169, 0
    v_mov_b32 v170, 0
    v_mov_b32 v171, 0
    v_mov_b32 v172, 0
    v_mov_b32 v173, 0
    v_mov_b32 v174, 0
    v_mov_b32 v175, 0
    v_mov_b32 v176, 0
    v_mov_b32 v177, 0
    v_mov_b32 v178, 0
    v_mov_b32 v179, 0
    v_mov_b32 v180, 0
    v_mov_b32 v181, 0
    v_mov_b32 v182, 0
    v_mov_b32 v183, 0
    v_mov_b32 v184, 0
    v_mov_b32 v185, 0
    v_mov_b32 v186, 0
    v_mov_b32 v187, 0
    v_mov_b32 v188, 0
    v_mov_b32 v189, 0
    v_mov_b32 v190, 0
    v_mov_b32 v191, 0
    v_mov_b32 v192, 0
    v_mov_b32 v193, 0
    v_mov_b32 v194, 0
    v_mov_b32 v195, 0
    v_mov_b32 v196, 0
    v_mov_b32 v197, 0
    v_mov_b32 v198, 0
    v_mov_b32 v199, 0
    v_mov_b32 v200, 0
    v_mov_b32 v201, 0
    v_mov_b32 v202, 0
    v_mov_b32 v203, 0
    v_mov_b32 v204, 0
    v_mov_b32 v205, 0
    v_mov_b32 v206, 0
    v_mov_b32 v207, 0
    v_mov_b32 v208, 0
    v_mov_b32 v209, 0
    v_mov_b32 v210, 0
    v_mov_b32 v211, 0
    v_mov_b32 v212, 0
    v_mov_b32 v213, 0
    v_mov_b32 v214, 0
    v_mov_b32 v215, 0
    v_mov_b32 v216, 0
    v_mov_b32 v217, 0
    v_mov_b32 v218, 0
    v_mov_b32 v219, 0
    v_mov_b32 v220, 0
    v_mov_b32 v221, 0
    v_mov_b32 v222, 0
    v_mov_b32 v223, 0
    v_mov_b32 v224, 0
    v_mov_b32 v225, 0
    v_mov_b32 v226, 0
    v_mov_b32 v227, 0
    v_mov_b32 v228, 0
    v_mov_b32 v229, 0
    v_mov_b32 v230, 0
    v_mov_b32 v231, 0
    v_mov_b32 v232, 0
    v_mov_b32 v233, 0
    v_mov_b32 v234, 0
    v_mov_b32 v235, 0
    v_mov_b32 v236, 0
    v_mov_b32 v237, 0
    v_mov_b32 v238, 0
    v_mov_b32 v239, 0
    v_mov_b32 v240, 0
    v_mov_b32 v241, 0
    v_mov_b32 v242, 0
    v_mov_b32 v243, 0
    v_mov_b32 v244, 0
    v_mov_b32 v245, 0
    v_mov_b32 v246, 0
    v_mov_b32 v247, 0
    v_mov_b32 v248, 0
    v_mov_b32 v249, 0
    v_mov_b32 v250, 0
    v_mov_b32 v251, 0
    v_mov_b32 v252, 0
    v_mov_b32 v253, 0
    v_mov_b32 v254, 0
    v_mov_b32 v255, 0
    s_cmp_lg_u32 s3, 4
    s_cbranch_scc1 L_pbwH
    v_mov_b32 v5, 163480
    ds_read_b32 v6, v5
    v_cmp_gt_u32 vcc, 32, v1
    s_nop 1
    v_cndmask_b32 v5, 0, v1, vcc
    v_add_u32 v5, s72, v5
    v_lshlrev_b32 v5, 7, v5
    v_add_u32 v5, 18907136, v5
    s_waitcnt lgkmcnt(0)
    v_readfirstlane_b32 s85, v6
L_pollH:
    buffer_load_dword v6, v5, s[36:39], 0 offen sc1
    s_waitcnt vmcnt(0)
    v_cmp_ne_u32 vcc, s85, v6
    s_nop 0
    s_cmp_eq_u64 vcc, 0
    s_cbranch_scc1 L_polldH
    s_sleep 2
    s_branch L_pollH
L_polldH:
    v_mov_b32 v5, 163472
    v_mov_b32 v6, 1
    ds_write_b32 v5, v6
    s_waitcnt lgkmcnt(0)
    s_branch L_pbdH
L_pbwH:
    v_mov_b32 v5, 163472
L_pbsH:
    ds_read_b32 v6, v5
    s_waitcnt lgkmcnt(0)
    v_readfirstlane_b32 s64, v6
    s_nop 0
    s_cmp_lg_u32 s64, 0
    s_cbranch_scc1 L_pbdH
    s_sleep 1
    s_branch L_pbsH
L_pbdH:
    buffer_load_dwordx4 v[64:67], v4, s[36:39], s66 offen offset:0 sc1
    buffer_load_dwordx4 v[68:71], v4, s[36:39], s66 offen offset:1024 sc1
    s_add_u32 s66, s66, 2048
    buffer_load_dwordx4 v[72:75], v4, s[36:39], s67 offen offset:0 sc1
    buffer_load_dwordx4 v[76:79], v4, s[36:39], s67 offen offset:1024 sc1
    s_add_u32 s67, s67, 2048
    buffer_load_dwordx4 v[80:83], v4, s[36:39], s68 offen offset:0 sc1
    buffer_load_dwordx4 v[84:87], v4, s[36:39], s68 offen offset:1024 sc1
    s_add_u32 s68, s68, 2048
    buffer_load_dwordx4 v[88:91], v4, s[36:39], s66 offen offset:0 sc1
    buffer_load_dwordx4 v[92:95], v4, s[36:39], s66 offen offset:1024 sc1
    s_add_u32 s66, s66, 2048
    buffer_load_dwordx4 v[96:99], v4, s[36:39], s67 offen offset:0 sc1
    buffer_load_dwordx4 v[100:103], v4, s[36:39], s67 offen offset:1024 sc1
    s_add_u32 s67, s67, 2048
    buffer_load_dwordx4 v[104:107], v4, s[36:39], s68 offen offset:0 sc1
    buffer_load_dwordx4 v[108:111], v4, s[36:39], s68 offen offset:1024 sc1
    s_add_u32 s68, s68, 2048
    buffer_load_dwordx4 v[112:115], v4, s[36:39], s66 offen offset:0 sc1
    buffer_load_dwordx4 v[116:119], v4, s[36:39], s66 offen offset:1024 sc1
    s_add_u32 s66, s66, 2048
    buffer_load_dwordx4 v[120:123], v4, s[36:39], s67 offen offset:0 sc1
    buffer_load_dwordx4 v[124:127], v4, s[36:39], s67 offen offset:1024 sc1
    s_add_u32 s67, s67, 2048
    buffer_load_dwordx4 v[128:131], v4, s[36:39], s68 offen offset:0 sc1
    buffer_load_dwordx4 v[132:135], v4, s[36:39], s68 offen offset:1024 sc1
    s_add_u32 s68, s68, 2048
    v_lshlrev_b32 v5, 2, v2
    s_mul_i32 s64, s60, 384
    s_add_u32 s64, s64, 17825792
    buffer_load_dword v28, v5, s[36:39], s64 offen offset:0 sc1
    buffer_load_dword v29, v5, s[36:39], s64 offen offset:64 sc1
    s_cmp_eq_u32 s73, 0
    s_cselect_b32 s64, s64, 0x7ff00000
    buffer_load_dword v30, v5, s[36:39], s64 offen offset:128 sc1
    buffer_load_dword v31, v5, s[36:39], s64 offen offset:192 sc1
    buffer_load_dword v8, v5, s[36:39], s64 offen offset:256 sc1
    buffer_load_dword v9, v5, s[36:39], s64 offen offset:320 sc1
    ds_read_b64_tr_b16 v[32:33], v24 offset:0
    ds_read_b64_tr_b16 v[34:35], v24 offset:2048
    ds_read_b64_tr_b16 v[36:37], v25 offset:0
    ds_read_b64_tr_b16 v[38:39], v25 offset:2048
    ds_read_b64_tr_b16 v[40:41], v26 offset:0
    ds_read_b64_tr_b16 v[42:43], v26 offset:2048
    ds_read_b64_tr_b16 v[44:45], v27 offset:0
    ds_read_b64_tr_b16 v[46:47], v27 offset:2048
    s_waitcnt vmcnt(18)
    v_swap_b32 v66, v68
    v_swap_b32 v67, v69
    v_swap_b32 v74, v76
    v_swap_b32 v75, v77
    v_swap_b32 v82, v84
    v_swap_b32 v83, v85
    s_waitcnt lgkmcnt(0)
    v_mfma_f32_16x16x32_bf16 v[160:163], v[32:35], v[64:67], v[160:163]
    ds_read_b64_tr_b16 v[48:49], v24 offset:4096
    v_mfma_f32_16x16x32_bf16 v[176:179], v[32:35], v[68:71], v[176:179]
    buffer_load_dwordx4 v[136:139], v4, s[36:39], s66 offen offset:0 sc1
    v_mfma_f32_16x16x32_bf16 v[192:195], v[32:35], v[72:75], v[192:195]
    v_mfma_f32_16x16x32_bf16 v[208:211], v[32:35], v[76:79], v[208:211]
    buffer_load_dwordx4 v[140:143], v4, s[36:39], s66 offen offset:1024 sc1
    s_add_u32 s66, s66, 2048
    ds_read_b64_tr_b16 v[50:51], v24 offset:6144
    v_mfma_f32_16x16x32_bf16 v[224:227], v[32:35], v[80:83], v[224:227]
    v_mfma_f32_16x16x32_bf16 v[240:243], v[32:35], v[84:87], v[240:243]
    buffer_load_dwordx4 v[144:147], v4, s[36:39], s67 offen offset:0 sc1
    v_mfma_f32_16x16x32_bf16 v[164:167], v[36:39], v[64:67], v[164:167]
    ds_read_b64_tr_b16 v[52:53], v25 offset:4096
    v_mfma_f32_16x16x32_bf16 v[180:183], v[36:39], v[68:71], v[180:183]
    buffer_load_dwordx4 v[148:151], v4, s[36:39], s67 offen offset:1024 sc1
    s_add_u32 s67, s67, 2048
    v_mfma_f32_16x16x32_bf16 v[196:199], v[36:39], v[72:75], v[196:199]
    v_mfma_f32_16x16x32_bf16 v[212:215], v[36:39], v[76:79], v[212:215]
    buffer_load_dwordx4 v[152:155], v4, s[36:39], s68 offen offset:0 sc1
    ds_read_b64_tr_b16 v[54:55], v25 offset:6144
    v_mfma_f32_16x16x32_bf16 v[228:231], v[36:39], v[80:83], v[228:231]
    v_mfma_f32_16x16x32_bf16 v[244:247], v[36:39], v[84:87], v[244:247]
    buffer_load_dwordx4 v[156:159], v4, s[36:39], s68 offen offset:1024 sc1
    s_add_u32 s68, s68, 2048
    v_mfma_f32_16x16x32_bf16 v[168:171], v[40:43], v[64:67], v[168:171]
    ds_read_b64_tr_b16 v[56:57], v26 offset:4096
    v_mfma_f32_16x16x32_bf16 v[184:187], v[40:43], v[68:71], v[184:187]
    s_add_u32 m0, s65, 16384
    s_nop 0
    buffer_load_dwordx4 v10, s[20:23], s69 offen lds
    v_mfma_f32_16x16x32_bf16 v[200:203], v[40:43], v[72:75], v[200:203]
    v_mfma_f32_16x16x32_bf16 v[216:219], v[40:43], v[76:79], v[216:219]
    s_add_u32 m0, s65, 17408
    s_nop 0
    buffer_load_dwordx4 v11, s[20:23], s69 offen lds
    ds_read_b64_tr_b16 v[58:59], v26 offset:6144
    v_mfma_f32_16x16x32_bf16 v[232:235], v[40:43], v[80:83], v[232:235]
    v_mfma_f32_16x16x32_bf16 v[248:251], v[40:43], v[84:87], v[248:251]
    s_add_u32 m0, s65, 18432
    s_nop 0
    buffer_load_dwordx4 v12, s[20:23], s69 offen lds
    v_mfma_f32_16x16x32_bf16 v[172:175], v[44:47], v[64:67], v[172:175]
    ds_read_b64_tr_b16 v[60:61], v27 offset:4096
    v_mfma_f32_16x16x32_bf16 v[188:191], v[44:47], v[68:71], v[188:191]
    s_add_u32 m0, s65, 19456
    s_nop 0
    buffer_load_dwordx4 v13, s[20:23], s69 offen lds
    s_add_u32 s69, s69, 40960
    v_mfma_f32_16x16x32_bf16 v[204:207], v[44:47], v[72:75], v[204:207]
    v_mfma_f32_16x16x32_bf16 v[220:223], v[44:47], v[76:79], v[220:223]
    ds_read_b64_tr_b16 v[62:63], v27 offset:6144
    v_mfma_f32_16x16x32_bf16 v[236:239], v[44:47], v[80:83], v[236:239]
    v_mfma_f32_16x16x32_bf16 v[252:255], v[44:47], v[84:87], v[252:255]
    s_waitcnt vmcnt(22)
    v_swap_b32 v90, v92
    v_swap_b32 v91, v93
    v_swap_b32 v98, v100
    v_swap_b32 v99, v101
    v_swap_b32 v106, v108
    v_swap_b32 v107, v109
    s_waitcnt lgkmcnt(0)
    v_mfma_f32_16x16x32_bf16 v[160:163], v[48:51], v[88:91], v[160:163]
    ds_read_b64_tr_b16 v[32:33], v24 offset:8192
    v_mfma_f32_16x16x32_bf16 v[176:179], v[48:51], v[92:95], v[176:179]
    buffer_load_dwordx4 v[64:67], v4, s[36:39], s66 offen offset:0 sc1
    v_mfma_f32_16x16x32_bf16 v[192:195], v[48:51], v[96:99], v[192:195]
    v_mfma_f32_16x16x32_bf16 v[208:211], v[48:51], v[100:103], v[208:211]
    buffer_load_dwordx4 v[68:71], v4, s[36:39], s66 offen offset:1024 sc1
    s_add_u32 s66, s66, 2048
    ds_read_b64_tr_b16 v[34:35], v24 offset:10240
    v_mfma_f32_16x16x32_bf16 v[224:227], v[48:51], v[104:107], v[224:227]
    v_mfma_f32_16x16x32_bf16 v[240:243], v[48:51], v[108:111], v[240:243]
    buffer_load_dwordx4 v[72:75], v4, s[36:39], s67 offen offset:0 sc1
    v_mfma_f32_16x16x32_bf16 v[164:167], v[52:55], v[88:91], v[164:167]
    ds_read_b64_tr_b16 v[36:37], v25 offset:8192
    v_mfma_f32_16x16x32_bf16 v[180:183], v[52:55], v[92:95], v[180:183]
    buffer_load_dwordx4 v[76:79], v4, s[36:39], s67 offen offset:1024 sc1
    s_add_u32 s67, s67, 2048
    v_mfma_f32_16x16x32_bf16 v[196:199], v[52:55], v[96:99], v[196:199]
    v_mfma_f32_16x16x32_bf16 v[212:215], v[52:55], v[100:103], v[212:215]
    buffer_load_dwordx4 v[80:83], v4, s[36:39], s68 offen offset:0 sc1
    ds_read_b64_tr_b16 v[38:39], v25 offset:10240
    v_mfma_f32_16x16x32_bf16 v[228:231], v[52:55], v[104:107], v[228:231]
    v_mfma_f32_16x16x32_bf16 v[244:247], v[52:55], v[108:111], v[244:247]
    buffer_load_dwordx4 v[84:87], v4, s[36:39], s68 offen offset:1024 sc1
    s_add_u32 s68, s68, 2048
    v_mfma_f32_16x16x32_bf16 v[168:171], v[56:59], v[88:91], v[168:171]
    ds_read_b64_tr_b16 v[40:41], v26 offset:8192
    v_mfma_f32_16x16x32_bf16 v[184:187], v[56:59], v[92:95], v[184:187]
    s_add_u32 m0, s65, 0
    s_nop 0
    buffer_load_dwordx4 v10, s[20:23], s69 offen lds
    v_mfma_f32_16x16x32_bf16 v[200:203], v[56:59], v[96:99], v[200:203]
    v_mfma_f32_16x16x32_bf16 v[216:219], v[56:59], v[100:103], v[216:219]
    s_add_u32 m0, s65, 1024
    s_nop 0
    buffer_load_dwordx4 v11, s[20:23], s69 offen lds
    ds_read_b64_tr_b16 v[42:43], v26 offset:10240
    v_mfma_f32_16x16x32_bf16 v[232:235], v[56:59], v[104:107], v[232:235]
    v_mfma_f32_16x16x32_bf16 v[248:251], v[56:59], v[108:111], v[248:251]
    s_add_u32 m0, s65, 2048
    s_nop 0
    buffer_load_dwordx4 v12, s[20:23], s69 offen lds
    v_mfma_f32_16x16x32_bf16 v[172:175], v[60:63], v[88:91], v[172:175]
    ds_read_b64_tr_b16 v[44:45], v27 offset:8192
    v_mfma_f32_16x16x32_bf16 v[188:191], v[60:63], v[92:95], v[188:191]
    s_add_u32 m0, s65, 3072
    s_nop 0
    buffer_load_dwordx4 v13, s[20:23], s69 offen lds
    s_add_u32 s69, s69, 40960
    v_mfma_f32_16x16x32_bf16 v[204:207], v[60:63], v[96:99], v[204:207]
    v_mfma_f32_16x16x32_bf16 v[220:223], v[60:63], v[100:103], v[220:223]
    ds_read_b64_tr_b16 v[46:47], v27 offset:10240
    v_mfma_f32_16x16x32_bf16 v[236:239], v[60:63], v[104:107], v[236:239]
    v_mfma_f32_16x16x32_bf16 v[252:255], v[60:63], v[108:111], v[252:255]
    s_waitcnt vmcnt(26)
    v_swap_b32 v114, v116
    v_swap_b32 v115, v117
    v_swap_b32 v122, v124
    v_swap_b32 v123, v125
    v_swap_b32 v130, v132
    v_swap_b32 v131, v133
    s_waitcnt lgkmcnt(0)
    v_mfma_f32_16x16x32_bf16 v[160:163], v[32:35], v[112:115], v[160:163]
    ds_read_b64_tr_b16 v[48:49], v24 offset:12288
    v_mfma_f32_16x16x32_bf16 v[176:179], v[32:35], v[116:119], v[176:179]
    buffer_load_dwordx4 v[88:91], v4, s[36:39], s66 offen offset:0 sc1
    v_mfma_f32_16x16x32_bf16 v[192:195], v[32:35], v[120:123], v[192:195]
    v_mfma_f32_16x16x32_bf16 v[208:211], v[32:35], v[124:127], v[208:211]
    buffer_load_dwordx4 v[92:95], v4, s[36:39], s66 offen offset:1024 sc1
    s_add_u32 s66, s66, 2048
    ds_read_b64_tr_b16 v[50:51], v24 offset:14336
    v_mfma_f32_16x16x32_bf16 v[224:227], v[32:35], v[128:131], v[224:227]
    v_mfma_f32_16x16x32_bf16 v[240:243], v[32:35], v[132:135], v[240:243]
    buffer_load_dwordx4 v[96:99], v4, s[36:39], s67 offen offset:0 sc1
    v_mfma_f32_16x16x32_bf16 v[164:167], v[36:39], v[112:115], v[164:167]
    ds_read_b64_tr_b16 v[52:53], v25 offset:12288
    v_mfma_f32_16x16x32_bf16 v[180:183], v[36:39], v[116:119], v[180:183]
    buffer_load_dwordx4 v[100:103], v4, s[36:39], s67 offen offset:1024 sc1
    s_add_u32 s67, s67, 2048
    v_mfma_f32_16x16x32_bf16 v[196:199], v[36:39], v[120:123], v[196:199]
    v_mfma_f32_16x16x32_bf16 v[212:215], v[36:39], v[124:127], v[212:215]
    buffer_load_dwordx4 v[104:107], v4, s[36:39], s68 offen offset:0 sc1
    ds_read_b64_tr_b16 v[54:55], v25 offset:14336
    v_mfma_f32_16x16x32_bf16 v[228:231], v[36:39], v[128:131], v[228:231]
    v_mfma_f32_16x16x32_bf16 v[244:247], v[36:39], v[132:135], v[244:247]
    buffer_load_dwordx4 v[108:111], v4, s[36:39], s68 offen offset:1024 sc1
    s_add_u32 s68, s68, 2048
    v_mfma_f32_16x16x32_bf16 v[168:171], v[40:43], v[112:115], v[168:171]
    ds_read_b64_tr_b16 v[56:57], v26 offset:12288
    v_mfma_f32_16x16x32_bf16 v[184:187], v[40:43], v[116:119], v[184:187]
    s_add_u32 m0, s65, 4096
    s_nop 0
    buffer_load_dwordx4 v10, s[20:23], s69 offen lds
    v_mfma_f32_16x16x32_bf16 v[200:203], v[40:43], v[120:123], v[200:203]
    v_mfma_f32_16x16x32_bf16 v[216:219], v[40:43], v[124:127], v[216:219]
    s_add_u32 m0, s65, 5120
    s_nop 0
    buffer_load_dwordx4 v11, s[20:23], s69 offen lds
    ds_read_b64_tr_b16 v[58:59], v26 offset:14336
    v_mfma_f32_16x16x32_bf16 v[232:235], v[40:43], v[128:131], v[232:235]
    v_mfma_f32_16x16x32_bf16 v[248:251], v[40:43], v[132:135], v[248:251]
    s_add_u32 m0, s65, 6144
    s_nop 0
    buffer_load_dwordx4 v12, s[20:23], s69 offen lds
    v_mfma_f32_16x16x32_bf16 v[172:175], v[44:47], v[112:115], v[172:175]
    ds_read_b64_tr_b16 v[60:61], v27 offset:12288
    v_mfma_f32_16x16x32_bf16 v[188:191], v[44:47], v[116:119], v[188:191]
    s_add_u32 m0, s65, 7168
    s_nop 0
    buffer_load_dwordx4 v13, s[20:23], s69 offen lds
    s_add_u32 s69, s69, 40960
    v_mfma_f32_16x16x32_bf16 v[204:207], v[44:47], v[120:123], v[204:207]
    v_mfma_f32_16x16x32_bf16 v[220:223], v[44:47], v[124:127], v[220:223]
    ds_read_b64_tr_b16 v[62:63], v27 offset:14336
    v_mfma_f32_16x16x32_bf16 v[236:239], v[44:47], v[128:131], v[236:239]
    v_mfma_f32_16x16x32_bf16 v[252:255], v[44:47], v[132:135], v[252:255]
    s_waitcnt vmcnt(20)
    v_swap_b32 v138, v140
    v_swap_b32 v139, v141
    v_swap_b32 v146, v148
    v_swap_b32 v147, v149
    v_swap_b32 v154, v156
    v_swap_b32 v155, v157
    s_waitcnt lgkmcnt(0)
    v_mfma_f32_16x16x32_bf16 v[160:163], v[48:51], v[136:139], v[160:163]
    ds_read_b64_tr_b16 v[32:33], v24 offset:16384
    v_mfma_f32_16x16x32_bf16 v[176:179], v[48:51], v[140:143], v[176:179]
    buffer_load_dwordx4 v[112:115], v4, s[36:39], s66 offen offset:0 sc1
    v_mfma_f32_16x16x32_bf16 v[192:195], v[48:51], v[144:147], v[192:195]
    v_mfma_f32_16x16x32_bf16 v[208:211], v[48:51], v[148:151], v[208:211]
    buffer_load_dwordx4 v[116:119], v4, s[36:39], s66 offen offset:1024 sc1
    s_add_u32 s66, s66, 2048
    ds_read_b64_tr_b16 v[34:35], v24 offset:18432
    v_mfma_f32_16x16x32_bf16 v[224:227], v[48:51], v[152:155], v[224:227]
    v_mfma_f32_16x16x32_bf16 v[240:243], v[48:51], v[156:159], v[240:243]
    buffer_load_dwordx4 v[120:123], v4, s[36:39], s67 offen offset:0 sc1
    v_mfma_f32_16x16x32_bf16 v[164:167], v[52:55], v[136:139], v[164:167]
    ds_read_b64_tr_b16 v[36:37], v25 offset:16384
    v_mfma_f32_16x16x32_bf16 v[180:183], v[52:55], v[140:143], v[180:183]
    buffer_load_dwordx4 v[124:127], v4, s[36:39], s67 offen offset:1024 sc1
    s_add_u32 s67, s67, 2048
    v_mfma_f32_16x16x32_bf16 v[196:199], v[52:55], v[144:147], v[196:199]
    v_mfma_f32_16x16x32_bf16 v[212:215], v[52:55], v[148:151], v[212:215]
    buffer_load_dwordx4 v[128:131], v4, s[36:39], s68 offen offset:0 sc1
    ds_read_b64_tr_b16 v[38:39], v25 offset:18432
    v_mfma_f32_16x16x32_bf16 v[228:231], v[52:55], v[152:155], v[228:231]
    v_mfma_f32_16x16x32_bf16 v[244:247], v[52:55], v[156:159], v[244:247]
    buffer_load_dwordx4 v[132:135], v4, s[36:39], s68 offen offset:1024 sc1
    s_add_u32 s68, s68, 2048
    v_mfma_f32_16x16x32_bf16 v[168:171], v[56:59], v[136:139], v[168:171]
    ds_read_b64_tr_b16 v[40:41], v26 offset:16384
    v_mfma_f32_16x16x32_bf16 v[184:187], v[56:59], v[140:143], v[184:187]
    s_add_u32 m0, s65, 8192
    s_nop 0
    buffer_load_dwordx4 v10, s[20:23], s69 offen lds
    v_mfma_f32_16x16x32_bf16 v[200:203], v[56:59], v[144:147], v[200:203]
    v_mfma_f32_16x16x32_bf16 v[216:219], v[56:59], v[148:151], v[216:219]
    s_add_u32 m0, s65, 9216
    s_nop 0
    buffer_load_dwordx4 v11, s[20:23], s69 offen lds
    ds_read_b64_tr_b16 v[42:43], v26 offset:18432
    v_mfma_f32_16x16x32_bf16 v[232:235], v[56:59], v[152:155], v[232:235]
    v_mfma_f32_16x16x32_bf16 v[248:251], v[56:59], v[156:159], v[248:251]
    s_add_u32 m0, s65, 10240
    s_nop 0
    buffer_load_dwordx4 v12, s[20:23], s69 offen lds
    v_mfma_f32_16x16x32_bf16 v[172:175], v[60:63], v[136:139], v[172:175]
    ds_read_b64_tr_b16 v[44:45], v27 offset:16384
    v_mfma_f32_16x16x32_bf16 v[188:191], v[60:63], v[140:143], v[188:191]
    s_add_u32 m0, s65, 11264
    s_nop 0
    buffer_load_dwordx4 v13, s[20:23], s69 offen lds
    s_add_u32 s69, s69, 40960
    v_mfma_f32_16x16x32_bf16 v[204:207], v[60:63], v[144:147], v[204:207]
    v_mfma_f32_16x16x32_bf16 v[220:223], v[60:63], v[148:151], v[220:223]
    ds_read_b64_tr_b16 v[46:47], v27 offset:18432
    v_mfma_f32_16x16x32_bf16 v[236:239], v[60:63], v[152:155], v[236:239]
    v_mfma_f32_16x16x32_bf16 v[252:255], v[60:63], v[156:159], v[252:255]
    s_waitcnt vmcnt(20)
    v_swap_b32 v66, v68
    v_swap_b32 v67, v69
    v_swap_b32 v74, v76
    v_swap_b32 v75, v77
    v_swap_b32 v82, v84
    v_swap_b32 v83, v85
    s_waitcnt lgkmcnt(0)
    v_mfma_f32_16x16x32_bf16 v[160:163], v[32:35], v[64:67], v[160:163]
    ds_read_b64_tr_b16 v[48:49], v24 offset:0
    v_mfma_f32_16x16x32_bf16 v[176:179], v[32:35], v[68:71], v[176:179]
    buffer_load_dwordx4 v[136:139], v4, s[36:39], s66 offen offset:0 sc1
    v_mfma_f32_16x16x32_bf16 v[192:195], v[32:35], v[72:75], v[192:195]
    v_mfma_f32_16x16x32_bf16 v[208:211], v[32:35], v[76:79], v[208:211]
    buffer_load_dwordx4 v[140:143], v4, s[36:39], s66 offen offset:1024 sc1
    s_add_u32 s66, s66, 2048
    ds_read_b64_tr_b16 v[50:51], v24 offset:2048
    v_mfma_f32_16x16x32_bf16 v[224:227], v[32:35], v[80:83], v[224:227]
    v_mfma_f32_16x16x32_bf16 v[240:243], v[32:35], v[84:87], v[240:243]
    buffer_load_dwordx4 v[144:147], v4, s[36:39], s67 offen offset:0 sc1
    v_mfma_f32_16x16x32_bf16 v[164:167], v[36:39], v[64:67], v[164:167]
    ds_read_b64_tr_b16 v[52:53], v25 offset:0
    v_mfma_f32_16x16x32_bf16 v[180:183], v[36:39], v[68:71], v[180:183]
    buffer_load_dwordx4 v[148:151], v4, s[36:39], s67 offen offset:1024 sc1
    s_add_u32 s67, s67, 2048
    v_mfma_f32_16x16x32_bf16 v[196:199], v[36:39], v[72:75], v[196:199]
    v_mfma_f32_16x16x32_bf16 v[212:215], v[36:39], v[76:79], v[212:215]
    buffer_load_dwordx4 v[152:155], v4, s[36:39], s68 offen offset:0 sc1
    ds_read_b64_tr_b16 v[54:55], v25 offset:2048
    v_mfma_f32_16x16x32_bf16 v[228:231], v[36:39], v[80:83], v[228:231]
    v_mfma_f32_16x16x32_bf16 v[244:247], v[36:39], v[84:87], v[244:247]
    buffer_load_dwordx4 v[156:159], v4, s[36:39], s68 offen offset:1024 sc1
    s_add_u32 s68, s68, 2048
    v_mfma_f32_16x16x32_bf16 v[168:171], v[40:43], v[64:67], v[168:171]
    ds_read_b64_tr_b16 v[56:57], v26 offset:0
    v_mfma_f32_16x16x32_bf16 v[184:187], v[40:43], v[68:71], v[184:187]
    s_add_u32 m0, s65, 12288
    s_nop 0
    buffer_load_dwordx4 v10, s[20:23], s69 offen lds
    v_mfma_f32_16x16x32_bf16 v[200:203], v[40:43], v[72:75], v[200:203]
    v_mfma_f32_16x16x32_bf16 v[216:219], v[40:43], v[76:79], v[216:219]
    s_add_u32 m0, s65, 13312
    s_nop 0
    buffer_load_dwordx4 v11, s[20:23], s69 offen lds
    ds_read_b64_tr_b16 v[58:59], v26 offset:2048
    v_mfma_f32_16x16x32_bf16 v[232:235], v[40:43], v[80:83], v[232:235]
    v_mfma_f32_16x16x32_bf16 v[248:251], v[40:43], v[84:87], v[248:251]
    s_add_u32 m0, s65, 14336
    s_nop 0
    buffer_load_dwordx4 v12, s[20:23], s69 offen lds
    v_mfma_f32_16x16x32_bf16 v[172:175], v[44:47], v[64:67], v[172:175]
    ds_read_b64_tr_b16 v[60:61], v27 offset:0
    v_mfma_f32_16x16x32_bf16 v[188:191], v[44:47], v[68:71], v[188:191]
    s_add_u32 m0, s65, 15360
    s_nop 0
    buffer_load_dwordx4 v13, s[20:23], s69 offen lds
    s_add_u32 s69, s69, 40960
    v_mfma_f32_16x16x32_bf16 v[204:207], v[44:47], v[72:75], v[204:207]
    v_mfma_f32_16x16x32_bf16 v[220:223], v[44:47], v[76:79], v[220:223]
    ds_read_b64_tr_b16 v[62:63], v27 offset:2048
    v_mfma_f32_16x16x32_bf16 v[236:239], v[44:47], v[80:83], v[236:239]
    v_mfma_f32_16x16x32_bf16 v[252:255], v[44:47], v[84:87], v[252:255]
    s_waitcnt vmcnt(20)
    v_swap_b32 v90, v92
    v_swap_b32 v91, v93
    v_swap_b32 v98, v100
    v_swap_b32 v99, v101
    v_swap_b32 v106, v108
    v_swap_b32 v107, v109
    s_waitcnt lgkmcnt(0)
    v_mfma_f32_16x16x32_bf16 v[160:163], v[48:51], v[88:91], v[160:163]
    ds_read_b64_tr_b16 v[32:33], v24 offset:4096
    v_mfma_f32_16x16x32_bf16 v[176:179], v[48:51], v[92:95], v[176:179]
    buffer_load_dwordx4 v[64:67], v4, s[36:39], s66 offen offset:0 sc1
    v_mfma_f32_16x16x32_bf16 v[192:195], v[48:51], v[96:99], v[192:195]
    v_mfma_f32_16x16x32_bf16 v[208:211], v[48:51], v[100:103], v[208:211]
    buffer_load_dwordx4 v[68:71], v4, s[36:39], s66 offen offset:1024 sc1
    s_add_u32 s66, s66, 2048
    ds_read_b64_tr_b16 v[34:35], v24 offset:6144
    v_mfma_f32_16x16x32_bf16 v[224:227], v[48:51], v[104:107], v[224:227]
    v_mfma_f32_16x16x32_bf16 v[240:243], v[48:51], v[108:111], v[240:243]
    buffer_load_dwordx4 v[72:75], v4, s[36:39], s67 offen offset:0 sc1
    v_mfma_f32_16x16x32_bf16 v[164:167], v[52:55], v[88:91], v[164:167]
    ds_read_b64_tr_b16 v[36:37], v25 offset:4096
    v_mfma_f32_16x16x32_bf16 v[180:183], v[52:55], v[92:95], v[180:183]
    buffer_load_dwordx4 v[76:79], v4, s[36:39], s67 offen offset:1024 sc1
    s_add_u32 s67, s67, 2048
    v_mfma_f32_16x16x32_bf16 v[196:199], v[52:55], v[96:99], v[196:199]
    v_mfma_f32_16x16x32_bf16 v[212:215], v[52:55], v[100:103], v[212:215]
    buffer_load_dwordx4 v[80:83], v4, s[36:39], s68 offen offset:0 sc1
    ds_read_b64_tr_b16 v[38:39], v25 offset:6144
    v_mfma_f32_16x16x32_bf16 v[228:231], v[52:55], v[104:107], v[228:231]
    v_mfma_f32_16x16x32_bf16 v[244:247], v[52:55], v[108:111], v[244:247]
    buffer_load_dwordx4 v[84:87], v4, s[36:39], s68 offen offset:1024 sc1
    s_add_u32 s68, s68, 2048
    v_mfma_f32_16x16x32_bf16 v[168:171], v[56:59], v[88:91], v[168:171]
    ds_read_b64_tr_b16 v[40:41], v26 offset:4096
    v_mfma_f32_16x16x32_bf16 v[184:187], v[56:59], v[92:95], v[184:187]
    s_add_u32 m0, s65, 16384
    s_nop 0
    buffer_load_dwordx4 v10, s[20:23], s69 offen lds
    v_mfma_f32_16x16x32_bf16 v[200:203], v[56:59], v[96:99], v[200:203]
    v_mfma_f32_16x16x32_bf16 v[216:219], v[56:59], v[100:103], v[216:219]
    s_add_u32 m0, s65, 17408
    s_nop 0
    buffer_load_dwordx4 v11, s[20:23], s69 offen lds
    ds_read_b64_tr_b16 v[42:43], v26 offset:6144
    v_mfma_f32_16x16x32_bf16 v[232:235], v[56:59], v[104:107], v[232:235]
    v_mfma_f32_16x16x32_bf16 v[248:251], v[56:59], v[108:111], v[248:251]
    s_add_u32 m0, s65, 18432
    s_nop 0
    buffer_load_dwordx4 v12, s[20:23], s69 offen lds
    v_mfma_f32_16x16x32_bf16 v[172:175], v[60:63], v[88:91], v[172:175]
    ds_read_b64_tr_b16 v[44:45], v27 offset:4096
    v_mfma_f32_16x16x32_bf16 v[188:191], v[60:63], v[92:95], v[188:191]
    s_add_u32 m0, s65, 19456
    s_nop 0
    buffer_load_dwordx4 v13, s[20:23], s69 offen lds
    s_add_u32 s69, s69, 40960
    v_mfma_f32_16x16x32_bf16 v[204:207], v[60:63], v[96:99], v[204:207]
    v_mfma_f32_16x16x32_bf16 v[220:223], v[60:63], v[100:103], v[220:223]
    ds_read_b64_tr_b16 v[46:47], v27 offset:6144
    v_mfma_f32_16x16x32_bf16 v[236:239], v[60:63], v[104:107], v[236:239]
    v_mfma_f32_16x16x32_bf16 v[252:255], v[60:63], v[108:111], v[252:255]
    s_waitcnt vmcnt(20)
    v_swap_b32 v114, v116
    v_swap_b32 v115, v117
    v_swap_b32 v122, v124
    v_swap_b32 v123, v125
    v_swap_b32 v130, v132
    v_swap_b32 v131, v133
    s_waitcnt lgkmcnt(0)
    v_mfma_f32_16x16x32_bf16 v[160:163], v[32:35], v[112:115], v[160:163]
    ds_read_b64_tr_b16 v[48:49], v24 offset:8192
    v_mfma_f32_16x16x32_bf16 v[176:179], v[32:35], v[116:119], v[176:179]
    buffer_load_dwordx4 v[88:91], v4, s[36:39], s66 offen offset:0 sc1
    v_mfma_f32_16x16x32_bf16 v[192:195], v[32:35], v[120:123], v[192:195]
    v_mfma_f32_16x16x32_bf16 v[208:211], v[32:35], v[124:127], v[208:211]
    buffer_load_dwordx4 v[92:95], v4, s[36:39], s66 offen offset:1024 sc1
    s_add_u32 s66, s66, 2048
    ds_read_b64_tr_b16 v[50:51], v24 offset:10240
    v_mfma_f32_16x16x32_bf16 v[224:227], v[32:35], v[128:131], v[224:227]
    v_mfma_f32_16x16x32_bf16 v[240:243], v[32:35], v[132:135], v[240:243]
    buffer_load_dwordx4 v[96:99], v4, s[36:39], s67 offen offset:0 sc1
    v_mfma_f32_16x16x32_bf16 v[164:167], v[36:39], v[112:115], v[164:167]
    ds_read_b64_tr_b16 v[52:53], v25 offset:8192
    v_mfma_f32_16x16x32_bf16 v[180:183], v[36:39], v[116:119], v[180:183]
    buffer_load_dwordx4 v[100:103], v4, s[36:39], s67 offen offset:1024 sc1
    s_add_u32 s67, s67, 2048
    v_mfma_f32_16x16x32_bf16 v[196:199], v[36:39], v[120:123], v[196:199]
    v_mfma_f32_16x16x32_bf16 v[212:215], v[36:39], v[124:127], v[212:215]
    buffer_load_dwordx4 v[104:107], v4, s[36:39], s68 offen offset:0 sc1
    ds_read_b64_tr_b16 v[54:55], v25 offset:10240
    v_mfma_f32_16x16x32_bf16 v[228:231], v[36:39], v[128:131], v[228:231]
    v_mfma_f32_16x16x32_bf16 v[244:247], v[36:39], v[132:135], v[244:247]
    buffer_load_dwordx4 v[108:111], v4, s[36:39], s68 offen offset:1024 sc1
    s_add_u32 s68, s68, 2048
    v_mfma_f32_16x16x32_bf16 v[168:171], v[40:43], v[112:115], v[168:171]
    ds_read_b64_tr_b16 v[56:57], v26 offset:8192
    v_mfma_f32_16x16x32_bf16 v[184:187], v[40:43], v[116:119], v[184:187]
    s_add_u32 m0, s65, 0
    s_nop 0
    buffer_load_dwordx4 v10, s[20:23], s69 offen lds
    v_mfma_f32_16x16x32_bf16 v[200:203], v[40:43], v[120:123], v[200:203]
    v_mfma_f32_16x16x32_bf16 v[216:219], v[40:43], v[124:127], v[216:219]
    s_add_u32 m0, s65, 1024
    s_nop 0
    buffer_load_dwordx4 v11, s[20:23], s69 offen lds
    ds_read_b64_tr_b16 v[58:59], v26 offset:10240
    v_mfma_f32_16x16x32_bf16 v[232:235], v[40:43], v[128:131], v[232:235]
    v_mfma_f32_16x16x32_bf16 v[248:251], v[40:43], v[132:135], v[248:251]
    s_add_u32 m0, s65, 2048
    s_nop 0
    buffer_load_dwordx4 v12, s[20:23], s69 offen lds
    v_mfma_f32_16x16x32_bf16 v[172:175], v[44:47], v[112:115], v[172:175]
    ds_read_b64_tr_b16 v[60:61], v27 offset:8192
    v_mfma_f32_16x16x32_bf16 v[188:191], v[44:47], v[116:119], v[188:191]
    s_add_u32 m0, s65, 3072
    s_nop 0
    buffer_load_dwordx4 v13, s[20:23], s69 offen lds
    s_add_u32 s69, s69, 40960
    v_mfma_f32_16x16x32_bf16 v[204:207], v[44:47], v[120:123], v[204:207]
    v_mfma_f32_16x16x32_bf16 v[220:223], v[44:47], v[124:127], v[220:223]
    ds_read_b64_tr_b16 v[62:63], v27 offset:10240
    v_mfma_f32_16x16x32_bf16 v[236:239], v[44:47], v[128:131], v[236:239]
    v_mfma_f32_16x16x32_bf16 v[252:255], v[44:47], v[132:135], v[252:255]
    s_waitcnt vmcnt(20)
    v_swap_b32 v138, v140
    v_swap_b32 v139, v141
    v_swap_b32 v146, v148
    v_swap_b32 v147, v149
    v_swap_b32 v154, v156
    v_swap_b32 v155, v157
    s_waitcnt lgkmcnt(0)
    v_mfma_f32_16x16x32_bf16 v[160:163], v[48:51], v[136:139], v[160:163]
    ds_read_b64_tr_b16 v[32:33], v24 offset:12288
    v_mfma_f32_16x16x32_bf16 v[176:179], v[48:51], v[140:143], v[176:179]
    buffer_load_dwordx4 v[112:115], v4, s[36:39], s66 offen offset:0 sc1
    v_mfma_f32_16x16x32_bf16 v[192:195], v[48:51], v[144:147], v[192:195]
    v_mfma_f32_16x16x32_bf16 v[208:211], v[48:51], v[148:151], v[208:211]
    buffer_load_dwordx4 v[116:119], v4, s[36:39], s66 offen offset:1024 sc1
    s_add_u32 s66, s66, 2048
    ds_read_b64_tr_b16 v[34:35], v24 offset:14336
    v_mfma_f32_16x16x32_bf16 v[224:227], v[48:51], v[152:155], v[224:227]
    v_mfma_f32_16x16x32_bf16 v[240:243], v[48:51], v[156:159], v[240:243]
    buffer_load_dwordx4 v[120:123], v4, s[36:39], s67 offen offset:0 sc1
    v_mfma_f32_16x16x32_bf16 v[164:167], v[52:55], v[136:139], v[164:167]
    ds_read_b64_tr_b16 v[36:37], v25 offset:12288
    v_mfma_f32_16x16x32_bf16 v[180:183], v[52:55], v[140:143], v[180:183]
    buffer_load_dwordx4 v[124:127], v4, s[36:39], s67 offen offset:1024 sc1
    s_add_u32 s67, s67, 2048
    v_mfma_f32_16x16x32_bf16 v[196:199], v[52:55], v[144:147], v[196:199]
    v_mfma_f32_16x16x32_bf16 v[212:215], v[52:55], v[148:151], v[212:215]
    buffer_load_dwordx4 v[128:131], v4, s[36:39], s68 offen offset:0 sc1
    ds_read_b64_tr_b16 v[38:39], v25 offset:14336
    v_mfma_f32_16x16x32_bf16 v[228:231], v[52:55], v[152:155], v[228:231]
    v_mfma_f32_16x16x32_bf16 v[244:247], v[52:55], v[156:159], v[244:247]
    buffer_load_dwordx4 v[132:135], v4, s[36:39], s68 offen offset:1024 sc1
    s_add_u32 s68, s68, 2048
    v_mfma_f32_16x16x32_bf16 v[168:171], v[56:59], v[136:139], v[168:171]
    ds_read_b64_tr_b16 v[40:41], v26 offset:12288
    v_mfma_f32_16x16x32_bf16 v[184:187], v[56:59], v[140:143], v[184:187]
    s_add_u32 m0, s65, 4096
    s_nop 0
    buffer_load_dwordx4 v10, s[20:23], s69 offen lds
    v_mfma_f32_16x16x32_bf16 v[200:203], v[56:59], v[144:147], v[200:203]
    v_mfma_f32_16x16x32_bf16 v[216:219], v[56:59], v[148:151], v[216:219]
    s_add_u32 m0, s65, 5120
    s_nop 0
    buffer_load_dwordx4 v11, s[20:23], s69 offen lds
    ds_read_b64_tr_b16 v[42:43], v26 offset:14336
    v_mfma_f32_16x16x32_bf16 v[232:235], v[56:59], v[152:155], v[232:235]
    v_mfma_f32_16x16x32_bf16 v[248:251], v[56:59], v[156:159], v[248:251]
    s_add_u32 m0, s65, 6144
    s_nop 0
    buffer_load_dwordx4 v12, s[20:23], s69 offen lds
    v_mfma_f32_16x16x32_bf16 v[172:175], v[60:63], v[136:139], v[172:175]
    ds_read_b64_tr_b16 v[44:45], v27 offset:12288
    v_mfma_f32_16x16x32_bf16 v[188:191], v[60:63], v[140:143], v[188:191]
    s_add_u32 m0, s65, 7168
    s_nop 0
    buffer_load_dwordx4 v13, s[20:23], s69 offen lds
    s_add_u32 s69, s69, 40960
    v_mfma_f32_16x16x32_bf16 v[204:207], v[60:63], v[144:147], v[204:207]
    v_mfma_f32_16x16x32_bf16 v[220:223], v[60:63], v[148:151], v[220:223]
    ds_read_b64_tr_b16 v[46:47], v27 offset:14336
    v_mfma_f32_16x16x32_bf16 v[236:239], v[60:63], v[152:155], v[236:239]
    v_mfma_f32_16x16x32_bf16 v[252:255], v[60:63], v[156:159], v[252:255]
    s_waitcnt vmcnt(20)
    v_swap_b32 v66, v68
    v_swap_b32 v67, v69
    v_swap_b32 v74, v76
    v_swap_b32 v75, v77
    v_swap_b32 v82, v84
    v_swap_b32 v83, v85
    s_waitcnt lgkmcnt(0)
    v_mfma_f32_16x16x32_bf16 v[160:163], v[32:35], v[64:67], v[160:163]
    ds_read_b64_tr_b16 v[48:49], v24 offset:16384
    v_mfma_f32_16x16x32_bf16 v[176:179], v[32:35], v[68:71], v[176:179]
    buffer_load_dwordx4 v[136:139], v4, s[36:39], s66 offen offset:0 sc1
    v_mfma_f32_16x16x32_bf16 v[192:195], v[32:35], v[72:75], v[192:195]
    v_mfma_f32_16x16x32_bf16 v[208:211], v[32:35], v[76:79], v[208:211]
    buffer_load_dwordx4 v[140:143], v4, s[36:39], s66 offen offset:1024 sc1
    s_add_u32 s66, s66, 2048
    ds_read_b64_tr_b16 v[50:51], v24 offset:18432
    v_mfma_f32_16x16x32_bf16 v[224:227], v[32:35], v[80:83], v[224:227]
    v_mfma_f32_16x16x32_bf16 v[240:243], v[32:35], v[84:87], v[240:243]
    buffer_load_dwordx4 v[144:147], v4, s[36:39], s67 offen offset:0 sc1
    v_mfma_f32_16x16x32_bf16 v[164:167], v[36:39], v[64:67], v[164:167]
    ds_read_b64_tr_b16 v[52:53], v25 offset:16384
    v_mfma_f32_16x16x32_bf16 v[180:183], v[36:39], v[68:71], v[180:183]
    buffer_load_dwordx4 v[148:151], v4, s[36:39], s67 offen offset:1024 sc1
    s_add_u32 s67, s67, 2048
    v_mfma_f32_16x16x32_bf16 v[196:199], v[36:39], v[72:75], v[196:199]
    v_mfma_f32_16x16x32_bf16 v[212:215], v[36:39], v[76:79], v[212:215]
    buffer_load_dwordx4 v[152:155], v4, s[36:39], s68 offen offset:0 sc1
    ds_read_b64_tr_b16 v[54:55], v25 offset:18432
    v_mfma_f32_16x16x32_bf16 v[228:231], v[36:39], v[80:83], v[228:231]
    v_mfma_f32_16x16x32_bf16 v[244:247], v[36:39], v[84:87], v[244:247]
    buffer_load_dwordx4 v[156:159], v4, s[36:39], s68 offen offset:1024 sc1
    s_add_u32 s68, s68, 2048
    v_mfma_f32_16x16x32_bf16 v[168:171], v[40:43], v[64:67], v[168:171]
    ds_read_b64_tr_b16 v[56:57], v26 offset:16384
    v_mfma_f32_16x16x32_bf16 v[184:187], v[40:43], v[68:71], v[184:187]
    s_add_u32 m0, s65, 8192
    s_nop 0
    buffer_load_dwordx4 v14, s[24:27], s70 offen lds
    v_mfma_f32_16x16x32_bf16 v[200:203], v[40:43], v[72:75], v[200:203]
    v_mfma_f32_16x16x32_bf16 v[216:219], v[40:43], v[76:79], v[216:219]
    s_add_u32 m0, s65, 9216
    s_nop 0
    buffer_load_dwordx4 v15, s[24:27], s70 offen lds
    ds_read_b64_tr_b16 v[58:59], v26 offset:18432
    v_mfma_f32_16x16x32_bf16 v[232:235], v[40:43], v[80:83], v[232:235]
    v_mfma_f32_16x16x32_bf16 v[248:251], v[40:43], v[84:87], v[248:251]
    s_add_u32 m0, s65, 10240
    s_nop 0
    buffer_load_dwordx4 v16, s[24:27], s70 offen lds
    v_mfma_f32_16x16x32_bf16 v[172:175], v[44:47], v[64:67], v[172:175]
    ds_read_b64_tr_b16 v[60:61], v27 offset:16384
    v_mfma_f32_16x16x32_bf16 v[188:191], v[44:47], v[68:71], v[188:191]
    s_add_u32 m0, s65, 11264
    s_nop 0
    buffer_load_dwordx4 v17, s[24:27], s70 offen lds
    s_add_u32 s70, s70, 40960
    v_mfma_f32_16x16x32_bf16 v[204:207], v[44:47], v[72:75], v[204:207]
    v_mfma_f32_16x16x32_bf16 v[220:223], v[44:47], v[76:79], v[220:223]
    ds_read_b64_tr_b16 v[62:63], v27 offset:18432
    v_mfma_f32_16x16x32_bf16 v[236:239], v[44:47], v[80:83], v[236:239]
    v_mfma_f32_16x16x32_bf16 v[252:255], v[44:47], v[84:87], v[252:255]
    s_waitcnt vmcnt(20)
    v_swap_b32 v90, v92
    v_swap_b32 v91, v93
    v_swap_b32 v98, v100
    v_swap_b32 v99, v101
    v_swap_b32 v106, v108
    v_swap_b32 v107, v109
    s_waitcnt lgkmcnt(0)
    v_mfma_f32_16x16x32_bf16 v[160:163], v[48:51], v[88:91], v[160:163]
    ds_read_b64_tr_b16 v[32:33], v24 offset:0
    v_mfma_f32_16x16x32_bf16 v[176:179], v[48:51], v[92:95], v[176:179]
    s_add_u32 m0, s65, 12288
    s_nop 0
    buffer_load_dwordx4 v14, s[24:27], s70 offen lds
    v_mfma_f32_16x16x32_bf16 v[192:195], v[48:51], v[96:99], v[192:195]
    v_mfma_f32_16x16x32_bf16 v[208:211], v[48:51], v[100:103], v[208:211]
    s_add_u32 m0, s65, 13312
    s_nop 0
    buffer_load_dwordx4 v15, s[24:27], s70 offen lds
    ds_read_b64_tr_b16 v[34:35], v24 offset:2048
    v_mfma_f32_16x16x32_bf16 v[224:227], v[48:51], v[104:107], v[224:227]
    v_mfma_f32_16x16x32_bf16 v[240:243], v[48:51], v[108:111], v[240:243]
    s_add_u32 m0, s65, 14336
    s_nop 0
    buffer_load_dwordx4 v16, s[24:27], s70 offen lds
    v_mfma_f32_16x16x32_bf16 v[164:167], v[52:55], v[88:91], v[164:167]
    ds_read_b64_tr_b16 v[36:37], v25 offset:0
    v_mfma_f32_16x16x32_bf16 v[180:183], v[52:55], v[92:95], v[180:183]
    s_add_u32 m0, s65, 15360
    s_nop 0
    buffer_load_dwordx4 v17, s[24:27], s70 offen lds
    s_add_u32 s70, s70, 40960
    v_mfma_f32_16x16x32_bf16 v[196:199], v[52:55], v[96:99], v[196:199]
    v_mfma_f32_16x16x32_bf16 v[212:215], v[52:55], v[100:103], v[212:215]
    ds_read_b64_tr_b16 v[38:39], v25 offset:2048
    v_mfma_f32_16x16x32_bf16 v[228:231], v[52:55], v[104:107], v[228:231]
    v_mfma_f32_16x16x32_bf16 v[244:247], v[52:55], v[108:111], v[244:247]
    v_mfma_f32_16x16x32_bf16 v[168:171], v[56:59], v[88:91], v[168:171]
    ds_read_b64_tr_b16 v[40:41], v26 offset:0
    v_mfma_f32_16x16x32_bf16 v[184:187], v[56:59], v[92:95], v[184:187]
    v_mfma_f32_16x16x32_bf16 v[200:203], v[56:59], v[96:99], v[200:203]
    v_mfma_f32_16x16x32_bf16 v[216:219], v[56:59], v[100:103], v[216:219]
    ds_read_b64_tr_b16 v[42:43], v26 offset:2048
    v_mfma_f32_16x16x32_bf16 v[232:235], v[56:59], v[104:107], v[232:235]
    v_mfma_f32_16x16x32_bf16 v[248:251], v[56:59], v[108:111], v[248:251]
    v_mfma_f32_16x16x32_bf16 v[172:175], v[60:63], v[88:91], v[172:175]
    ds_read_b64_tr_b16 v[44:45], v27 offset:0
    v_mfma_f32_16x16x32_bf16 v[188:191], v[60:63], v[92:95], v[188:191]
    v_mfma_f32_16x16x32_bf16 v[204:207], v[60:63], v[96:99], v[204:207]
    v_mfma_f32_16x16x32_bf16 v[220:223], v[60:63], v[100:103], v[220:223]
    ds_read_b64_tr_b16 v[46:47], v27 offset:2048
    v_mfma_f32_16x16x32_bf16 v[236:239], v[60:63], v[104:107], v[236:239]
    v_mfma_f32_16x16x32_bf16 v[252:255], v[60:63], v[108:111], v[252:255]
    s_waitcnt vmcnt(14)
    v_swap_b32 v114, v116
    v_swap_b32 v115, v117
    v_swap_b32 v122, v124
    v_swap_b32 v123, v125
    v_swap_b32 v130, v132
    v_swap_b32 v131, v133
    s_waitcnt lgkmcnt(0)
    v_mfma_f32_16x16x32_bf16 v[160:163], v[32:35], v[112:115], v[160:163]
    ds_read_b64_tr_b16 v[48:49], v24 offset:4096
    v_mfma_f32_16x16x32_bf16 v[176:179], v[32:35], v[116:119], v[176:179]
    s_add_u32 m0, s65, 16384
    s_nop 0
    buffer_load_dwordx4 v14, s[24:27], s70 offen lds
    v_mfma_f32_16x16x32_bf16 v[192:195], v[32:35], v[120:123], v[192:195]
    v_mfma_f32_16x16x32_bf16 v[208:211], v[32:35], v[124:127], v[208:211]
    s_add_u32 m0, s65, 17408
    s_nop 0
    buffer_load_dwordx4 v15, s[24:27], s70 offen lds
    ds_read_b64_tr_b16 v[50:51], v24 offset:6144
    v_mfma_f32_16x16x32_bf16 v[224:227], v[32:35], v[128:131], v[224:227]
    v_mfma_f32_16x16x32_bf16 v[240:243], v[32:35], v[132:135], v[240:243]
    s_add_u32 m0, s65, 18432
    s_nop 0
    buffer_load_dwordx4 v16, s[24:27], s70 offen lds
    v_mfma_f32_16x16x32_bf16 v[164:167], v[36:39], v[112:115], v[164:167]
    ds_read_b64_tr_b16 v[52:53], v25 offset:4096
    v_mfma_f32_16x16x32_bf16 v[180:183], v[36:39], v[116:119], v[180:183]
    s_add_u32 m0, s65, 19456
    s_nop 0
    buffer_load_dwordx4 v17, s[24:27], s70 offen lds
    s_add_u32 s70, s70, 40960
    v_mfma_f32_16x16x32_bf16 v[196:199], v[36:39], v[120:123], v[196:199]
    v_mfma_f32_16x16x32_bf16 v[212:215], v[36:39], v[124:127], v[212:215]
    ds_read_b64_tr_b16 v[54:55], v25 offset:6144
    v_mfma_f32_16x16x32_bf16 v[228:231], v[36:39], v[128:131], v[228:231]
    v_mfma_f32_16x16x32_bf16 v[244:247], v[36:39], v[132:135], v[244:247]
    v_mfma_f32_16x16x32_bf16 v[168:171], v[40:43], v[112:115], v[168:171]
    ds_read_b64_tr_b16 v[56:57], v26 offset:4096
    v_mfma_f32_16x16x32_bf16 v[184:187], v[40:43], v[116:119], v[184:187]
    v_mfma_f32_16x16x32_bf16 v[200:203], v[40:43], v[120:123], v[200:203]
    v_mfma_f32_16x16x32_bf16 v[216:219], v[40:43], v[124:127], v[216:219]
    ds_read_b64_tr_b16 v[58:59], v26 offset:6144
    v_mfma_f32_16x16x32_bf16 v[232:235], v[40:43], v[128:131], v[232:235]
    v_mfma_f32_16x16x32_bf16 v[248:251], v[40:43], v[132:135], v[248:251]
    v_mfma_f32_16x16x32_bf16 v[172:175], v[44:47], v[112:115], v[172:175]
    ds_read_b64_tr_b16 v[60:61], v27 offset:4096
    v_mfma_f32_16x16x32_bf16 v[188:191], v[44:47], v[116:119], v[188:191]
    v_mfma_f32_16x16x32_bf16 v[204:207], v[44:47], v[120:123], v[204:207]
    v_mfma_f32_16x16x32_bf16 v[220:223], v[44:47], v[124:127], v[220:223]
    ds_read_b64_tr_b16 v[62:63], v27 offset:6144
    v_mfma_f32_16x16x32_bf16 v[236:239], v[44:47], v[128:131], v[236:239]
    v_mfma_f32_16x16x32_bf16 v[252:255], v[44:47], v[132:135], v[252:255]
    s_waitcnt vmcnt(8)
    v_swap_b32 v138, v140
    v_swap_b32 v139, v141
    v_swap_b32 v146, v148
    v_swap_b32 v147, v149
    v_swap_b32 v154, v156
    v_swap_b32 v155, v157
    s_waitcnt lgkmcnt(0)
    v_mfma_f32_16x16x32_bf16 v[160:163], v[48:51], v[136:139], v[160:163]
    ds_read_b64_tr_b16 v[32:33], v24 offset:8192
    v_mfma_f32_16x16x32_bf16 v[176:179], v[48:51], v[140:143], v[176:179]
    s_add_u32 m0, s65, 0
    s_nop 0
    buffer_load_dwordx4 v14, s[24:27], s70 offen lds
    v_mfma_f32_16x16x32_bf16 v[192:195], v[48:51], v[144:147], v[192:195]
    v_mfma_f32_16x16x32_bf16 v[208:211], v[48:51], v[148:151], v[208:211]
    s_add_u32 m0, s65, 1024
    s_nop 0
    buffer_load_dwordx4 v15, s[24:27], s70 offen lds
    ds_read_b64_tr_b16 v[34:35], v24 offset:10240
    v_mfma_f32_16x16x32_bf16 v[224:227], v[48:51], v[152:155], v[224:227]
    v_mfma_f32_16x16x32_bf16 v[240:243], v[48:51], v[156:159], v[240:243]
    s_add_u32 m0, s65, 2048
    s_nop 0
    buffer_load_dwordx4 v16, s[24:27], s70 offen lds
    v_mfma_f32_16x16x32_bf16 v[164:167], v[52:55], v[136:139], v[164:167]
    ds_read_b64_tr_b16 v[36:37], v25 offset:8192
    v_mfma_f32_16x16x32_bf16 v[180:183], v[52:55], v[140:143], v[180:183]
    s_add_u32 m0, s65, 3072
    s_nop 0
    buffer_load_dwordx4 v17, s[24:27], s70 offen lds
    s_add_u32 s70, s70, 40960
    v_mfma_f32_16x16x32_bf16 v[196:199], v[52:55], v[144:147], v[196:199]
    v_mfma_f32_16x16x32_bf16 v[212:215], v[52:55], v[148:151], v[212:215]
    ds_read_b64_tr_b16 v[38:39], v25 offset:10240
    v_mfma_f32_16x16x32_bf16 v[228:231], v[52:55], v[152:155], v[228:231]
    v_mfma_f32_16x16x32_bf16 v[244:247], v[52:55], v[156:159], v[244:247]
    v_mfma_f32_16x16x32_bf16 v[168:171], v[56:59], v[136:139], v[168:171]
    ds_read_b64_tr_b16 v[40:41], v26 offset:8192
    v_mfma_f32_16x16x32_bf16 v[184:187], v[56:59], v[140:143], v[184:187]
    v_mfma_f32_16x16x32_bf16 v[200:203], v[56:59], v[144:147], v[200:203]
    v_mfma_f32_16x16x32_bf16 v[216:219], v[56:59], v[148:151], v[216:219]
    ds_read_b64_tr_b16 v[42:43], v26 offset:10240
    v_mfma_f32_16x16x32_bf16 v[232:235], v[56:59], v[152:155], v[232:235]
    v_mfma_f32_16x16x32_bf16 v[248:251], v[56:59], v[156:159], v[248:251]
    v_mfma_f32_16x16x32_bf16 v[172:175], v[60:63], v[136:139], v[172:175]
    ds_read_b64_tr_b16 v[44:45], v27 offset:8192
    v_mfma_f32_16x16x32_bf16 v[188:191], v[60:63], v[140:143], v[188:191]
    v_mfma_f32_16x16x32_bf16 v[204:207], v[60:63], v[144:147], v[204:207]
    v_mfma_f32_16x16x32_bf16 v[220:223], v[60:63], v[148:151], v[220:223]
    ds_read_b64_tr_b16 v[46:47], v27 offset:10240
    v_mfma_f32_16x16x32_bf16 v[236:239], v[60:63], v[152:155], v[236:239]
    v_mfma_f32_16x16x32_bf16 v[252:255], v[60:63], v[156:159], v[252:255]
    s_add_u32 m0, s65, 4096
    s_nop 0
    buffer_load_dwordx4 v14, s[24:27], s70 offen lds
    s_add_u32 m0, s65, 5120
    s_nop 0
    buffer_load_dwordx4 v15, s[24:27], s70 offen lds
    s_add_u32 m0, s65, 6144
    s_nop 0
    buffer_load_dwordx4 v16, s[24:27], s70 offen lds
    s_add_u32 m0, s65, 7168
    s_nop 0
    buffer_load_dwordx4 v17, s[24:27], s70 offen lds
    s_add_u32 s70, s70, 40960
    v_sub_f32 v28, 1.0, v28
    v_sub_f32 v29, 1.0, v29
    v_sub_f32 v30, 1.0, v30
    v_sub_f32 v31, 1.0, v31
    v_sub_f32 v8, 1.0, v8
    v_sub_f32 v9, 1.0, v9
    v_mul_f32 v160, v160, v28
    v_mul_f32 v161, v161, v28
    v_mul_f32 v162, v162, v28
    v_mul_f32 v163, v163, v28
    v_mul_f32 v164, v164, v28
    v_mul_f32 v165, v165, v28
    v_mul_f32 v166, v166, v28
    v_mul_f32 v167, v167, v28
    v_mul_f32 v168, v168, v28
    v_mul_f32 v169, v169, v28
    v_mul_f32 v170, v170, v28
    v_mul_f32 v171, v171, v28
    v_mul_f32 v172, v172, v28
    v_mul_f32 v173, v173, v28
    v_mul_f32 v174, v174, v28
    v_mul_f32 v175, v175, v28
    v_mul_f32 v176, v176, v29
    v_mul_f32 v177, v177, v29
    v_mul_f32 v178, v178, v29
    v_mul_f32 v179, v179, v29
    v_mul_f32 v180, v180, v29
    v_mul_f32 v181, v181, v29
    v_mul_f32 v182, v182, v29
    v_mul_f32 v183, v183, v29
    v_mul_f32 v184, v184, v29
    v_mul_f32 v185, v185, v29
    v_mul_f32 v186, v186, v29
    v_mul_f32 v187, v187, v29
    v_mul_f32 v188, v188, v29
    v_mul_f32 v189, v189, v29
    v_mul_f32 v190, v190, v29
    v_mul_f32 v191, v191, v29
    v_mul_f32 v192, v192, v30
    v_mul_f32 v193, v193, v30
    v_mul_f32 v194, v194, v30
    v_mul_f32 v195, v195, v30
    v_mul_f32 v196, v196, v30
    v_mul_f32 v197, v197, v30
    v_mul_f32 v198, v198, v30
    v_mul_f32 v199, v199, v30
    v_mul_f32 v200, v200, v30
    v_mul_f32 v201, v201, v30
    v_mul_f32 v202, v202, v30
    v_mul_f32 v203, v203, v30
    v_mul_f32 v204, v204, v30
    v_mul_f32 v205, v205, v30
    v_mul_f32 v206, v206, v30
    v_mul_f32 v207, v207, v30
    v_mul_f32 v208, v208, v31
    v_mul_f32 v209, v209, v31
    v_mul_f32 v210, v210, v31
    v_mul_f32 v211, v211, v31
    v_mul_f32 v212, v212, v31
    v_mul_f32 v213, v213, v31
    v_mul_f32 v214, v214, v31
    v_mul_f32 v215, v215, v31
    v_mul_f32 v216, v216, v31
    v_mul_f32 v217, v217, v31
    v_mul_f32 v218, v218, v31
    v_mul_f32 v219, v219, v31
    v_mul_f32 v220, v220, v31
    v_mul_f32 v221, v221, v31
    v_mul_f32 v222, v222, v31
    v_mul_f32 v223, v223, v31
    v_mul_f32 v224, v224, v8
    v_mul_f32 v225, v225, v8
    v_mul_f32 v226, v226, v8
    v_mul_f32 v227, v227, v8
    v_mul_f32 v228, v228, v8
    v_mul_f32 v229, v229, v8
    v_mul_f32 v230, v230, v8
    v_mul_f32 v231, v231, v8
    v_mul_f32 v232, v232, v8
    v_mul_f32 v233, v233, v8
    v_mul_f32 v234, v234, v8
    v_mul_f32 v235, v235, v8
    v_mul_f32 v236, v236, v8
    v_mul_f32 v237, v237, v8
    v_mul_f32 v238, v238, v8
    v_mul_f32 v239, v239, v8
    v_mul_f32 v240, v240, v9
    v_mul_f32 v241, v241, v9
    v_mul_f32 v242, v242, v9
    v_mul_f32 v243, v243, v9
    v_mul_f32 v244, v244, v9
    v_mul_f32 v245, v245, v9
    v_mul_f32 v246, v246, v9
    v_mul_f32 v247, v247, v9
    v_mul_f32 v248, v248, v9
    v_mul_f32 v249, v249, v9
    v_mul_f32 v250, v250, v9
    v_mul_f32 v251, v251, v9
    v_mul_f32 v252, v252, v9
    v_mul_f32 v253, v253, v9
    v_mul_f32 v254, v254, v9
    v_mul_f32 v255, v255, v9
    s_cmp_lg_u32 s3, 4
    s_cbranch_scc1 L_pbwO
    v_mov_b32 v5, 163480
    ds_read_b32 v6, v5
    v_cmp_gt_u32 vcc, 32, v1
    s_nop 1
    v_cndmask_b32 v5, 0, v1, vcc
    v_add_u32 v5, s72, v5
    v_lshlrev_b32 v5, 7, v5
    v_add_u32 v5, 18939904, v5
    s_waitcnt lgkmcnt(0)
    v_readfirstlane_b32 s85, v6
L_pollO:
    buffer_load_dword v6, v5, s[36:39], 0 offen sc1
    s_waitcnt vmcnt(0)
    v_cmp_ne_u32 vcc, s85, v6
    s_nop 0
    s_cmp_eq_u64 vcc, 0
    s_cbranch_scc1 L_polldO
    s_sleep 2
    s_branch L_pollO
L_polldO:
    v_mov_b32 v5, 163476
    v_mov_b32 v6, 1
    ds_write_b32 v5, v6
    s_waitcnt lgkmcnt(0)
    s_branch L_pbdO
L_pbwO:
    v_mov_b32 v5, 163476
L_pbsO:
    ds_read_b32 v6, v5
    s_waitcnt lgkmcnt(0)
    v_readfirstlane_b32 s64, v6
    s_nop 0
    s_cmp_lg_u32 s64, 0
    s_cbranch_scc1 L_pbdO
    s_sleep 1
    s_branch L_pbsO
L_pbdO:
    buffer_load_dwordx4 v[64:67], v18, s[36:39], s71 offen sc1
    buffer_load_dwordx4 v[68:71], v19, s[36:39], s71 offen sc1
    buffer_load_dwordx4 v[72:75], v20, s[36:39], s71 offen sc1
    buffer_load_dwordx4 v[76:79], v21, s[36:39], s71 offen sc1
    buffer_load_dwordx4 v[80:83], v22, s[36:39], s71 offen sc1
    buffer_load_dwordx4 v[84:87], v23, s[36:39], s71 offen sc1
    s_add_u32 s71, s71, 1024
    buffer_load_dwordx4 v[88:91], v18, s[36:39], s71 offen sc1
    buffer_load_dwordx4 v[92:95], v19, s[36:39], s71 offen sc1
    buffer_load_dwordx4 v[96:99], v20, s[36:39], s71 offen sc1
    buffer_load_dwordx4 v[100:103], v21, s[36:39], s71 offen sc1
    buffer_load_dwordx4 v[104:107], v22, s[36:39], s71 offen sc1
    buffer_load_dwordx4 v[108:111], v23, s[36:39], s71 offen sc1
    s_add_u32 s71, s71, 1024
    buffer_load_dwordx4 v[112:115], v18, s[36:39], s71 offen sc1
    buffer_load_dwordx4 v[116:119], v19, s[36:39], s71 offen sc1
    buffer_load_dwordx4 v[120:123], v20, s[36:39], s71 offen sc1
    buffer_load_dwordx4 v[124:127], v21, s[36:39], s71 offen sc1
    buffer_load_dwordx4 v[128:131], v22, s[36:39], s71 offen sc1
    buffer_load_dwordx4 v[132:135], v23, s[36:39], s71 offen sc1
    s_add_u32 s71, s71, 1024
    buffer_load_dwordx4 v[136:139], v18, s[36:39], s71 offen sc1
    buffer_load_dwordx4 v[140:143], v19, s[36:39], s71 offen sc1
    buffer_load_dwordx4 v[144:147], v20, s[36:39], s71 offen sc1
    buffer_load_dwordx4 v[148:151], v21, s[36:39], s71 offen sc1
    buffer_load_dwordx4 v[152:155], v22, s[36:39], s71 offen sc1
    buffer_load_dwordx4 v[156:159], v23, s[36:39], s71 offen sc1
    s_add_u32 s71, s71, 1024
    s_waitcnt vmcnt(18)
    s_waitcnt lgkmcnt(0)
    v_mfma_f32_16x16x32_bf16 v[160:163], v[32:35], v[64:67], v[160:163]
    ds_read_b64_tr_b16 v[48:49], v24 offset:12288
    v_mfma_f32_16x16x32_bf16 v[176:179], v[32:35], v[68:71], v[176:179]
    v_mfma_f32_16x16x32_bf16 v[192:195], v[32:35], v[72:75], v[192:195]
    v_mfma_f32_16x16x32_bf16 v[208:211], v[32:35], v[76:79], v[208:211]
    ds_read_b64_tr_b16 v[50:51], v24 offset:14336
    v_mfma_f32_16x16x32_bf16 v[224:227], v[32:35], v[80:83], v[224:227]
    v_mfma_f32_16x16x32_bf16 v[240:243], v[32:35], v[84:87], v[240:243]
    v_mfma_f32_16x16x32_bf16 v[164:167], v[36:39], v[64:67], v[164:167]
    ds_read_b64_tr_b16 v[52:53], v25 offset:12288
    v_mfma_f32_16x16x32_bf16 v[180:183], v[36:39], v[68:71], v[180:183]
    v_mfma_f32_16x16x32_bf16 v[196:199], v[36:39], v[72:75], v[196:199]
    v_mfma_f32_16x16x32_bf16 v[212:215], v[36:39], v[76:79], v[212:215]
    ds_read_b64_tr_b16 v[54:55], v25 offset:14336
    v_mfma_f32_16x16x32_bf16 v[228:231], v[36:39], v[80:83], v[228:231]
    v_mfma_f32_16x16x32_bf16 v[244:247], v[36:39], v[84:87], v[244:247]
    v_mfma_f32_16x16x32_bf16 v[168:171], v[40:43], v[64:67], v[168:171]
    ds_read_b64_tr_b16 v[56:57], v26 offset:12288
    v_mfma_f32_16x16x32_bf16 v[184:187], v[40:43], v[68:71], v[184:187]
    v_mfma_f32_16x16x32_bf16 v[200:203], v[40:43], v[72:75], v[200:203]
    v_mfma_f32_16x16x32_bf16 v[216:219], v[40:43], v[76:79], v[216:219]
    ds_read_b64_tr_b16 v[58:59], v26 offset:14336
    v_mfma_f32_16x16x32_bf16 v[232:235], v[40:43], v[80:83], v[232:235]
    v_mfma_f32_16x16x32_bf16 v[248:251], v[40:43], v[84:87], v[248:251]
    v_mfma_f32_16x16x32_bf16 v[172:175], v[44:47], v[64:67], v[172:175]
    ds_read_b64_tr_b16 v[60:61], v27 offset:12288
    v_mfma_f32_16x16x32_bf16 v[188:191], v[44:47], v[68:71], v[188:191]
    v_mfma_f32_16x16x32_bf16 v[204:207], v[44:47], v[72:75], v[204:207]
    v_mfma_f32_16x16x32_bf16 v[220:223], v[44:47], v[76:79], v[220:223]
    ds_read_b64_tr_b16 v[62:63], v27 offset:14336
    v_mfma_f32_16x16x32_bf16 v[236:239], v[44:47], v[80:83], v[236:239]
    v_mfma_f32_16x16x32_bf16 v[252:255], v[44:47], v[84:87], v[252:255]
    buffer_load_dwordx4 v[64:67], v18, s[36:39], s71 offen sc1
    buffer_load_dwordx4 v[68:71], v19, s[36:39], s71 offen sc1
    buffer_load_dwordx4 v[72:75], v20, s[36:39], s71 offen sc1
    buffer_load_dwordx4 v[76:79], v21, s[36:39], s71 offen sc1
    buffer_load_dwordx4 v[80:83], v22, s[36:39], s71 offen sc1
    buffer_load_dwordx4 v[84:87], v23, s[36:39], s71 offen sc1
    s_add_u32 s71, s71, 1024
    s_waitcnt vmcnt(18)
    s_waitcnt lgkmcnt(0)
    v_mfma_f32_16x16x32_bf16 v[160:163], v[48:51], v[88:91], v[160:163]
    ds_read_b64_tr_b16 v[32:33], v24 offset:16384
    v_mfma_f32_16x16x32_bf16 v[176:179], v[48:51], v[92:95], v[176:179]
    v_mfma_f32_16x16x32_bf16 v[192:195], v[48:51], v[96:99], v[192:195]
    v_mfma_f32_16x16x32_bf16 v[208:211], v[48:51], v[100:103], v[208:211]
    ds_read_b64_tr_b16 v[34:35], v24 offset:18432
    v_mfma_f32_16x16x32_bf16 v[224:227], v[48:51], v[104:107], v[224:227]
    v_mfma_f32_16x16x32_bf16 v[240:243], v[48:51], v[108:111], v[240:243]
    v_mfma_f32_16x16x32_bf16 v[164:167], v[52:55], v[88:91], v[164:167]
    ds_read_b64_tr_b16 v[36:37], v25 offset:16384
    v_mfma_f32_16x16x32_bf16 v[180:183], v[52:55], v[92:95], v[180:183]
    v_mfma_f32_16x16x32_bf16 v[196:199], v[52:55], v[96:99], v[196:199]
    v_mfma_f32_16x16x32_bf16 v[212:215], v[52:55], v[100:103], v[212:215]
    ds_read_b64_tr_b16 v[38:39], v25 offset:18432
    v_mfma_f32_16x16x32_bf16 v[228:231], v[52:55], v[104:107], v[228:231]
    v_mfma_f32_16x16x32_bf16 v[244:247], v[52:55], v[108:111], v[244:247]
    v_mfma_f32_16x16x32_bf16 v[168:171], v[56:59], v[88:91], v[168:171]
    ds_read_b64_tr_b16 v[40:41], v26 offset:16384
    v_mfma_f32_16x16x32_bf16 v[184:187], v[56:59], v[92:95], v[184:187]
    v_mfma_f32_16x16x32_bf16 v[200:203], v[56:59], v[96:99], v[200:203]
    v_mfma_f32_16x16x32_bf16 v[216:219], v[56:59], v[100:103], v[216:219]
    ds_read_b64_tr_b16 v[42:43], v26 offset:18432
    v_mfma_f32_16x16x32_bf16 v[232:235], v[56:59], v[104:107], v[232:235]
    v_mfma_f32_16x16x32_bf16 v[248:251], v[56:59], v[108:111], v[248:251]
    v_mfma_f32_16x16x32_bf16 v[172:175], v[60:63], v[88:91], v[172:175]
    ds_read_b64_tr_b16 v[44:45], v27 offset:16384
    v_mfma_f32_16x16x32_bf16 v[188:191], v[60:63], v[92:95], v[188:191]
    v_mfma_f32_16x16x32_bf16 v[204:207], v[60:63], v[96:99], v[204:207]
    v_mfma_f32_16x16x32_bf16 v[220:223], v[60:63], v[100:103], v[220:223]
    ds_read_b64_tr_b16 v[46:47], v27 offset:18432
    v_mfma_f32_16x16x32_bf16 v[236:239], v[60:63], v[104:107], v[236:239]
    v_mfma_f32_16x16x32_bf16 v[252:255], v[60:63], v[108:111], v[252:255]
    s_waitcnt vmcnt(12)
    s_waitcnt lgkmcnt(0)
    v_mfma_f32_16x16x32_bf16 v[160:163], v[32:35], v[112:115], v[160:163]
    ds_read_b64_tr_b16 v[48:49], v24 offset:0
    v_mfma_f32_16x16x32_bf16 v[176:179], v[32:35], v[116:119], v[176:179]
    v_mfma_f32_16x16x32_bf16 v[192:195], v[32:35], v[120:123], v[192:195]
    v_mfma_f32_16x16x32_bf16 v[208:211], v[32:35], v[124:127], v[208:211]
    ds_read_b64_tr_b16 v[50:51], v24 offset:2048
    v_mfma_f32_16x16x32_bf16 v[224:227], v[32:35], v[128:131], v[224:227]
    v_mfma_f32_16x16x32_bf16 v[240:243], v[32:35], v[132:135], v[240:243]
    v_mfma_f32_16x16x32_bf16 v[164:167], v[36:39], v[112:115], v[164:167]
    ds_read_b64_tr_b16 v[52:53], v25 offset:0
    v_mfma_f32_16x16x32_bf16 v[180:183], v[36:39], v[116:119], v[180:183]
    v_mfma_f32_16x16x32_bf16 v[196:199], v[36:39], v[120:123], v[196:199]
    v_mfma_f32_16x16x32_bf16 v[212:215], v[36:39], v[124:127], v[212:215]
    ds_read_b64_tr_b16 v[54:55], v25 offset:2048
    v_mfma_f32_16x16x32_bf16 v[228:231], v[36:39], v[128:131], v[228:231]
    v_mfma_f32_16x16x32_bf16 v[244:247], v[36:39], v[132:135], v[244:247]
    v_mfma_f32_16x16x32_bf16 v[168:171], v[40:43], v[112:115], v[168:171]
    ds_read_b64_tr_b16 v[56:57], v26 offset:0
    v_mfma_f32_16x16x32_bf16 v[184:187], v[40:43], v[116:119], v[184:187]
    v_mfma_f32_16x16x32_bf16 v[200:203], v[40:43], v[120:123], v[200:203]
    v_mfma_f32_16x16x32_bf16 v[216:219], v[40:43], v[124:127], v[216:219]
    ds_read_b64_tr_b16 v[58:59], v26 offset:2048
    v_mfma_f32_16x16x32_bf16 v[232:235], v[40:43], v[128:131], v[232:235]
    v_mfma_f32_16x16x32_bf16 v[248:251], v[40:43], v[132:135], v[248:251]
    v_mfma_f32_16x16x32_bf16 v[172:175], v[44:47], v[112:115], v[172:175]
    ds_read_b64_tr_b16 v[60:61], v27 offset:0
    v_mfma_f32_16x16x32_bf16 v[188:191], v[44:47], v[116:119], v[188:191]
    v_mfma_f32_16x16x32_bf16 v[204:207], v[44:47], v[120:123], v[204:207]
    v_mfma_f32_16x16x32_bf16 v[220:223], v[44:47], v[124:127], v[220:223]
    ds_read_b64_tr_b16 v[62:63], v27 offset:2048
    v_mfma_f32_16x16x32_bf16 v[236:239], v[44:47], v[128:131], v[236:239]
    v_mfma_f32_16x16x32_bf16 v[252:255], v[44:47], v[132:135], v[252:255]
    s_waitcnt vmcnt(6)
    s_waitcnt lgkmcnt(0)
    v_mfma_f32_16x16x32_bf16 v[160:163], v[48:51], v[136:139], v[160:163]
    ds_read_b64_tr_b16 v[32:33], v24 offset:4096
    v_mfma_f32_16x16x32_bf16 v[176:179], v[48:51], v[140:143], v[176:179]
    v_mfma_f32_16x16x32_bf16 v[192:195], v[48:51], v[144:147], v[192:195]
    v_mfma_f32_16x16x32_bf16 v[208:211], v[48:51], v[148:151], v[208:211]
    ds_read_b64_tr_b16 v[34:35], v24 offset:6144
    v_mfma_f32_16x16x32_bf16 v[224:227], v[48:51], v[152:155], v[224:227]
    v_mfma_f32_16x16x32_bf16 v[240:243], v[48:51], v[156:159], v[240:243]
    v_mfma_f32_16x16x32_bf16 v[164:167], v[52:55], v[136:139], v[164:167]
    ds_read_b64_tr_b16 v[36:37], v25 offset:4096
    v_mfma_f32_16x16x32_bf16 v[180:183], v[52:55], v[140:143], v[180:183]
    v_mfma_f32_16x16x32_bf16 v[196:199], v[52:55], v[144:147], v[196:199]
    v_mfma_f32_16x16x32_bf16 v[212:215], v[52:55], v[148:151], v[212:215]
    ds_read_b64_tr_b16 v[38:39], v25 offset:6144
    v_mfma_f32_16x16x32_bf16 v[228:231], v[52:55], v[152:155], v[228:231]
    v_mfma_f32_16x16x32_bf16 v[244:247], v[52:55], v[156:159], v[244:247]
    v_mfma_f32_16x16x32_bf16 v[168:171], v[56:59], v[136:139], v[168:171]
    ds_read_b64_tr_b16 v[40:41], v26 offset:4096
    v_mfma_f32_16x16x32_bf16 v[184:187], v[56:59], v[140:143], v[184:187]
    v_mfma_f32_16x16x32_bf16 v[200:203], v[56:59], v[144:147], v[200:203]
    v_mfma_f32_16x16x32_bf16 v[216:219], v[56:59], v[148:151], v[216:219]
    ds_read_b64_tr_b16 v[42:43], v26 offset:6144
    v_mfma_f32_16x16x32_bf16 v[232:235], v[56:59], v[152:155], v[232:235]
    v_mfma_f32_16x16x32_bf16 v[248:251], v[56:59], v[156:159], v[248:251]
    v_mfma_f32_16x16x32_bf16 v[172:175], v[60:63], v[136:139], v[172:175]
    ds_read_b64_tr_b16 v[44:45], v27 offset:4096
    v_mfma_f32_16x16x32_bf16 v[188:191], v[60:63], v[140:143], v[188:191]
    v_mfma_f32_16x16x32_bf16 v[204:207], v[60:63], v[144:147], v[204:207]
    v_mfma_f32_16x16x32_bf16 v[220:223], v[60:63], v[148:151], v[220:223]
    ds_read_b64_tr_b16 v[46:47], v27 offset:6144
    v_mfma_f32_16x16x32_bf16 v[236:239], v[60:63], v[152:155], v[236:239]
    v_mfma_f32_16x16x32_bf16 v[252:255], v[60:63], v[156:159], v[252:255]
    s_waitcnt vmcnt(0)
    s_waitcnt lgkmcnt(0)
    v_mfma_f32_16x16x32_bf16 v[160:163], v[32:35], v[64:67], v[160:163]
    v_mfma_f32_16x16x32_bf16 v[176:179], v[32:35], v[68:71], v[176:179]
    v_mfma_f32_16x16x32_bf16 v[192:195], v[32:35], v[72:75], v[192:195]
    v_mfma_f32_16x16x32_bf16 v[208:211], v[32:35], v[76:79], v[208:211]
    v_mfma_f32_16x16x32_bf16 v[224:227], v[32:35], v[80:83], v[224:227]
    v_mfma_f32_16x16x32_bf16 v[240:243], v[32:35], v[84:87], v[240:243]
    v_mfma_f32_16x16x32_bf16 v[164:167], v[36:39], v[64:67], v[164:167]
    v_mfma_f32_16x16x32_bf16 v[180:183], v[36:39], v[68:71], v[180:183]
    v_mfma_f32_16x16x32_bf16 v[196:199], v[36:39], v[72:75], v[196:199]
    v_mfma_f32_16x16x32_bf16 v[212:215], v[36:39], v[76:79], v[212:215]
    v_mfma_f32_16x16x32_bf16 v[228:231], v[36:39], v[80:83], v[228:231]
    v_mfma_f32_16x16x32_bf16 v[244:247], v[36:39], v[84:87], v[244:247]
    v_mfma_f32_16x16x32_bf16 v[168:171], v[40:43], v[64:67], v[168:171]
    v_mfma_f32_16x16x32_bf16 v[184:187], v[40:43], v[68:71], v[184:187]
    v_mfma_f32_16x16x32_bf16 v[200:203], v[40:43], v[72:75], v[200:203]
    v_mfma_f32_16x16x32_bf16 v[216:219], v[40:43], v[76:79], v[216:219]
    v_mfma_f32_16x16x32_bf16 v[232:235], v[40:43], v[80:83], v[232:235]
    v_mfma_f32_16x16x32_bf16 v[248:251], v[40:43], v[84:87], v[248:251]
    v_mfma_f32_16x16x32_bf16 v[172:175], v[44:47], v[64:67], v[172:175]
    v_mfma_f32_16x16x32_bf16 v[188:191], v[44:47], v[68:71], v[188:191]
    v_mfma_f32_16x16x32_bf16 v[204:207], v[44:47], v[72:75], v[204:207]
    v_mfma_f32_16x16x32_bf16 v[220:223], v[44:47], v[76:79], v[220:223]
    v_mfma_f32_16x16x32_bf16 v[236:239], v[44:47], v[80:83], v[236:239]
    v_mfma_f32_16x16x32_bf16 v[252:255], v[44:47], v[84:87], v[252:255]
    s_barrier
    s_cmp_eq_u32 s87, 0
    s_cbranch_scc0 L_red0
    ds_write_b128 v4, v[164:167] offset:18432
    ds_write_b128 v4, v[180:183] offset:19456
    ds_write_b128 v4, v[196:199] offset:20480
    ds_write_b128 v4, v[212:215] offset:21504
    ds_write_b128 v4, v[228:231] offset:22528
    ds_write_b128 v4, v[244:247] offset:23552
    ds_write_b128 v4, v[168:171] offset:36864
    ds_write_b128 v4, v[184:187] offset:37888
    ds_write_b128 v4, v[200:203] offset:38912
    ds_write_b128 v4, v[216:219] offset:39936
    ds_write_b128 v4, v[232:235] offset:40960
    ds_write_b128 v4, v[248:251] offset:41984
    ds_write_b128 v4, v[172:175] offset:55296
    ds_write_b128 v4, v[188:191] offset:56320
    ds_write_b128 v4, v[204:207] offset:57344
    ds_write_b128 v4, v[220:223] offset:58368
    ds_write_b128 v4, v[236:239] offset:59392
    ds_write_b128 v4, v[252:255] offset:60416
    s_waitcnt lgkmcnt(0)
    s_barrier
    v_add_u32 v6, 0, v4
    ds_read_b128 v[64:67], v6 offset:0
    ds_read_b128 v[68:71], v6 offset:1024
    ds_read_b128 v[72:75], v6 offset:2048
    ds_read_b128 v[76:79], v6 offset:3072
    ds_read_b128 v[80:83], v6 offset:4096
    ds_read_b128 v[84:87], v6 offset:5120
    ds_read_b128 v[88:91], v6 offset:6144
    ds_read_b128 v[92:95], v6 offset:7168
    ds_read_b128 v[96:99], v6 offset:8192
    ds_read_b128 v[100:103], v6 offset:9216
    ds_read_b128 v[104:107], v6 offset:10240
    ds_read_b128 v[108:111], v6 offset:11264
    ds_read_b128 v[112:115], v6 offset:12288
    ds_read_b128 v[116:119], v6 offset:13312
    ds_read_b128 v[120:123], v6 offset:14336
    ds_read_b128 v[124:127], v6 offset:15360
    ds_read_b128 v[128:131], v6 offset:16384
    ds_read_b128 v[132:135], v6 offset:17408
    s_waitcnt lgkmcnt(15)
    v_add_f32 v136, v160, v64
    v_add_f32 v137, v161, v65
    v_add_f32 v138, v162, v66
    v_add_f32 v139, v163, v67
    s_waitcnt lgkmcnt(15)
    v_add_f32 v140, v176, v68
    v_add_f32 v141, v177, v69
    v_add_f32 v142, v178, v70
    v_add_f32 v143, v179, v71
    s_waitcnt lgkmcnt(15)
    v_add_f32 v144, v192, v72
    v_add_f32 v145, v193, v73
    v_add_f32 v146, v194, v74
    v_add_f32 v147, v195, v75
    s_waitcnt lgkmcnt(14)
    v_add_f32 v148, v208, v76
    v_add_f32 v149, v209, v77
    v_add_f32 v150, v210, v78
    v_add_f32 v151, v211, v79
    s_waitcnt lgkmcnt(13)
    v_add_f32 v152, v224, v80
    v_add_f32 v153, v225, v81
    v_add_f32 v154, v226, v82
    v_add_f32 v155, v227, v83
    s_waitcnt lgkmcnt(12)
    v_add_f32 v156, v240, v84
    v_add_f32 v157, v241, v85
    v_add_f32 v158, v242, v86
    v_add_f32 v159, v243, v87
    s_waitcnt lgkmcnt(11)
    v_add_f32 v136, v136, v88
    v_add_f32 v137, v137, v89
    v_add_f32 v138, v138, v90
    v_add_f32 v139, v139, v91
    s_waitcnt lgkmcnt(10)
    v_add_f32 v140, v140, v92
    v_add_f32 v141, v141, v93
    v_add_f32 v142, v142, v94
    v_add_f32 v143, v143, v95
    s_waitcnt lgkmcnt(9)
    v_add_f32 v144, v144, v96
    v_add_f32 v145, v145, v97
    v_add_f32 v146, v146, v98
    v_add_f32 v147, v147, v99
    s_waitcnt lgkmcnt(8)
    v_add_f32 v148, v148, v100
    v_add_f32 v149, v149, v101
    v_add_f32 v150, v150, v102
    v_add_f32 v151, v151, v103
    s_waitcnt lgkmcnt(7)
    v_add_f32 v152, v152, v104
    v_add_f32 v153, v153, v105
    v_add_f32 v154, v154, v106
    v_add_f32 v155, v155, v107
    s_waitcnt lgkmcnt(6)
    v_add_f32 v156, v156, v108
    v_add_f32 v157, v157, v109
    v_add_f32 v158, v158, v110
    v_add_f32 v159, v159, v111
    s_waitcnt lgkmcnt(5)
    v_add_f32 v136, v136, v112
    v_add_f32 v137, v137, v113
    v_add_f32 v138, v138, v114
    v_add_f32 v139, v139, v115
    s_waitcnt lgkmcnt(4)
    v_add_f32 v140, v140, v116
    v_add_f32 v141, v141, v117
    v_add_f32 v142, v142, v118
    v_add_f32 v143, v143, v119
    s_waitcnt lgkmcnt(3)
    v_add_f32 v144, v144, v120
    v_add_f32 v145, v145, v121
    v_add_f32 v146, v146, v122
    v_add_f32 v147, v147, v123
    s_waitcnt lgkmcnt(2)
    v_add_f32 v148, v148, v124
    v_add_f32 v149, v149, v125
    v_add_f32 v150, v150, v126
    v_add_f32 v151, v151, v127
    s_waitcnt lgkmcnt(1)
    v_add_f32 v152, v152, v128
    v_add_f32 v153, v153, v129
    v_add_f32 v154, v154, v130
    v_add_f32 v155, v155, v131
    s_waitcnt lgkmcnt(0)
    v_add_f32 v156, v156, v132
    v_add_f32 v157, v157, v133
    v_add_f32 v158, v158, v134
    v_add_f32 v159, v159, v135
    s_branch L_redone
    s_nop 7
L_red0:
    s_cmp_eq_u32 s87, 1
    s_cbranch_scc0 L_red1
    ds_write_b128 v4, v[160:163] offset:0
    ds_write_b128 v4, v[176:179] offset:1024
    ds_write_b128 v4, v[192:195] offset:2048
    ds_write_b128 v4, v[208:211] offset:3072
    ds_write_b128 v4, v[224:227] offset:4096
    ds_write_b128 v4, v[240:243] offset:5120
    ds_write_b128 v4, v[168:171] offset:43008
    ds_write_b128 v4, v[184:187] offset:44032
    ds_write_b128 v4, v[200:203] offset:45056
    ds_write_b128 v4, v[216:219] offset:46080
    ds_write_b128 v4, v[232:235] offset:47104
    ds_write_b128 v4, v[248:251] offset:48128
    ds_write_b128 v4, v[172:175] offset:61440
    ds_write_b128 v4, v[188:191] offset:62464
    ds_write_b128 v4, v[204:207] offset:63488
    ds_write_b128 v4, v[220:223] offset:64512
    v_add_u32 v6, 65536, v4
    ds_write_b128 v6, v[236:239] offset:0
    v_add_u32 v6, 65536, v4
    ds_write_b128 v6, v[252:255] offset:1024
    s_waitcnt lgkmcnt(0)
    s_barrier
    v_add_u32 v6, 18432, v4
    ds_read_b128 v[64:67], v6 offset:0
    ds_read_b128 v[68:71], v6 offset:1024
    ds_read_b128 v[72:75], v6 offset:2048
    ds_read_b128 v[76:79], v6 offset:3072
    ds_read_b128 v[80:83], v6 offset:4096
    ds_read_b128 v[84:87], v6 offset:5120
    ds_read_b128 v[88:91], v6 offset:6144
    ds_read_b128 v[92:95], v6 offset:7168
    ds_read_b128 v[96:99], v6 offset:8192
    ds_read_b128 v[100:103], v6 offset:9216
    ds_read_b128 v[104:107], v6 offset:10240
    ds_read_b128 v[108:111], v6 offset:11264
    ds_read_b128 v[112:115], v6 offset:12288
    ds_read_b128 v[116:119], v6 offset:13312
    ds_read_b128 v[120:123], v6 offset:14336
    ds_read_b128 v[124:127], v6 offset:15360
    ds_read_b128 v[128:131], v6 offset:16384
    ds_read_b128 v[132:135], v6 offset:17408
    s_waitcnt lgkmcnt(15)
    v_add_f32 v136, v164, v64
    v_add_f32 v137, v165, v65
    v_add_f32 v138, v166, v66
    v_add_f32 v139, v167, v67
    s_waitcnt lgkmcnt(15)
    v_add_f32 v140, v180, v68
    v_add_f32 v141, v181, v69
    v_add_f32 v142, v182, v70
    v_add_f32 v143, v183, v71
    s_waitcnt lgkmcnt(15)
    v_add_f32 v144, v196, v72
    v_add_f32 v145, v197, v73
    v_add_f32 v146, v198, v74
    v_add_f32 v147, v199, v75
    s_waitcnt lgkmcnt(14)
    v_add_f32 v148, v212, v76
    v_add_f32 v149, v213, v77
    v_add_f32 v150, v214, v78
    v_add_f32 v151, v215, v79
    s_waitcnt lgkmcnt(13)
    v_add_f32 v152, v228, v80
    v_add_f32 v153, v229, v81
    v_add_f32 v154, v230, v82
    v_add_f32 v155, v231, v83
    s_waitcnt lgkmcnt(12)
    v_add_f32 v156, v244, v84
    v_add_f32 v157, v245, v85
    v_add_f32 v158, v246, v86
    v_add_f32 v159, v247, v87
    s_waitcnt lgkmcnt(11)
    v_add_f32 v136, v136, v88
    v_add_f32 v137, v137, v89
    v_add_f32 v138, v138, v90
    v_add_f32 v139, v139, v91
    s_waitcnt lgkmcnt(10)
    v_add_f32 v140, v140, v92
    v_add_f32 v141, v141, v93
    v_add_f32 v142, v142, v94
    v_add_f32 v143, v143, v95
    s_waitcnt lgkmcnt(9)
    v_add_f32 v144, v144, v96
    v_add_f32 v145, v145, v97
    v_add_f32 v146, v146, v98
    v_add_f32 v147, v147, v99
    s_waitcnt lgkmcnt(8)
    v_add_f32 v148, v148, v100
    v_add_f32 v149, v149, v101
    v_add_f32 v150, v150, v102
    v_add_f32 v151, v151, v103
    s_waitcnt lgkmcnt(7)
    v_add_f32 v152, v152, v104
    v_add_f32 v153, v153, v105
    v_add_f32 v154, v154, v106
    v_add_f32 v155, v155, v107
    s_waitcnt lgkmcnt(6)
    v_add_f32 v156, v156, v108
    v_add_f32 v157, v157, v109
    v_add_f32 v158, v158, v110
    v_add_f32 v159, v159, v111
    s_waitcnt lgkmcnt(5)
    v_add_f32 v136, v136, v112
    v_add_f32 v137, v137, v113
    v_add_f32 v138, v138, v114
    v_add_f32 v139, v139, v115
    s_waitcnt lgkmcnt(4)
    v_add_f32 v140, v140, v116
    v_add_f32 v141, v141, v117
    v_add_f32 v142, v142, v118
    v_add_f32 v143, v143, v119
    s_waitcnt lgkmcnt(3)
    v_add_f32 v144, v144, v120
    v_add_f32 v145, v145, v121
    v_add_f32 v146, v146, v122
    v_add_f32 v147, v147, v123
    s_waitcnt lgkmcnt(2)
    v_add_f32 v148, v148, v124
    v_add_f32 v149, v149, v125
    v_add_f32 v150, v150, v126
    v_add_f32 v151, v151, v127
    s_waitcnt lgkmcnt(1)
    v_add_f32 v152, v152, v128
    v_add_f32 v153, v153, v129
    v_add_f32 v154, v154, v130
    v_add_f32 v155, v155, v131
    s_waitcnt lgkmcnt(0)
    v_add_f32 v156, v156, v132
    v_add_f32 v157, v157, v133
    v_add_f32 v158, v158, v134
    v_add_f32 v159, v159, v135
    s_branch L_redone
    s_nop 7
L_red1:
    s_cmp_eq_u32 s87, 2
    s_cbranch_scc0 L_red2
    ds_write_b128 v4, v[160:163] offset:6144
    ds_write_b128 v4, v[176:179] offset:7168
    ds_write_b128 v4, v[192:195] offset:8192
    ds_write_b128 v4, v[208:211] offset:9216
    ds_write_b128 v4, v[224:227] offset:10240
    ds_write_b128 v4, v[240:243] offset:11264
    ds_write_b128 v4, v[164:167] offset:24576
    ds_write_b128 v4, v[180:183] offset:25600
    ds_write_b128 v4, v[196:199] offset:26624
    ds_write_b128 v4, v[212:215] offset:27648
    ds_write_b128 v4, v[228:231] offset:28672
    ds_write_b128 v4, v[244:247] offset:29696
    v_add_u32 v6, 65536, v4
    ds_write_b128 v6, v[172:175] offset:2048
    v_add_u32 v6, 65536, v4
    ds_write_b128 v6, v[188:191] offset:3072
    v_add_u32 v6, 65536, v4
    ds_write_b128 v6, v[204:207] offset:4096
    v_add_u32 v6, 65536, v4
    ds_write_b128 v6, v[220:223] offset:5120
    v_add_u32 v6, 65536, v4
    ds_write_b128 v6, v[236:239] offset:6144
    v_add_u32 v6, 65536, v4
    ds_write_b128 v6, v[252:255] offset:7168
    s_waitcnt lgkmcnt(0)
    s_barrier
    v_add_u32 v6, 36864, v4
    ds_read_b128 v[64:67], v6 offset:0
    ds_read_b128 v[68:71], v6 offset:1024
    ds_read_b128 v[72:75], v6 offset:2048
    ds_read_b128 v[76:79], v6 offset:3072
    ds_read_b128 v[80:83], v6 offset:4096
    ds_read_b128 v[84:87], v6 offset:5120
    ds_read_b128 v[88:91], v6 offset:6144
    ds_read_b128 v[92:95], v6 offset:7168
    ds_read_b128 v[96:99], v6 offset:8192
    ds_read_b128 v[100:103], v6 offset:9216
    ds_read_b128 v[104:107], v6 offset:10240
    ds_read_b128 v[108:111], v6 offset:11264
    ds_read_b128 v[112:115], v6 offset:12288
    ds_read_b128 v[116:119], v6 offset:13312
    ds_read_b128 v[120:123], v6 offset:14336
    ds_read_b128 v[124:127], v6 offset:15360
    ds_read_b128 v[128:131], v6 offset:16384
    ds_read_b128 v[132:135], v6 offset:17408
    s_waitcnt lgkmcnt(15)
    v_add_f32 v136, v168, v64
    v_add_f32 v137, v169, v65
    v_add_f32 v138, v170, v66
    v_add_f32 v139, v171, v67
    s_waitcnt lgkmcnt(15)
    v_add_f32 v140, v184, v68
    v_add_f32 v141, v185, v69
    v_add_f32 v142, v186, v70
    v_add_f32 v143, v187, v71
    s_waitcnt lgkmcnt(15)
    v_add_f32 v144, v200, v72
    v_add_f32 v145, v201, v73
    v_add_f32 v146, v202, v74
    v_add_f32 v147, v203, v75
    s_waitcnt lgkmcnt(14)
    v_add_f32 v148, v216, v76
    v_add_f32 v149, v217, v77
    v_add_f32 v150, v218, v78
    v_add_f32 v151, v219, v79
    s_waitcnt lgkmcnt(13)
    v_add_f32 v152, v232, v80
    v_add_f32 v153, v233, v81
    v_add_f32 v154, v234, v82
    v_add_f32 v155, v235, v83
    s_waitcnt lgkmcnt(12)
    v_add_f32 v156, v248, v84
    v_add_f32 v157, v249, v85
    v_add_f32 v158, v250, v86
    v_add_f32 v159, v251, v87
    s_waitcnt lgkmcnt(11)
    v_add_f32 v136, v136, v88
    v_add_f32 v137, v137, v89
    v_add_f32 v138, v138, v90
    v_add_f32 v139, v139, v91
    s_waitcnt lgkmcnt(10)
    v_add_f32 v140, v140, v92
    v_add_f32 v141, v141, v93
    v_add_f32 v142, v142, v94
    v_add_f32 v143, v143, v95
    s_waitcnt lgkmcnt(9)
    v_add_f32 v144, v144, v96
    v_add_f32 v145, v145, v97
    v_add_f32 v146, v146, v98
    v_add_f32 v147, v147, v99
    s_waitcnt lgkmcnt(8)
    v_add_f32 v148, v148, v100
    v_add_f32 v149, v149, v101
    v_add_f32 v150, v150, v102
    v_add_f32 v151, v151, v103
    s_waitcnt lgkmcnt(7)
    v_add_f32 v152, v152, v104
    v_add_f32 v153, v153, v105
    v_add_f32 v154, v154, v106
    v_add_f32 v155, v155, v107
    s_waitcnt lgkmcnt(6)
    v_add_f32 v156, v156, v108
    v_add_f32 v157, v157, v109
    v_add_f32 v158, v158, v110
    v_add_f32 v159, v159, v111
    s_waitcnt lgkmcnt(5)
    v_add_f32 v136, v136, v112
    v_add_f32 v137, v137, v113
    v_add_f32 v138, v138, v114
    v_add_f32 v139, v139, v115
    s_waitcnt lgkmcnt(4)
    v_add_f32 v140, v140, v116
    v_add_f32 v141, v141, v117
    v_add_f32 v142, v142, v118
    v_add_f32 v143, v143, v119
    s_waitcnt lgkmcnt(3)
    v_add_f32 v144, v144, v120
    v_add_f32 v145, v145, v121
    v_add_f32 v146, v146, v122
    v_add_f32 v147, v147, v123
    s_waitcnt lgkmcnt(2)
    v_add_f32 v148, v148, v124
    v_add_f32 v149, v149, v125
    v_add_f32 v150, v150, v126
    v_add_f32 v151, v151, v127
    s_waitcnt lgkmcnt(1)
    v_add_f32 v152, v152, v128
    v_add_f32 v153, v153, v129
    v_add_f32 v154, v154, v130
    v_add_f32 v155, v155, v131
    s_waitcnt lgkmcnt(0)
    v_add_f32 v156, v156, v132
    v_add_f32 v157, v157, v133
    v_add_f32 v158, v158, v134
    v_add_f32 v159, v159, v135
    s_branch L_redone
    s_nop 7
L_red2:
    s_cmp_eq_u32 s87, 3
    s_cbranch_scc0 L_red3
    ds_write_b128 v4, v[160:163] offset:12288
    ds_write_b128 v4, v[176:179] offset:13312
    ds_write_b128 v4, v[192:195] offset:14336
    ds_write_b128 v4, v[208:211] offset:15360
    ds_write_b128 v4, v[224:227] offset:16384
    ds_write_b128 v4, v[240:243] offset:17408
    ds_write_b128 v4, v[164:167] offset:30720
    ds_write_b128 v4, v[180:183] offset:31744
    ds_write_b128 v4, v[196:199] offset:32768
    ds_write_b128 v4, v[212:215] offset:33792
    ds_write_b128 v4, v[228:231] offset:34816
    ds_write_b128 v4, v[244:247] offset:35840
    ds_write_b128 v4, v[168:171] offset:49152
    ds_write_b128 v4, v[184:187] offset:50176
    ds_write_b128 v4, v[200:203] offset:51200
    ds_write_b128 v4, v[216:219] offset:52224
    ds_write_b128 v4, v[232:235] offset:53248
    ds_write_b128 v4, v[248:251] offset:54272
    s_waitcnt lgkmcnt(0)
    s_barrier
    v_add_u32 v6, 55296, v4
    ds_read_b128 v[64:67], v6 offset:0
    ds_read_b128 v[68:71], v6 offset:1024
    ds_read_b128 v[72:75], v6 offset:2048
    ds_read_b128 v[76:79], v6 offset:3072
    ds_read_b128 v[80:83], v6 offset:4096
    ds_read_b128 v[84:87], v6 offset:5120
    ds_read_b128 v[88:91], v6 offset:6144
    ds_read_b128 v[92:95], v6 offset:7168
    ds_read_b128 v[96:99], v6 offset:8192
    ds_read_b128 v[100:103], v6 offset:9216
    ds_read_b128 v[104:107], v6 offset:10240
    ds_read_b128 v[108:111], v6 offset:11264
    ds_read_b128 v[112:115], v6 offset:12288
    ds_read_b128 v[116:119], v6 offset:13312
    ds_read_b128 v[120:123], v6 offset:14336
    ds_read_b128 v[124:127], v6 offset:15360
    ds_read_b128 v[128:131], v6 offset:16384
    ds_read_b128 v[132:135], v6 offset:17408
    s_waitcnt lgkmcnt(15)
    v_add_f32 v136, v172, v64
    v_add_f32 v137, v173, v65
    v_add_f32 v138, v174, v66
    v_add_f32 v139, v175, v67
    s_waitcnt lgkmcnt(15)
    v_add_f32 v140, v188, v68
    v_add_f32 v141, v189, v69
    v_add_f32 v142, v190, v70
    v_add_f32 v143, v191, v71
    s_waitcnt lgkmcnt(15)
    v_add_f32 v144, v204, v72
    v_add_f32 v145, v205, v73
    v_add_f32 v146, v206, v74
    v_add_f32 v147, v207, v75
    s_waitcnt lgkmcnt(14)
    v_add_f32 v148, v220, v76
    v_add_f32 v149, v221, v77
    v_add_f32 v150, v222, v78
    v_add_f32 v151, v223, v79
    s_waitcnt lgkmcnt(13)
    v_add_f32 v152, v236, v80
    v_add_f32 v153, v237, v81
    v_add_f32 v154, v238, v82
    v_add_f32 v155, v239, v83
    s_waitcnt lgkmcnt(12)
    v_add_f32 v156, v252, v84
    v_add_f32 v157, v253, v85
    v_add_f32 v158, v254, v86
    v_add_f32 v159, v255, v87
    s_waitcnt lgkmcnt(11)
    v_add_f32 v136, v136, v88
    v_add_f32 v137, v137, v89
    v_add_f32 v138, v138, v90
    v_add_f32 v139, v139, v91
    s_waitcnt lgkmcnt(10)
    v_add_f32 v140, v140, v92
    v_add_f32 v141, v141, v93
    v_add_f32 v142, v142, v94
    v_add_f32 v143, v143, v95
    s_waitcnt lgkmcnt(9)
    v_add_f32 v144, v144, v96
    v_add_f32 v145, v145, v97
    v_add_f32 v146, v146, v98
    v_add_f32 v147, v147, v99
    s_waitcnt lgkmcnt(8)
    v_add_f32 v148, v148, v100
    v_add_f32 v149, v149, v101
    v_add_f32 v150, v150, v102
    v_add_f32 v151, v151, v103
    s_waitcnt lgkmcnt(7)
    v_add_f32 v152, v152, v104
    v_add_f32 v153, v153, v105
    v_add_f32 v154, v154, v106
    v_add_f32 v155, v155, v107
    s_waitcnt lgkmcnt(6)
    v_add_f32 v156, v156, v108
    v_add_f32 v157, v157, v109
    v_add_f32 v158, v158, v110
    v_add_f32 v159, v159, v111
    s_waitcnt lgkmcnt(5)
    v_add_f32 v136, v136, v112
    v_add_f32 v137, v137, v113
    v_add_f32 v138, v138, v114
    v_add_f32 v139, v139, v115
    s_waitcnt lgkmcnt(4)
    v_add_f32 v140, v140, v116
    v_add_f32 v141, v141, v117
    v_add_f32 v142, v142, v118
    v_add_f32 v143, v143, v119
    s_waitcnt lgkmcnt(3)
    v_add_f32 v144, v144, v120
    v_add_f32 v145, v145, v121
    v_add_f32 v146, v146, v122
    v_add_f32 v147, v147, v123
    s_waitcnt lgkmcnt(2)
    v_add_f32 v148, v148, v124
    v_add_f32 v149, v149, v125
    v_add_f32 v150, v150, v126
    v_add_f32 v151, v151, v127
    s_waitcnt lgkmcnt(1)
    v_add_f32 v152, v152, v128
    v_add_f32 v153, v153, v129
    v_add_f32 v154, v154, v130
    v_add_f32 v155, v155, v131
    s_waitcnt lgkmcnt(0)
    v_add_f32 v156, v156, v132
    v_add_f32 v157, v157, v133
    v_add_f32 v158, v158, v134
    v_add_f32 v159, v159, v135
    s_branch L_redone
    s_nop 7
L_red3:
L_redone:
    s_mul_i32 s64, s60, 122880
    s_lshl_b32 s71, s61, 7
    s_add_u32 s64, s64, s71
    s_lshl_b32 s71, s87, 5
    s_add_u32 s64, s64, s71
    v_mul_u32_u24 v5, 1280, v2
    v_lshl_add_u32 v5, v3, 3, v5
    v_cvt_pk_bf16_f32 v136, v136, v137
    v_cvt_pk_bf16_f32 v137, v138, v139
    v_add_u32 v6, 0, v5
    buffer_store_dwordx2 v[136:137], v6, s[32:35], s64 offen
    v_cvt_pk_bf16_f32 v140, v140, v141
    v_cvt_pk_bf16_f32 v141, v142, v143
    v_add_u32 v6, 20480, v5
    buffer_store_dwordx2 v[140:141], v6, s[32:35], s64 offen
    v_cvt_pk_bf16_f32 v144, v144, v145
    v_cvt_pk_bf16_f32 v145, v146, v147
    v_add_u32 v6, 40960, v5
    buffer_store_dwordx2 v[144:145], v6, s[32:35], s64 offen
    v_cvt_pk_bf16_f32 v148, v148, v149
    v_cvt_pk_bf16_f32 v149, v150, v151
    v_add_u32 v6, 61440, v5
    buffer_store_dwordx2 v[148:149], v6, s[32:35], s64 offen
    v_cvt_pk_bf16_f32 v152, v152, v153
    v_cvt_pk_bf16_f32 v153, v154, v155
    v_add_u32 v6, 81920, v5
    buffer_store_dwordx2 v[152:153], v6, s[32:35], s64 offen
    v_cvt_pk_bf16_f32 v156, v156, v157
    v_cvt_pk_bf16_f32 v157, v158, v159
    v_add_u32 v6, 102400, v5
    buffer_store_dwordx2 v[156:157], v6, s[32:35], s64 offen
L_END:
    s_endpgm

.section .rodata,"a"
.p2align 6
.amdhsa_kernel gated_mix__sliding_block__dense_activation_relu__prompt_kernel
  .amdhsa_next_free_vgpr 256
  .amdhsa_next_free_sgpr 102
  .amdhsa_accum_offset 256
  .amdhsa_group_segment_fixed_size 0
  .amdhsa_kernarg_size 80
  .amdhsa_user_sgpr_count 2
  .amdhsa_user_sgpr_kernarg_segment_ptr 1
  .amdhsa_system_sgpr_workgroup_id_x 1
.end_amdhsa_kernel
```
